```python
import torch

def _softmax(x, axis=-1):
    return torch.softmax(x, dim=axis)
def _gelu(x):
    return torch.nn.functional.gelu(x, approximate="tanh")
def _silu(x):
    return torch.nn.functional.silu(x)
def _sigmoid(x):
    return torch.sigmoid(x)
def _layernorm(x, axis=-1, eps=1e-5):
    m = x.mean(dim=axis, keepdim=True)
    v = x.var(dim=axis, keepdim=True, unbiased=False)
    return (x - m) / torch.sqrt(v + eps)
def _scatter_add(tgt, idx, src, axis=0):
    return tgt.clone().index_add_(axis, idx, src)
def _segment_sum(src, seg, n):
    out = torch.zeros((n,) + src.shape[1:], dtype=src.dtype)
    return out.index_add_(0, seg, src)
def _pad(x, pw):
    flat = tuple(v for pair in reversed(pw) for v in pair)
    return torch.nn.functional.pad(x, flat)

kernel_name = 'interleave_layers__sliding_local_dilated__sliding_local_dilated__prompt'

def setup_inputs():

    _w = (lambda a: (lambda t: t.to(torch.bfloat16) if t.is_floating_point() else t)(torch.as_tensor(a)))
    def _A_setup():
        B, S, D = 1, 2048, 512
        return {
            "x": _w((lambda *s: torch.randn(*s, dtype=torch.bfloat16) * 0.05)(B, S, D)),
            "wqkv": _w((lambda *s: torch.randn(*s, dtype=torch.bfloat16) * 0.05)(D, 3 * D)),
            "wo": _w((lambda *s: torch.randn(*s, dtype=torch.bfloat16) * 0.05)(D, D)),
        }
    _A_in = _A_setup()

    def _B_setup():
        B, S, D = 1, 2048, 512
        return {
            "x": _w((lambda *s: torch.randn(*s, dtype=torch.bfloat16) * 0.05)(B, S, D)),
            "wqkv": _w((lambda *s: torch.randn(*s, dtype=torch.bfloat16) * 0.05)(D, 3 * D)),
            "wo": _w((lambda *s: torch.randn(*s, dtype=torch.bfloat16) * 0.05)(D, D)),
        }
    _B_in = _B_setup()

    return {
        "A_x": _A_in["x"],
        "A_wqkv": _A_in["wqkv"],
        "A_wo": _A_in["wo"],
        "B_x": _B_in["x"],
        "B_wqkv": _B_in["wqkv"],
        "B_wo": _B_in["wo"],
    }

def reference(A_x, A_wqkv, A_wo, B_x, B_wqkv, B_wo):
    def _A_ref(x, wqkv, wo):
        B, S, D = x.shape
        H = 32; Dh = D // H
        W, dil = 8, 2
        qkv = (lambda x, *d: x.permute(*d))((x @ wqkv).reshape(B, S, 3, H, Dh), 2, 0, 3, 1, 4)
        q, k, v = qkv[0], qkv[1], qkv[2]
        scale = Dh ** -0.5
        pos = torch.arange(S)
        off = torch.arange(W) * dil
        idx = pos[:, None] - off[None, :]
        mask = idx >= 0
        idx_c = torch.where(mask, idx, 0).reshape(-1)
        kg = k[:, :, idx_c, :].reshape(B, H, S, W, Dh)
        vg = v[:, :, idx_c, :].reshape(B, H, S, W, Dh)
        logits = torch.einsum("bhsd,bhswd->bhsw", q, kg) * scale
        logits = torch.where(mask[None, None, :, :], logits, -1e9)
        attn = _softmax(logits, axis=-1)
        o = torch.einsum("bhsw,bhswd->bhsd", attn, vg)
        return (lambda x, *d: x.permute(*d))(o, 0, 2, 1, 3).reshape(B, S, D) @ wo

    def _B_ref(x, wqkv, wo):
        B, S, D = x.shape
        H = 32; Dh = D // H
        W, dil = 8, 2
        qkv = (lambda x, *d: x.permute(*d))((x @ wqkv).reshape(B, S, 3, H, Dh), 2, 0, 3, 1, 4)
        q, k, v = qkv[0], qkv[1], qkv[2]
        scale = Dh ** -0.5
        pos = torch.arange(S)
        off = torch.arange(W) * dil
        idx = pos[:, None] - off[None, :]
        mask = idx >= 0
        idx_c = torch.where(mask, idx, 0).reshape(-1)
        kg = k[:, :, idx_c, :].reshape(B, H, S, W, Dh)
        vg = v[:, :, idx_c, :].reshape(B, H, S, W, Dh)
        logits = torch.einsum("bhsd,bhswd->bhsw", q, kg) * scale
        logits = torch.where(mask[None, None, :, :], logits, -1e9)
        attn = _softmax(logits, axis=-1)
        o = torch.einsum("bhsw,bhswd->bhsd", attn, vg)
        return (lambda x, *d: x.permute(*d))(o, 0, 2, 1, 3).reshape(B, S, D) @ wo

    x = A_x
    x = x + _A_ref(_layernorm(x, axis=-1), A_wqkv, A_wo)
    x = x + _B_ref(_layernorm(x, axis=-1), B_wqkv, B_wo)
    x = x + _A_ref(_layernorm(x, axis=-1), A_wqkv, A_wo)
    x = x + _B_ref(_layernorm(x, axis=-1), B_wqkv, B_wo)
    return x
```

```asm
; @launch grid=(256,1,1) block=(256,1,1) lds=163840
.amdgcn_target "amdgcn-amd-amdhsa--gfx950"
.text
.globl interleave_layers__sliding_local_dilated__sliding_local_dilated__prompt_kernel
.p2align 8
.type interleave_layers__sliding_local_dilated__sliding_local_dilated__prompt_kernel,@function
interleave_layers__sliding_local_dilated__sliding_local_dilated__prompt_kernel:
    s_cmp_ge_u32 s2, 0x100
    s_cbranch_scc0 L_go
    s_endpgm
L_go:
    s_load_dwordx2 s[12:13], s[0:1], 8
    s_load_dwordx2 s[8:9], s[0:1], 0
    s_load_dwordx2 s[36:37], s[0:1], 64
    s_getpc_b64 s[52:53]
L_pc:
    v_lshrrev_b32 v56, 6, v0
    v_and_b32 v57, 3, v0
    v_lshl_add_u32 v56, v56, 2, v57
    s_lshr_b32 s74, s2, 3
    s_lshl_b32 s74, s74, 7
    v_lshl_add_u32 v56, v56, 12, s74
    v_min_u32 v125, L_q0S-L_pc, v56
    v_mov_b32 v56, v125
    v_mov_b32 v57, 0
    v_lshl_add_u64 v[56:57], v[56:57], 0, s[52:53]
    global_load_dword v53, v[56:57], off
    v_lshrrev_b32 v43, 6, v0
    v_and_b32 v40, 63, v0
    v_readfirstlane_b32 s68, v43
    v_lshrrev_b32 v42, 4, v40
    v_lshrrev_b32 v43, 3, v40
    v_and_b32 v44, 7, v40
    s_and_b32 s74, s2, 7
    s_bfe_u32 s69, s2, 0x30003
    s_lshr_b32 s75, s2, 6
    s_lshl_b32 s70, s74, 2
    s_add_u32 s70, s70, s75
    s_lshl_b32 s75, s69, 7
    s_and_b32 s101, s70, 3
    s_lshl_b32 s101, s101, 1
    s_mov_b32 s14, 0x180000
    s_mov_b32 s15, 0x20000
    v_and_b32 v46, 1, v42
    v_lshlrev_b32 v45, 1, v46
    v_xor_b32 v45, v45, v44
    s_mul_i32 s92, s68, 49152
    s_add_u32 s92, s92, s75
    v_lshl_add_u32 v45, v45, 4, s92
    v_mul_u32_u24 v120, 0xc00, v43
    v_add_u32 v120, v120, v45
    v_xor_b32 v121, 64, v120
    v_add_u32 v121, 24576, v121
    s_mul_i32 s48, s68, 6144
    v_min_u32 v126, 11, v40
    s_lshr_b32 s92, s2, 3
    s_lshl_b32 s92, s92, 2
    s_add_u32 s92, s92, s68
    s_mul_i32 s92, s92, 12288
    s_add_u32 s92, s92, 384
    v_lshl_add_u32 v126, v126, 10, s92
    s_and_b32 s76, s70, 15
    s_lshr_b32 s92, s70, 4
    s_lshl_b32 s92, s92, 10
    s_lshl_b32 s71, s76, 17
    s_add_u32 s71, s71, s92
    s_mov_b32 s10, 0x200000
    s_mov_b32 s11, 0x20000
    s_lshl_b32 s80, s68, 12
    v_xor_b32 v45, v44, v42
    v_lshlrev_b32 v45, 4, v45
    v_lshl_add_u32 v48, v43, 11, v45
    s_add_u32 s4, s68, s70
    s_and_b32 s4, s4, 3
    s_lshl_b32 s92, s4, 8
    v_add_u32 v48, s92, v48
    s_and_b32 s92, s69, 1
    s_lshl_b32 s92, s92, 6
    v_xor_b32 v48, s92, v48
    v_xor_b32 v49, 64, v48
    s_mul_i32 s88, s70, 0x52000
    s_add_u32 s82, s88, 0x21000
    s_mov_b32 s38, 0xd00000
    s_mov_b32 s39, 0x20000
    v_mov_b32 v51, 0
    v_lshrrev_b32 v45, 2, v40
    v_lshrrev_b32 v47, 5, v40
    v_mad_u32_u24 v45, v47, s69, v45
    v_and_b32 v47, 3, v40
    v_lshlrev_b32 v47, 2, v47
    v_lshl_add_u32 v45, v45, 7, v47
    s_lshl_b32 s92, s69, 4
    s_add_u32 s92, s92, s82
    s_add_u32 s96, s69, 0
    s_and_b32 s96, s96, 7
    s_and_b32 s97, s96, 1
    s_mul_i32 s97, s97, 4294960128
    s_lshl_b32 s96, s96, 13
    s_add_u32 s97, s97, s96
    s_add_u32 m0, s97, s80
    s_lshl_b32 s96, s96, 1
    s_add_u32 s96, s96, s71
    s_cmp_lg_u32 s68, 3
    s_waitcnt lgkmcnt(0)
    s_cbranch_scc1 L_noclr_1
    s_mov_b32 exec_hi, 15
    buffer_store_dword v51, v45, s[36:39], s92 offen sc1
    s_mov_b64 exec, -1
L_noclr_1:
    buffer_load_dword v55, v126, s[12:15], 0 offen
    s_load_dwordx2 s[32:33], s[0:1], 56
    s_load_dwordx2 s[16:17], s[0:1], 16
    s_load_dwordx2 s[20:21], s[0:1], 32
    s_load_dwordx2 s[24:25], s[0:1], 40
    s_load_dwordx2 s[28:29], s[0:1], 48
    buffer_load_dwordx4 v48, s[8:11], s96 offen lds
    s_add_u32 m0, m0, 1920
    s_nop 0
    buffer_load_dwordx4 v48, s[8:11], s96 offen offset:128 lds
    s_add_u32 s49, s101, 0
    s_and_b32 s49, s49, 7
    s_mul_i32 s49, s49, 196608
    s_add_u32 m0, s48, 133120
    s_nop 0
    buffer_load_dwordx4 v120, s[12:15], s49 offen offset:0 lds
    buffer_load_dwordx4 v120, s[12:15], s49 offen offset:1024 lds
    buffer_load_dwordx4 v120, s[12:15], s49 offen offset:2048 lds
    s_add_u32 m0, s48, 136192
    s_nop 0
    buffer_load_dwordx4 v121, s[12:15], s49 offen offset:0 lds
    buffer_load_dwordx4 v121, s[12:15], s49 offen offset:1024 lds
    buffer_load_dwordx4 v121, s[12:15], s49 offen offset:2048 lds
    s_add_u32 s49, s101, 1
    s_and_b32 s49, s49, 7
    s_mul_i32 s49, s49, 196608
    s_add_u32 m0, s48, 65536
    s_nop 0
    buffer_load_dwordx4 v120, s[12:15], s49 offen offset:0 lds
    buffer_load_dwordx4 v120, s[12:15], s49 offen offset:1024 lds
    buffer_load_dwordx4 v120, s[12:15], s49 offen offset:2048 lds
    s_add_u32 m0, s48, 68608
    s_nop 0
    buffer_load_dwordx4 v121, s[12:15], s49 offen offset:0 lds
    buffer_load_dwordx4 v121, s[12:15], s49 offen offset:1024 lds
    buffer_load_dwordx4 v121, s[12:15], s49 offen offset:2048 lds
    s_mov_b32 s22, 0x180000
    s_mov_b32 s23, 0x20000
    s_mov_b32 s30, 0x200000
    s_mov_b32 s31, 0x20000
    s_mov_b32 s34, 0x100
    s_mov_b32 s35, 0x20000
    s_mov_b32 s42, 0x80000
    s_mov_b32 s43, 0x20000
    s_waitcnt lgkmcnt(0)
    s_getreg_b32 s93, hwreg(HW_REG_XCC_ID, 0, 4)
    s_mul_i32 s79, s93, s93
    s_lshl_b32 s79, s79, 16
    s_lshl_b32 s93, s93, 8
    s_add_u32 s79, s79, s93
    s_add_u32 s79, s79, 1
    s_lshl_b32 s77, s70, 3
    s_cmp_lg_u32 s68, 3
    s_cbranch_scc1 L_nohs_2
    v_mov_b32 v50, s79
    s_waitcnt vmcnt(15)
    s_mov_b64 exec, 1
    buffer_atomic_add v50, off, s[32:35], s77 sc1
    s_mov_b64 exec, -1
L_nohs_2:
    v_and_b32 v41, 15, v40
    v_bfe_u32 v47, v40, 2, 2
    v_and_b32 v51, 3, v40
    v_mul_u32_u24 v45, 0xc00, v42
    v_lshl_add_u32 v45, v47, 7, v45
    v_lshl_add_u32 v45, v51, 3, v45
    v_bfe_u32 v44, v40, 3, 2
    v_xor_b32 v44, s68, v44
    v_lshl_add_u32 v45, v44, 5, v45
    v_add_u32 v122, 65536, v45
    v_add_u32 v123, 133120, v45
    v_mov_b32 v34, 0x3f803f80
    v_mov_b32 v35, 0x3f803f80
    v_mov_b32 v36, 0x3f803f80
    v_mov_b32 v37, 0x3f803f80
    s_lshl_b32 s92, s69, 2
    s_add_u32 s92, s92, s68
    s_lshl_b32 s93, s92, 2
    s_add_u32 s83, s82, s93
    s_lshl_b32 s93, s92, 10
    s_add_u32 s84, s88, s93
    s_add_u32 s84, s84, 0x22000
    v_lshlrev_b32 v16, 4, v40
    s_mov_b64 s[40:41], s[16:17]
    s_cmp_eq_u32 s76, 0
    s_cselect_b32 s100, 0xf149f2ca, 0
    s_cselect_b32 s93, 0, 0x52000
    s_cselect_b32 s78, 0, 8
    s_sub_u32 s85, s84, s93
    s_sub_u32 s58, s83, s93
    s_add_u32 s58, s58, s75
    s_add_u32 s86, s88, 0x20000
    s_lshl_b32 s93, s69, 8
    s_add_u32 s87, s86, s93
    s_mul_i32 s81, s68, 4224
    s_mov_b32 s72, 1
    s_lshl_b32 s19, s101, 16
    s_lshl_b32 s93, s92, 9
    v_lshrrev_b32 v44, 1, v42
    v_lshl_add_u32 v45, v44, 4, v41
    v_lshl_add_u32 v20, v45, 4, s93
    v_lshl_add_u32 v19, v46, 3, v20
    v_lshl_add_u32 v45, v41, 1, v44
    s_lshl_b32 s93, s68, 2
    s_add_u32 s93, s93, 158208
    v_lshl_add_u32 v26, v45, 4, s93
    v_lshlrev_b32 v45, 2, v45
    v_add_u32 v27, 157696, v45
    v_add_u32 v28, 158208, v16
    v_lshlrev_b32 v21, 2, v40
    v_and_b32 v22, 0x7c, v21
    v_lshlrev_b32 v45, 2, v41
    v_add_u32 v23, 157696, v45
    v_lshlrev_b32 v45, 4, v42
    v_add_u32 v24, 157696, v45
    v_mov_b32 v25, 1
    v_mul_u32_u24 v45, 1056, v47
    v_lshl_add_u32 v45, v46, 7, v45
    v_lshl_add_u32 v45, v44, 9, v45
    v_lshl_add_u32 v45, v51, 3, v45
    s_lshl_b32 s93, s68, 5
    s_add_u32 s93, s93, 65536
    v_add_u32 v18, s93, v45
    v_and_b32 v45, 1, v43
    v_lshlrev_b32 v45, 1, v45
    v_and_b32 v47, 4, v43
    v_or_b32 v45, v45, v47
    v_bfe_u32 v47, v43, 1, 1
    v_or_b32 v45, v45, v47
    s_lshl_b32 s93, s68, 15
    s_add_u32 s93, s93, s75
    v_lshl_add_u32 v45, v45, 12, s93
    v_and_b32 v47, 7, v40
    v_lshl_add_u32 v17, v47, 4, v45
    v_lshrrev_b32 v47, 1, v41
    v_xor_b32 v45, v47, v42
    v_lshlrev_b32 v45, 4, v45
    v_lshl_add_u32 v118, v41, 7, v45
    v_xor_b32 v119, 64, v118
    s_lshl_b32 s93, s68, 1
    v_add_u32 v45, s93, v44
    v_xor_b32 v45, v45, v47
    s_sub_u32 s93, s69, s101
    s_and_b32 s93, s93, 7
    s_lshl_b32 s93, s93, 11
    v_lshl_add_u32 v45, v45, 4, s93
    v_lshl_add_u32 v45, v41, 7, v45
    v_lshl_add_u32 v52, v46, 3, v45
    v_mov_b32 v47, 0xf149f2ca
    v_lshl_add_u32 v45, v42, 2, 0
    v_cmp_le_u32 s[60:61], v45, v41
    v_sub_u32 v45, v41, v45
    v_and_b32 v45, 15, v45
    v_cmp_ge_u32 vcc, 7, v45
    s_nop 1
    v_cndmask_b32 v30, v47, 0, vcc
    v_lshl_add_u32 v45, v42, 2, 1
    v_cmp_le_u32 s[62:63], v45, v41
    v_sub_u32 v45, v41, v45
    v_and_b32 v45, 15, v45
    v_cmp_ge_u32 vcc, 7, v45
    s_nop 1
    v_cndmask_b32 v31, v47, 0, vcc
    v_lshl_add_u32 v45, v42, 2, 2
    v_cmp_le_u32 s[64:65], v45, v41
    v_sub_u32 v45, v41, v45
    v_and_b32 v45, 15, v45
    v_cmp_ge_u32 vcc, 7, v45
    s_nop 1
    v_cndmask_b32 v32, v47, 0, vcc
    v_lshl_add_u32 v45, v42, 2, 3
    v_cmp_le_u32 s[66:67], v45, v41
    v_sub_u32 v45, v41, v45
    v_and_b32 v45, 15, v45
    v_cmp_ge_u32 vcc, 7, v45
    s_nop 1
    v_cndmask_b32 v33, v47, 0, vcc
    v_mov_b32 v47, 0xffff
    v_mov_b32 v46, 0xffff0000
    v_cndmask_b32 v38, 0, v47, s[60:61]
    v_cndmask_b32 v45, 0, v46, s[62:63]
    v_or_b32 v38, v38, v45
    v_cndmask_b32 v39, 0, v47, s[64:65]
    v_cndmask_b32 v45, 0, v46, s[66:67]
    v_or_b32 v39, v39, v45
    ds_write_b128 v28, v[30:33] offset:3584
    ds_write_b64 v28, v[38:39] offset:4608
    s_sub_u32 s78, s77, s78
    v_mov_b32 v20, s77
    v_mov_b32 v45, s78
    v_cmp_eq_u32 vcc, 0, v40
    s_nop 1
    v_cndmask_b32 v20, v45, v20, vcc
    s_waitcnt vmcnt(6)
    s_barrier
    ds_read_b64_tr_b16 a[0:1], v123 offset:0
    ds_read_b64_tr_b16 a[2:3], v123 offset:512
    ds_read_b64_tr_b16 a[4:5], v123 offset:1024
    ds_read_b64_tr_b16 a[6:7], v123 offset:1536
    ds_read_b64_tr_b16 a[8:9], v123 offset:2048
    ds_read_b64_tr_b16 a[10:11], v123 offset:2560
    ds_read_b64_tr_b16 a[12:13], v123 offset:12288
    ds_read_b64_tr_b16 a[14:15], v123 offset:12800
    ds_read_b64_tr_b16 a[16:17], v123 offset:13312
    ds_read_b64_tr_b16 a[18:19], v123 offset:13824
    ds_read_b64_tr_b16 a[20:21], v123 offset:14336
    ds_read_b64_tr_b16 a[22:23], v123 offset:14848
    s_add_u32 s96, s69, 1
    s_and_b32 s96, s96, 7
    s_and_b32 s97, s96, 1
    s_mul_i32 s97, s97, 4294960128
    s_lshl_b32 s96, s96, 13
    s_add_u32 s97, s97, s96
    s_add_u32 m0, s97, s80
    s_lshl_b32 s96, s96, 1
    s_add_u32 s96, s96, s71
    buffer_load_dwordx4 v49, s[8:11], s96 offen lds
    s_add_u32 m0, m0, 1920
    s_nop 0
    buffer_load_dwordx4 v49, s[8:11], s96 offen offset:128 lds
    s_add_u32 s96, s69, 2
    s_and_b32 s96, s96, 7
    s_and_b32 s97, s96, 1
    s_mul_i32 s97, s97, 4294960128
    s_lshl_b32 s96, s96, 13
    s_add_u32 s97, s97, s96
    s_add_u32 m0, s97, s80
    s_lshl_b32 s96, s96, 1
    s_add_u32 s96, s96, s71
    buffer_load_dwordx4 v48, s[8:11], s96 offen lds
    s_add_u32 m0, m0, 1920
    s_nop 0
    buffer_load_dwordx4 v48, s[8:11], s96 offen offset:128 lds
    s_add_u32 s96, s69, 3
    s_and_b32 s96, s96, 7
    s_and_b32 s97, s96, 1
    s_mul_i32 s97, s97, 4294960128
    s_lshl_b32 s96, s96, 13
    s_add_u32 s97, s97, s96
    s_add_u32 m0, s97, s80
    s_lshl_b32 s96, s96, 1
    s_add_u32 s96, s96, s71
    buffer_load_dwordx4 v49, s[8:11], s96 offen lds
    s_add_u32 m0, m0, 1920
    s_nop 0
    buffer_load_dwordx4 v49, s[8:11], s96 offen offset:128 lds
    s_add_u32 s96, s69, 4
    s_and_b32 s96, s96, 7
    s_and_b32 s97, s96, 1
    s_mul_i32 s97, s97, 4294960128
    s_lshl_b32 s96, s96, 13
    s_add_u32 s97, s97, s96
    s_add_u32 m0, s97, s80
    s_lshl_b32 s96, s96, 1
    s_add_u32 s96, s96, s71
    buffer_load_dwordx4 v48, s[8:11], s96 offen lds
    s_add_u32 m0, m0, 1920
    s_nop 0
    buffer_load_dwordx4 v48, s[8:11], s96 offen offset:128 lds
    s_add_u32 s96, s69, 5
    s_and_b32 s96, s96, 7
    s_and_b32 s97, s96, 1
    s_mul_i32 s97, s97, 4294960128
    s_lshl_b32 s96, s96, 13
    s_add_u32 s97, s97, s96
    s_add_u32 m0, s97, s80
    s_lshl_b32 s96, s96, 1
    s_add_u32 s96, s96, s71
    buffer_load_dwordx4 v49, s[8:11], s96 offen lds
    s_add_u32 m0, m0, 1920
    s_nop 0
    buffer_load_dwordx4 v49, s[8:11], s96 offen offset:128 lds
    s_add_u32 s96, s69, 6
    s_and_b32 s96, s96, 7
    s_and_b32 s97, s96, 1
    s_mul_i32 s97, s97, 4294960128
    s_lshl_b32 s96, s96, 13
    s_add_u32 s97, s97, s96
    s_add_u32 m0, s97, s80
    s_lshl_b32 s96, s96, 1
    s_add_u32 s96, s96, s71
    buffer_load_dwordx4 v48, s[8:11], s96 offen lds
    s_add_u32 m0, m0, 1920
    s_nop 0
    buffer_load_dwordx4 v48, s[8:11], s96 offen offset:128 lds
    s_add_u32 s96, s69, 7
    s_and_b32 s96, s96, 7
    s_and_b32 s97, s96, 1
    s_mul_i32 s97, s97, 4294960128
    s_lshl_b32 s96, s96, 13
    s_add_u32 s97, s97, s96
    s_add_u32 m0, s97, s80
    s_lshl_b32 s96, s96, 1
    s_add_u32 s96, s96, s71
    buffer_load_dwordx4 v49, s[8:11], s96 offen lds
    s_add_u32 m0, m0, 1920
    s_nop 0
    buffer_load_dwordx4 v49, s[8:11], s96 offen offset:128 lds
    s_add_u32 s49, s101, 2
    s_and_b32 s49, s49, 7
    s_mul_i32 s49, s49, 196608
    s_add_u32 m0, s48, 90112
    s_nop 0
    buffer_load_dwordx4 v120, s[12:15], s49 offen offset:0 lds
    buffer_load_dwordx4 v120, s[12:15], s49 offen offset:1024 lds
    buffer_load_dwordx4 v120, s[12:15], s49 offen offset:2048 lds
    s_add_u32 m0, s48, 93184
    s_nop 0
    buffer_load_dwordx4 v121, s[12:15], s49 offen offset:0 lds
    buffer_load_dwordx4 v121, s[12:15], s49 offen offset:1024 lds
    buffer_load_dwordx4 v121, s[12:15], s49 offen offset:2048 lds
    s_add_u32 s89, s88, 16384
    s_add_u32 s90, s88, 32768
    s_add_u32 s91, s88, 49152
    s_lshl_b32 s78, s4, 12
    s_add_u32 s92, s88, s78
    s_add_u32 s96, s88, 0x10000
    s_add_u32 s4, s96, s78
    s_add_u32 s93, s89, s78
    s_add_u32 s97, s89, 0x10000
    s_add_u32 s5, s97, s78
    s_add_u32 s94, s90, s78
    s_add_u32 s98, s90, 0x10000
    s_add_u32 s6, s98, s78
    s_add_u32 s95, s91, s78
    s_add_u32 s99, s91, 0x10000
    s_add_u32 s7, s99, s78
    v_mov_b32 v47, -1
    s_add_u32 s78, s84, 0x8000
    s_lshl_b32 s76, s68, 14
    v_add_u32 v48, s76, v118
    v_add_u32 v49, s76, v119
    s_waitcnt lgkmcnt(0)
    s_add_u32 s49, s101, 3
    s_and_b32 s49, s49, 7
    s_mul_i32 s49, s49, 196608
    s_add_u32 m0, s48, 133120
    s_waitcnt vmcnt(20)
    s_barrier
    buffer_load_dwordx4 v120, s[12:15], s49 offen offset:0 lds
    ds_read_b64_tr_b16 a[24:25], v122 offset:0
    ds_read_b64_tr_b16 a[26:27], v122 offset:512
    buffer_load_dwordx4 v120, s[12:15], s49 offen offset:1024 lds
    ds_read_b64_tr_b16 a[28:29], v122 offset:1024
    ds_read_b64_tr_b16 a[30:31], v122 offset:1536
    v_mfma_f32_16x16x32_bf16 v[104:107], a[0:3], v[34:37], 0
    buffer_load_dwordx4 v120, s[12:15], s49 offen offset:2048 lds
    ds_read_b64_tr_b16 a[32:33], v122 offset:2048
    ds_read_b64_tr_b16 a[34:35], v122 offset:2560
    v_mfma_f32_16x16x32_bf16 v[108:111], a[4:7], v[34:37], 0
    s_add_u32 m0, s48, 136192
    s_nop 0
    buffer_load_dwordx4 v121, s[12:15], s49 offen offset:0 lds
    ds_read_b64_tr_b16 a[36:37], v122 offset:12288
    ds_read_b64_tr_b16 a[38:39], v122 offset:12800
    v_mfma_f32_16x16x32_bf16 v[112:115], v[34:37], a[8:11], 0
    buffer_load_dwordx4 v121, s[12:15], s49 offen offset:1024 lds
    ds_read_b64_tr_b16 a[40:41], v122 offset:13312
    ds_read_b64_tr_b16 a[42:43], v122 offset:13824
    buffer_load_dwordx4 v121, s[12:15], s49 offen offset:2048 lds
    ds_read_b64_tr_b16 a[44:45], v122 offset:14336
    ds_read_b64_tr_b16 a[46:47], v122 offset:14848
    v_mfma_f32_16x16x32_bf16 v[104:107], a[12:15], v[34:37], v[104:107]
    buffer_store_dwordx4 v[44:47], v16, s[36:39], s84 offen sc1
    v_mfma_f32_16x16x32_bf16 v[108:111], a[16:19], v[34:37], v[108:111]
    buffer_store_dwordx4 v[44:47], v16, s[36:39], s78 offen sc1
    v_mfma_f32_16x16x32_bf16 v[112:115], v[34:37], a[20:23], v[112:115]
    s_waitcnt lgkmcnt(0)
    s_add_u32 s49, s101, 4
    s_and_b32 s49, s49, 7
    s_mul_i32 s49, s49, 196608
    s_add_u32 m0, s48, 65536
    s_waitcnt vmcnt(8)
    s_barrier
    buffer_load_dwordx4 v120, s[12:15], s49 offen offset:0 lds
    ds_read_b64_tr_b16 a[48:49], v122 offset:24576
    ds_read_b64_tr_b16 a[50:51], v122 offset:25088
    ds_read_b64_tr_b16 a[52:53], v122 offset:25600
    ds_read_b64_tr_b16 a[54:55], v122 offset:26112
    v_mfma_f32_16x16x32_bf16 v[104:107], a[24:27], v[34:37], v[104:107]
    buffer_load_dwordx4 v120, s[12:15], s49 offen offset:1024 lds
    ds_read_b64_tr_b16 a[56:57], v122 offset:26624
    ds_read_b64_tr_b16 a[58:59], v122 offset:27136
    ds_read_b64_tr_b16 a[60:61], v122 offset:36864
    ds_read_b64_tr_b16 a[62:63], v122 offset:37376
    v_mfma_f32_16x16x32_bf16 v[108:111], a[28:31], v[34:37], v[108:111]
    buffer_load_dwordx4 v120, s[12:15], s49 offen offset:2048 lds
    ds_read_b64_tr_b16 a[64:65], v122 offset:37888
    ds_read_b64_tr_b16 a[66:67], v122 offset:38400
    ds_read_b64_tr_b16 a[68:69], v122 offset:38912
    ds_read_b64_tr_b16 a[70:71], v122 offset:39424
    v_mfma_f32_16x16x32_bf16 v[112:115], v[34:37], a[32:35], v[112:115]
    s_add_u32 m0, s48, 68608
    s_nop 0
    buffer_load_dwordx4 v121, s[12:15], s49 offen offset:0 lds
    ds_read_b128 v[80:83], v48 offset:0
    ds_read_b128 v[84:87], v49 offset:0
    ds_read_b128 v[88:91], v48 offset:2048
    ds_read_b128 v[92:95], v49 offset:2048
    v_mfma_f32_16x16x32_bf16 v[104:107], a[36:39], v[34:37], v[104:107]
    buffer_load_dwordx4 v121, s[12:15], s49 offen offset:1024 lds
    v_mfma_f32_16x16x32_bf16 v[108:111], a[40:43], v[34:37], v[108:111]
    buffer_load_dwordx4 v121, s[12:15], s49 offen offset:2048 lds
    v_mfma_f32_16x16x32_bf16 v[112:115], v[34:37], a[44:47], v[112:115]
    s_waitcnt lgkmcnt(0)
    s_add_u32 s49, s101, 5
    s_and_b32 s49, s49, 7
    s_mul_i32 s49, s49, 196608
    s_add_u32 m0, s48, 90112
    s_waitcnt vmcnt(8)
    s_barrier
    buffer_load_dwordx4 v120, s[12:15], s49 offen offset:0 lds
    ds_read_b64_tr_b16 a[72:73], v123 offset:0
    ds_read_b64_tr_b16 a[74:75], v123 offset:512
    ds_read_b64_tr_b16 a[76:77], v123 offset:1024
    ds_read_b64_tr_b16 a[78:79], v123 offset:1536
    v_mfma_f32_16x16x32_bf16 v[96:99], v[34:37], v[80:83], 0
    v_mfma_f32_16x16x32_bf16 v[60:63], v[80:83], v[80:83], 0
    buffer_load_dwordx4 v120, s[12:15], s49 offen offset:1024 lds
    ds_read_b64_tr_b16 a[80:81], v123 offset:2048
    ds_read_b64_tr_b16 a[82:83], v123 offset:2560
    ds_read_b64_tr_b16 a[84:85], v123 offset:12288
    ds_read_b64_tr_b16 a[86:87], v123 offset:12800
    v_mfma_f32_16x16x32_bf16 v[96:99], v[34:37], v[84:87], v[96:99]
    v_mfma_f32_16x16x32_bf16 v[60:63], v[84:87], v[84:87], v[60:63]
    buffer_load_dwordx4 v120, s[12:15], s49 offen offset:2048 lds
    ds_read_b64_tr_b16 a[88:89], v123 offset:13312
    ds_read_b64_tr_b16 a[90:91], v123 offset:13824
    ds_read_b64_tr_b16 a[92:93], v123 offset:14336
    ds_read_b64_tr_b16 a[94:95], v123 offset:14848
    v_mfma_f32_16x16x32_bf16 v[96:99], v[34:37], v[88:91], v[96:99]
    v_mfma_f32_16x16x32_bf16 v[60:63], v[88:91], v[88:91], v[60:63]
    v_mfma_f32_16x16x32_bf16 v[96:99], v[34:37], v[92:95], v[96:99]
    s_add_u32 m0, s48, 93184
    s_nop 0
    buffer_load_dwordx4 v121, s[12:15], s49 offen offset:0 lds
    ds_read_b128 v[64:67], v48 offset:4096
    ds_read_b128 v[68:71], v49 offset:4096
    ds_read_b128 v[72:75], v48 offset:6144
    ds_read_b128 v[76:79], v49 offset:6144
    v_mfma_f32_16x16x32_bf16 v[60:63], v[92:95], v[92:95], v[60:63]
    v_mfma_f32_16x16x32_bf16 v[104:107], a[48:51], v[34:37], v[104:107]
    buffer_load_dwordx4 v121, s[12:15], s49 offen offset:1024 lds
    v_mfma_f32_16x16x32_bf16 v[108:111], a[52:55], v[34:37], v[108:111]
    v_mfma_f32_16x16x32_bf16 v[112:115], v[34:37], a[56:59], v[112:115]
    buffer_load_dwordx4 v121, s[12:15], s49 offen offset:2048 lds
    v_mfma_f32_16x16x32_bf16 v[104:107], a[60:63], v[34:37], v[104:107]
    v_mfma_f32_16x16x32_bf16 v[108:111], a[64:67], v[34:37], v[108:111]
    v_mfma_f32_16x16x32_bf16 v[112:115], v[34:37], a[68:71], v[112:115]
    s_waitcnt lgkmcnt(0)
    s_add_u32 s49, s101, 6
    s_and_b32 s49, s49, 7
    s_mul_i32 s49, s49, 196608
    s_add_u32 m0, s48, 133120
    s_waitcnt vmcnt(6)
    s_barrier
    buffer_load_dwordx4 v120, s[12:15], s49 offen offset:0 lds
    ds_read_b64_tr_b16 a[96:97], v122 offset:0
    ds_read_b64_tr_b16 a[98:99], v122 offset:512
    ds_read_b64_tr_b16 a[100:101], v122 offset:1024
    ds_read_b64_tr_b16 a[102:103], v122 offset:1536
    v_mfma_f32_16x16x32_bf16 v[96:99], v[34:37], v[64:67], v[96:99]
    v_mfma_f32_16x16x32_bf16 v[60:63], v[64:67], v[64:67], v[60:63]
    buffer_load_dwordx4 v120, s[12:15], s49 offen offset:1024 lds
    ds_read_b64_tr_b16 a[104:105], v122 offset:2048
    ds_read_b64_tr_b16 a[106:107], v122 offset:2560
    ds_read_b64_tr_b16 a[108:109], v122 offset:12288
    ds_read_b64_tr_b16 a[110:111], v122 offset:12800
    v_mfma_f32_16x16x32_bf16 v[96:99], v[34:37], v[68:71], v[96:99]
    v_mfma_f32_16x16x32_bf16 v[60:63], v[68:71], v[68:71], v[60:63]
    buffer_load_dwordx4 v120, s[12:15], s49 offen offset:2048 lds
    ds_read_b64_tr_b16 a[112:113], v122 offset:13312
    ds_read_b64_tr_b16 a[114:115], v122 offset:13824
    ds_read_b64_tr_b16 a[116:117], v122 offset:14336
    ds_read_b64_tr_b16 a[118:119], v122 offset:14848
    v_mfma_f32_16x16x32_bf16 v[96:99], v[34:37], v[72:75], v[96:99]
    v_mfma_f32_16x16x32_bf16 v[60:63], v[72:75], v[72:75], v[60:63]
    v_mfma_f32_16x16x32_bf16 v[96:99], v[34:37], v[76:79], v[96:99]
    s_add_u32 m0, s48, 136192
    s_nop 0
    buffer_load_dwordx4 v121, s[12:15], s49 offen offset:0 lds
    ds_read_b128 v[80:83], v48 offset:8192
    ds_read_b128 v[84:87], v49 offset:8192
    ds_read_b128 v[88:91], v48 offset:10240
    ds_read_b128 v[92:95], v49 offset:10240
    v_mfma_f32_16x16x32_bf16 v[60:63], v[76:79], v[76:79], v[60:63]
    v_mfma_f32_16x16x32_bf16 v[104:107], a[72:75], v[34:37], v[104:107]
    buffer_load_dwordx4 v121, s[12:15], s49 offen offset:1024 lds
    v_mfma_f32_16x16x32_bf16 v[108:111], a[76:79], v[34:37], v[108:111]
    v_mfma_f32_16x16x32_bf16 v[112:115], v[34:37], a[80:83], v[112:115]
    buffer_load_dwordx4 v121, s[12:15], s49 offen offset:2048 lds
    v_mfma_f32_16x16x32_bf16 v[104:107], a[84:87], v[34:37], v[104:107]
    v_mfma_f32_16x16x32_bf16 v[108:111], a[88:91], v[34:37], v[108:111]
    v_mfma_f32_16x16x32_bf16 v[112:115], v[34:37], a[92:95], v[112:115]
    s_waitcnt lgkmcnt(0)
    s_add_u32 s49, s101, 7
    s_and_b32 s49, s49, 7
    s_mul_i32 s49, s49, 196608
    s_add_u32 m0, s48, 65536
    s_waitcnt vmcnt(6)
    s_barrier
    buffer_load_dwordx4 v120, s[12:15], s49 offen offset:0 lds
    ds_read_b64_tr_b16 a[120:121], v122 offset:24576
    ds_read_b64_tr_b16 a[122:123], v122 offset:25088
    ds_read_b64_tr_b16 a[124:125], v122 offset:25600
    ds_read_b64_tr_b16 a[126:127], v122 offset:26112
    v_mfma_f32_16x16x32_bf16 v[96:99], v[34:37], v[80:83], v[96:99]
    v_mfma_f32_16x16x32_bf16 v[60:63], v[80:83], v[80:83], v[60:63]
    buffer_load_dwordx4 v120, s[12:15], s49 offen offset:1024 lds
    ds_read_b64_tr_b16 a[128:129], v122 offset:26624
    ds_read_b64_tr_b16 a[130:131], v122 offset:27136
    ds_read_b64_tr_b16 a[132:133], v122 offset:36864
    ds_read_b64_tr_b16 a[134:135], v122 offset:37376
    v_mfma_f32_16x16x32_bf16 v[96:99], v[34:37], v[84:87], v[96:99]
    v_mfma_f32_16x16x32_bf16 v[60:63], v[84:87], v[84:87], v[60:63]
    buffer_load_dwordx4 v120, s[12:15], s49 offen offset:2048 lds
    ds_read_b64_tr_b16 a[136:137], v122 offset:37888
    ds_read_b64_tr_b16 a[138:139], v122 offset:38400
    ds_read_b64_tr_b16 a[140:141], v122 offset:38912
    ds_read_b64_tr_b16 a[142:143], v122 offset:39424
    v_mfma_f32_16x16x32_bf16 v[96:99], v[34:37], v[88:91], v[96:99]
    v_mfma_f32_16x16x32_bf16 v[60:63], v[88:91], v[88:91], v[60:63]
    v_mfma_f32_16x16x32_bf16 v[96:99], v[34:37], v[92:95], v[96:99]
    s_add_u32 m0, s48, 68608
    s_nop 0
    buffer_load_dwordx4 v121, s[12:15], s49 offen offset:0 lds
    ds_read_b128 v[64:67], v48 offset:12288
    ds_read_b128 v[68:71], v49 offset:12288
    ds_read_b128 v[72:75], v48 offset:14336
    ds_read_b128 v[76:79], v49 offset:14336
    v_mfma_f32_16x16x32_bf16 v[60:63], v[92:95], v[92:95], v[60:63]
    v_mfma_f32_16x16x32_bf16 v[104:107], a[96:99], v[34:37], v[104:107]
    buffer_load_dwordx4 v121, s[12:15], s49 offen offset:1024 lds
    v_mfma_f32_16x16x32_bf16 v[108:111], a[100:103], v[34:37], v[108:111]
    v_mfma_f32_16x16x32_bf16 v[112:115], v[34:37], a[104:107], v[112:115]
    buffer_load_dwordx4 v121, s[12:15], s49 offen offset:2048 lds
    v_mfma_f32_16x16x32_bf16 v[104:107], a[108:111], v[34:37], v[104:107]
    v_mfma_f32_16x16x32_bf16 v[108:111], a[112:115], v[34:37], v[108:111]
    v_mfma_f32_16x16x32_bf16 v[112:115], v[34:37], a[116:119], v[112:115]
    s_waitcnt lgkmcnt(0)
    s_add_u32 s49, s101, 0
    s_and_b32 s49, s49, 7
    s_mul_i32 s49, s49, 196608
    s_add_u32 m0, s48, 90112
    s_waitcnt vmcnt(6)
    s_barrier
    s_add_u32 s73, s83, s75
    buffer_store_dword v25, off, s[36:39], s73 offset:1024 sc1
    ds_read_b64_tr_b16 a[144:145], v123 offset:0
    ds_read_b64_tr_b16 a[146:147], v123 offset:512
    v_mfma_f32_16x16x32_bf16 v[96:99], v[34:37], v[64:67], v[96:99]
    buffer_load_dword v29, v20, s[32:35], 0 offen sc1
    ds_read_b64_tr_b16 a[148:149], v123 offset:1024
    ds_read_b64_tr_b16 a[150:151], v123 offset:1536
    v_mfma_f32_16x16x32_bf16 v[60:63], v[64:67], v[64:67], v[60:63]
    v_mfma_f32_16x16x32_bf16 v[96:99], v[34:37], v[68:71], v[96:99]
    buffer_load_dword v126, v126, s[20:23], 0 offen
    ds_read_b64_tr_b16 a[152:153], v123 offset:2048
    ds_read_b64_tr_b16 a[154:155], v123 offset:2560
    v_mfma_f32_16x16x32_bf16 v[60:63], v[68:71], v[68:71], v[60:63]
    buffer_load_dwordx4 v120, s[20:23], s49 offen offset:0 lds
    ds_read_b64_tr_b16 a[156:157], v123 offset:12288
    ds_read_b64_tr_b16 a[158:159], v123 offset:12800
    ds_read_b64_tr_b16 a[160:161], v123 offset:13312
    v_mfma_f32_16x16x32_bf16 v[96:99], v[34:37], v[72:75], v[96:99]
    v_mfma_f32_16x16x32_bf16 v[60:63], v[72:75], v[72:75], v[60:63]
    buffer_load_dwordx4 v120, s[20:23], s49 offen offset:1024 lds
    ds_read_b64_tr_b16 a[162:163], v123 offset:13824
    ds_read_b64_tr_b16 a[164:165], v123 offset:14336
    v_mfma_f32_16x16x32_bf16 v[96:99], v[34:37], v[76:79], v[96:99]
    buffer_load_dwordx4 v120, s[20:23], s49 offen offset:2048 lds
    ds_read_b64_tr_b16 a[166:167], v123 offset:14848
    ds_read_b64 v[80:81], v52 offset:0
    v_mfma_f32_16x16x32_bf16 v[60:63], v[76:79], v[76:79], v[60:63]
    v_mfma_f32_16x16x32_bf16 v[104:107], a[120:123], v[34:37], v[104:107]
    s_add_u32 m0, s48, 93184
    s_nop 0
    buffer_load_dwordx4 v121, s[20:23], s49 offen offset:0 lds
    ds_read_b64 v[82:83], v52 offset:16384
    ds_read_b64 v[84:85], v52 offset:32768
    ds_read_b64 v[86:87], v52 offset:49152
    v_mfma_f32_16x16x32_bf16 v[108:111], a[124:127], v[34:37], v[108:111]
    buffer_load_dwordx4 v121, s[20:23], s49 offen offset:1024 lds
    v_mfma_f32_16x16x32_bf16 v[112:115], v[34:37], a[128:131], v[112:115]
    v_mfma_f32_16x16x32_bf16 v[104:107], a[132:135], v[34:37], v[104:107]
    buffer_load_dwordx4 v121, s[20:23], s49 offen offset:2048 lds
    v_mfma_f32_16x16x32_bf16 v[108:111], a[136:139], v[34:37], v[108:111]
    v_mfma_f32_16x16x32_bf16 v[112:115], v[34:37], a[140:143], v[112:115]
    s_waitcnt lgkmcnt(0)
    s_waitcnt vmcnt(9)
    s_barrier
    ds_read_b64_tr_b16 a[168:169], v122 offset:0
    ds_read_b64_tr_b16 a[170:171], v122 offset:512
    ds_read_b64_tr_b16 a[172:173], v122 offset:1024
    ds_read_b64_tr_b16 a[174:175], v122 offset:1536
    ds_read_b64_tr_b16 a[176:177], v122 offset:2048
    ds_read_b64_tr_b16 a[178:179], v122 offset:2560
    ds_read_b64_tr_b16 a[180:181], v122 offset:12288
    ds_read_b64_tr_b16 a[182:183], v122 offset:12800
    ds_read_b64_tr_b16 a[184:185], v122 offset:13312
    ds_read_b64_tr_b16 a[186:187], v122 offset:13824
    ds_read_b64_tr_b16 a[188:189], v122 offset:14336
    ds_read_b64_tr_b16 a[190:191], v122 offset:14848
    v_mfma_f32_16x16x32_bf16 v[104:107], a[144:147], v[34:37], v[104:107]
    v_mfma_f32_16x16x32_bf16 v[108:111], a[148:151], v[34:37], v[108:111]
    v_mfma_f32_16x16x32_bf16 v[112:115], v[34:37], a[152:155], v[112:115]
    v_mfma_f32_16x16x32_bf16 v[104:107], a[156:159], v[34:37], v[104:107]
    v_mfma_f32_16x16x32_bf16 v[108:111], a[160:163], v[34:37], v[108:111]
    v_mfma_f32_16x16x32_bf16 v[112:115], v[34:37], a[164:167], v[112:115]
    v_mov_b32 v97, 0
    v_lshl_add_u32 v45, v42, 2, 0
    v_cmp_eq_u32 vcc, v45, v41
    ds_read_b128 v[64:67], v118 offset:49152
    ds_read_b128 v[68:71], v119 offset:49152
    v_cndmask_b32 v97, v97, v60, vcc
    v_lshl_add_u32 v45, v42, 2, 1
    v_cmp_eq_u32 vcc, v45, v41
    ds_read_b128 v[72:75], v118 offset:51200
    s_waitcnt lgkmcnt(13)
    v_mfma_f32_16x16x32_bf16 v[104:107], a[168:171], v[34:37], v[104:107]
    v_cndmask_b32 v97, v97, v61, vcc
    v_lshl_add_u32 v45, v42, 2, 2
    v_cmp_eq_u32 vcc, v45, v41
    s_lshl_b32 s59, s79, 3
    v_lshlrev_b32 v0, 16, v80
    v_cndmask_b32 v97, v97, v62, vcc
    v_lshl_add_u32 v45, v42, 2, 3
    v_cmp_eq_u32 vcc, v45, v41
    s_waitcnt lgkmcnt(11)
    v_mfma_f32_16x16x32_bf16 v[108:111], a[172:175], v[34:37], v[108:111]
    v_cndmask_b32 v97, v97, v63, vcc
    v_mov_b32 v98, v97
    v_and_b32 v46, 1, v42
    v_and_b32 v1, 0xffff0000, v80
    v_permlane32_swap_b32 v98, v97
    v_add_f32 v97, v97, v98
    v_mov_b32 v98, v97
    v_lshlrev_b32 v46, 16, v46
    v_lshlrev_b32 v2, 16, v81
    v_permlane16_swap_b32 v98, v97
    v_add_f32 v97, v97, v98
    v_mul_f32 v96, 0x3b000000, v96
    v_mul_f32 v97, 0x3b000000, v97
    v_fma_f32 v97, -v96, v96, v97
    v_max_f32 v97, 0, v97
    v_cvt_pk_bf16_f32 v97, v96, v97
    v_lshlrev_b32 v96, 16, v97
    v_and_b32 v97, 0xffff0000, v97
    s_waitcnt lgkmcnt(9)
    v_mfma_f32_16x16x32_bf16 v[112:115], v[34:37], a[176:179], v[112:115]
    s_lshl_b32 s73, s69, 2
    v_add_f32 v97, 0x3727c5ac, v97
    v_and_b32 v3, 0xffff0000, v81
    s_add_u32 s73, s73, s68
    v_cvt_pk_bf16_f32 v97, v97, v97
    v_lshlrev_b32 v4, 16, v82
    s_waitcnt lgkmcnt(7)
    v_mfma_f32_16x16x32_bf16 v[104:107], a[180:183], v[34:37], v[104:107]
    s_lshl_b32 s73, s73, 11
    v_and_b32 v97, 0xffff0000, v97
    v_and_b32 v5, 0xffff0000, v82
    v_lshl_add_u32 v46, v41, 7, v46
    v_sqrt_f32 v97, v97
    v_lshlrev_b32 v6, 16, v83
    s_waitcnt lgkmcnt(5)
    v_mfma_f32_16x16x32_bf16 v[108:111], a[184:187], v[34:37], v[108:111]
    v_add_u32 v46, s73, v46
    v_and_b32 v7, 0xffff0000, v83
    s_mul_i32 s73, s69, 640
    v_xor_b32 v96, 0x80000000, v96
    v_lshlrev_b32 v8, 16, v84
    s_waitcnt lgkmcnt(3)
    v_mfma_f32_16x16x32_bf16 v[112:115], v[34:37], a[188:191], v[112:115]
    s_add_u32 s73, s73, 0x20000
    v_cvt_pk_bf16_f32 v97, v97, v97
    v_and_b32 v9, 0xffff0000, v84
    v_lshl_add_u32 v51, v41, 2, s68
    v_and_b32 v97, 0xffff0000, v97
    v_lshlrev_b32 v10, 16, v85
    s_lshl_b32 s74, s68, 8
    v_min_u32 v51, 4, v51
    v_rcp_f32 v97, v97
    v_and_b32 v11, 0xffff0000, v85
    v_add_u32 v43, s74, v24
    v_lshl_add_u32 v51, v51, 7, s73
    v_lshlrev_b32 v12, 16, v86
    v_add_u32 v44, s74, v23
    v_cmp_lt_u32 s[50:51], 31, v40
    s_lshl_b32 s76, s68, 6
    v_and_b32 v13, 0xffff0000, v86
    ds_write_b128 v43, v[104:107] offset:2048
    v_cndmask_b32 v124, v46, v51, s[50:51]
    v_add_u32 v45, s76, v23
    v_lshlrev_b32 v14, 16, v87
    ds_write_b128 v43, v[108:111] offset:2112
    s_lshr_b32 s2, s2, 3
    ds_write2_b32 v45, v97, v96 offset0:0 offset1:64
    v_and_b32 v15, 0xffff0000, v87
    ds_write_b32 v44, v112 offset:2176
    s_lshl_b32 s2, s2, 7
    s_waitcnt lgkmcnt(6)
    v_mfma_f32_16x16x32_bf16 v[40:43], a[0:3], v[64:67], 0
    s_lshl_b32 s74, s68, 8
    ds_read_b128 v[76:79], v119 offset:51200
    v_add_u32 v84, s74, v24
    v_add_u32 v88, s74, v23
    v_mfma_f32_16x16x32_bf16 v[44:47], a[4:7], v[64:67], 0
    ds_read_b128 v[80:83], v84 offset:2048
    ds_read_b128 v[84:87], v84 offset:2112
    v_mfma_f32_16x16x32_bf16 v[48:51], v[64:67], a[8:11], 0
    s_waitcnt lgkmcnt(8)
    ds_read_b32 v88, v88 offset:2176
    v_mfma_f32_16x16x32_bf16 v[40:43], a[12:15], v[68:71], v[40:43]
    ds_read_b128 v[64:67], v118 offset:53248
    v_mfma_f32_16x16x32_bf16 v[44:47], a[16:19], v[68:71], v[44:47]
    v_mfma_f32_16x16x32_bf16 v[48:51], v[68:71], a[20:23], v[48:51]
    s_waitcnt lgkmcnt(9)
    v_mfma_f32_16x16x32_bf16 v[40:43], a[24:27], v[72:75], v[40:43]
    ds_read_b128 v[68:71], v119 offset:53248
    v_mfma_f32_16x16x32_bf16 v[44:47], a[28:31], v[72:75], v[44:47]
    v_mfma_f32_16x16x32_bf16 v[48:51], v[72:75], a[32:35], v[48:51]
    s_waitcnt lgkmcnt(5)
    v_mfma_f32_16x16x32_bf16 v[40:43], a[36:39], v[76:79], v[40:43]
    ds_read_b128 v[72:75], v118 offset:55296
    v_mfma_f32_16x16x32_bf16 v[44:47], a[40:43], v[76:79], v[44:47]
    v_mfma_f32_16x16x32_bf16 v[48:51], v[76:79], a[44:47], v[48:51]
    s_waitcnt lgkmcnt(2)
    v_mfma_f32_16x16x32_bf16 v[40:43], a[48:51], v[64:67], v[40:43]
    s_add_u32 s49, s101, 1
    s_and_b32 s49, s49, 7
    s_mul_i32 s49, s49, 196608
    s_add_u32 m0, s48, 133120
    s_barrier
    ds_read_b128 v[76:79], v119 offset:55296
    v_mfma_f32_16x16x32_bf16 v[44:47], a[52:55], v[64:67], v[44:47]
    buffer_load_dwordx4 v120, s[20:23], s49 offen offset:0 lds
    ds_read2_b32 v[114:115], v23 offset0:48 offset1:112
    v_mfma_f32_16x16x32_bf16 v[48:51], v[64:67], a[56:59], v[48:51]
    s_waitcnt lgkmcnt(3)
    buffer_load_dwordx4 v120, s[20:23], s49 offen offset:1024 lds
    ds_read_b128 v[106:109], v24 offset:192
    ds_read_b128 v[110:113], v24 offset:448
    v_mfma_f32_16x16x32_bf16 v[40:43], a[60:63], v[68:71], v[40:43]
    ds_read_b128 v[64:67], v118 offset:57344
    v_mfma_f32_16x16x32_bf16 v[44:47], a[64:67], v[68:71], v[44:47]
    buffer_load_dwordx4 v120, s[20:23], s49 offen offset:2048 lds
    s_add_u32 m0, s48, 136192
    v_mfma_f32_16x16x32_bf16 v[48:51], v[68:71], a[68:71], v[48:51]
    s_waitcnt lgkmcnt(5)
    buffer_load_dwordx4 v121, s[20:23], s49 offen offset:0 lds
    v_mfma_f32_16x16x32_bf16 v[40:43], a[72:75], v[72:75], v[40:43]
    ds_read_b128 v[68:71], v119 offset:57344
    v_mfma_f32_16x16x32_bf16 v[44:47], a[76:79], v[72:75], v[44:47]
    buffer_load_dwordx4 v121, s[20:23], s49 offen offset:1024 lds
    v_mfma_f32_16x16x32_bf16 v[48:51], v[72:75], a[80:83], v[48:51]
    s_waitcnt lgkmcnt(5)
    buffer_load_dwordx4 v121, s[20:23], s49 offen offset:2048 lds
    v_mfma_f32_16x16x32_bf16 v[40:43], a[84:87], v[76:79], v[40:43]
    ds_read_b128 v[72:75], v118 offset:59392
    v_mfma_f32_16x16x32_bf16 v[44:47], a[88:91], v[76:79], v[44:47]
    v_mfma_f32_16x16x32_bf16 v[48:51], v[76:79], a[92:95], v[48:51]
    s_waitcnt lgkmcnt(2)
    v_mfma_f32_16x16x32_bf16 v[40:43], a[96:99], v[64:67], v[40:43]
    ds_read_b128 v[76:79], v119 offset:59392
    v_mfma_f32_16x16x32_bf16 v[44:47], a[100:103], v[64:67], v[44:47]
    v_mfma_f32_16x16x32_bf16 v[48:51], v[64:67], a[104:107], v[48:51]
    s_waitcnt lgkmcnt(2)
    v_mfma_f32_16x16x32_bf16 v[40:43], a[108:111], v[68:71], v[40:43]
    ds_read_b128 v[64:67], v118 offset:61440
    v_mfma_f32_16x16x32_bf16 v[44:47], a[112:115], v[68:71], v[44:47]
    v_mfma_f32_16x16x32_bf16 v[48:51], v[68:71], a[116:119], v[48:51]
    s_waitcnt lgkmcnt(2)
    v_mfma_f32_16x16x32_bf16 v[40:43], a[120:123], v[72:75], v[40:43]
    ds_read_b128 v[68:71], v119 offset:61440
    v_mfma_f32_16x16x32_bf16 v[44:47], a[124:127], v[72:75], v[44:47]
    v_mfma_f32_16x16x32_bf16 v[48:51], v[72:75], a[128:131], v[48:51]
    s_waitcnt lgkmcnt(2)
    v_mfma_f32_16x16x32_bf16 v[40:43], a[132:135], v[76:79], v[40:43]
    ds_read_b128 v[72:75], v118 offset:63488
    v_mfma_f32_16x16x32_bf16 v[44:47], a[136:139], v[76:79], v[44:47]
    v_mfma_f32_16x16x32_bf16 v[48:51], v[76:79], a[140:143], v[48:51]
    s_waitcnt lgkmcnt(2)
    v_mfma_f32_16x16x32_bf16 v[40:43], a[144:147], v[64:67], v[40:43]
    ds_read_b128 v[76:79], v119 offset:63488
    v_mfma_f32_16x16x32_bf16 v[44:47], a[148:151], v[64:67], v[44:47]
    v_mfma_f32_16x16x32_bf16 v[48:51], v[64:67], a[152:155], v[48:51]
    s_waitcnt lgkmcnt(2)
    v_mfma_f32_16x16x32_bf16 v[40:43], a[156:159], v[68:71], v[40:43]
    ds_read_b128 v[64:67], v118 offset:32768
    v_mfma_f32_16x16x32_bf16 v[44:47], a[160:163], v[68:71], v[44:47]
    v_mfma_f32_16x16x32_bf16 v[48:51], v[68:71], a[164:167], v[48:51]
    s_waitcnt lgkmcnt(2)
    v_mfma_f32_16x16x32_bf16 v[40:43], a[168:171], v[72:75], v[40:43]
    ds_read_b128 v[68:71], v119 offset:32768
    v_mfma_f32_16x16x32_bf16 v[44:47], a[172:175], v[72:75], v[44:47]
    v_mfma_f32_16x16x32_bf16 v[48:51], v[72:75], a[176:179], v[48:51]
    s_waitcnt lgkmcnt(2)
    v_mfma_f32_16x16x32_bf16 v[40:43], a[180:183], v[76:79], v[40:43]
    ds_read_b128 v[72:75], v118 offset:34816
    v_mfma_f32_16x16x32_bf16 v[44:47], a[184:187], v[76:79], v[44:47]
    v_mfma_f32_16x16x32_bf16 v[48:51], v[76:79], a[188:191], v[48:51]
    s_waitcnt lgkmcnt(2)
    v_mfma_f32_16x16x32_bf16 v[52:55], a[0:3], v[64:67], 0
    ds_read_b128 v[76:79], v119 offset:34816
    v_mfma_f32_16x16x32_bf16 v[56:59], a[4:7], v[64:67], 0
    v_mfma_f32_16x16x32_bf16 v[60:63], v[64:67], a[8:11], 0
    s_waitcnt lgkmcnt(2)
    v_mfma_f32_16x16x32_bf16 v[52:55], a[12:15], v[68:71], v[52:55]
    ds_read_b128 v[64:67], v118 offset:36864
    v_fma_f32 v44, v115, v84, v44
    v_fma_f32 v45, v115, v85, v45
    v_mfma_f32_16x16x32_bf16 v[56:59], a[16:19], v[68:71], v[56:59]
    v_fma_f32 v46, v115, v86, v46
    v_fma_f32 v47, v115, v87, v47
    v_mul_f32 v44, v114, v44
    v_mfma_f32_16x16x32_bf16 v[60:63], v[68:71], a[20:23], v[60:63]
    s_waitcnt lgkmcnt(2)
    v_mul_f32 v45, v114, v45
    v_mul_f32 v46, v114, v46
    v_mfma_f32_16x16x32_bf16 v[52:55], a[24:27], v[72:75], v[52:55]
    ds_read_b128 v[68:71], v119 offset:36864
    v_mul_f32 v47, v114, v47
    v_cvt_pk_bf16_f32 v90, v44, v45
    v_mfma_f32_16x16x32_bf16 v[56:59], a[28:31], v[72:75], v[56:59]
    v_cvt_pk_bf16_f32 v91, v46, v47
    v_fma_f32 v48, v110, v88, v48
    v_mfma_f32_16x16x32_bf16 v[60:63], v[72:75], a[32:35], v[60:63]
    s_waitcnt lgkmcnt(2)
    v_fma_f32 v49, v111, v88, v49
    v_fma_f32 v50, v112, v88, v50
    v_fma_f32 v51, v113, v88, v51
    v_mfma_f32_16x16x32_bf16 v[52:55], a[36:39], v[76:79], v[52:55]
    ds_read_b128 v[72:75], v118 offset:38912
    v_mul_f32 v48, v106, v48
    v_mfma_f32_16x16x32_bf16 v[56:59], a[40:43], v[76:79], v[56:59]
    v_mul_f32 v49, v107, v49
    v_mul_f32 v50, v108, v50
    v_mul_f32 v51, v109, v51
    v_mfma_f32_16x16x32_bf16 v[60:63], v[76:79], a[44:47], v[60:63]
    s_waitcnt lgkmcnt(2)
    v_cvt_pk_bf16_f32 v92, v48, v49
    v_cvt_pk_bf16_f32 v93, v50, v51
    v_mfma_f32_16x16x32_bf16 v[52:55], a[48:51], v[64:67], v[52:55]
    ds_read_b128 v[76:79], v119 offset:38912
    v_fma_f32 v40, v115, v80, v40
    v_fma_f32 v41, v115, v81, v41
    v_mfma_f32_16x16x32_bf16 v[56:59], a[52:55], v[64:67], v[56:59]
    s_waitcnt vmcnt(13)
    v_fma_f32 v42, v115, v82, v42
    v_and_b32 v117, 15, v29
    v_mfma_f32_16x16x32_bf16 v[60:63], v[64:67], a[56:59], v[60:63]
    s_waitcnt lgkmcnt(2)
    v_fma_f32 v43, v115, v83, v43
    v_cvt_pk_bf16_f32 v102, v40, v41
    v_cmp_ne_u32 vcc, 8, v117
    v_mfma_f32_16x16x32_bf16 v[52:55], a[60:63], v[68:71], v[52:55]
    ds_read_b128 v[64:67], v118 offset:40960
    v_cvt_pk_bf16_f32 v103, v42, v43
    v_mfma_f32_16x16x32_bf16 v[56:59], a[64:67], v[68:71], v[56:59]
    v_mul_f32 v89, 0x3eb8aa3b, v114
    s_cbranch_vccnz L_slow_6
L_back_7:
    v_readfirstlane_b32 s78, v29
    s_nop 1
    s_cmp_eq_u32 s78, s59
    s_cbranch_scc0 L_q0S
    v_mfma_f32_16x16x32_bf16 v[60:63], v[68:71], a[68:71], v[60:63]
    s_waitcnt lgkmcnt(2)
    ds_read2_b32 v[114:115], v23 offset0:32 offset1:96
    ds_read_b128 v[106:109], v24 offset:128
    ds_read_b128 v[110:113], v24 offset:384
    v_mfma_f32_16x16x32_bf16 v[52:55], a[72:75], v[72:75], v[52:55]
    ds_read_b128 v[68:71], v119 offset:40960
    v_mfma_f32_16x16x32_bf16 v[56:59], a[76:79], v[72:75], v[56:59]
    v_mfma_f32_16x16x32_bf16 v[60:63], v[72:75], a[80:83], v[60:63]
    s_waitcnt lgkmcnt(5)
    v_mfma_f32_16x16x32_bf16 v[52:55], a[84:87], v[76:79], v[52:55]
    ds_read_b128 v[72:75], v118 offset:43008
    v_mfma_f32_16x16x32_bf16 v[56:59], a[88:91], v[76:79], v[56:59]
    v_mfma_f32_16x16x32_bf16 v[60:63], v[76:79], a[92:95], v[60:63]
    s_waitcnt lgkmcnt(5)
    v_mfma_f32_16x16x32_bf16 v[52:55], a[96:99], v[64:67], v[52:55]
    ds_read_b128 v[76:79], v119 offset:43008
    v_mfma_f32_16x16x32_bf16 v[56:59], a[100:103], v[64:67], v[56:59]
    v_mfma_f32_16x16x32_bf16 v[60:63], v[64:67], a[104:107], v[60:63]
    s_waitcnt lgkmcnt(2)
    v_mfma_f32_16x16x32_bf16 v[52:55], a[108:111], v[68:71], v[52:55]
    ds_read_b128 v[64:67], v118 offset:45056
    v_mfma_f32_16x16x32_bf16 v[56:59], a[112:115], v[68:71], v[56:59]
    v_mfma_f32_16x16x32_bf16 v[60:63], v[68:71], a[116:119], v[60:63]
    s_waitcnt lgkmcnt(2)
    buffer_load_dword v29, off, s[36:39], s58 offset:1024 sc1
    v_mfma_f32_16x16x32_bf16 v[52:55], a[120:123], v[72:75], v[52:55]
    s_add_u32 s3, s19, 393216
    s_and_b32 s3, s3, 0x7ffff
    s_add_u32 m0, s81, 116224
    ds_read_b128 v[68:71], v119 offset:45056
    v_mfma_f32_16x16x32_bf16 v[56:59], a[124:127], v[72:75], v[56:59]
    buffer_load_dwordx4 v17, s[40:43], s3 offen offset:0 lds
    v_mfma_f32_16x16x32_bf16 v[60:63], v[72:75], a[128:131], v[60:63]
    s_waitcnt lgkmcnt(2)
    v_mfma_f32_16x16x32_bf16 v[52:55], a[132:135], v[76:79], v[52:55]
    s_add_u32 m0, s81, 116256
    ds_read_b128 v[72:75], v118 offset:47104
    v_mfma_f32_16x16x32_bf16 v[56:59], a[136:139], v[76:79], v[56:59]
    buffer_load_dwordx4 v17, s[40:43], s3 offen offset:1024 lds
    v_mfma_f32_16x16x32_bf16 v[60:63], v[76:79], a[140:143], v[60:63]
    s_waitcnt lgkmcnt(2)
    v_mfma_f32_16x16x32_bf16 v[52:55], a[144:147], v[64:67], v[52:55]
    s_add_u32 m0, s81, 116288
    ds_read_b128 v[76:79], v119 offset:47104
    v_mfma_f32_16x16x32_bf16 v[56:59], a[148:151], v[64:67], v[56:59]
    buffer_load_dwordx4 v17, s[40:43], s3 offen offset:2048 lds
    v_mfma_f32_16x16x32_bf16 v[60:63], v[64:67], a[152:155], v[60:63]
    s_waitcnt lgkmcnt(2)
    v_mfma_f32_16x16x32_bf16 v[52:55], a[156:159], v[68:71], v[52:55]
    s_add_u32 m0, s81, 116320
    ds_read_b128 v[64:67], v118 offset:16384
    v_mfma_f32_16x16x32_bf16 v[56:59], a[160:163], v[68:71], v[56:59]
    buffer_load_dwordx4 v17, s[40:43], s3 offen offset:3072 lds
    v_mfma_f32_16x16x32_bf16 v[60:63], v[68:71], a[164:167], v[60:63]
    s_waitcnt vmcnt(17)
    s_waitcnt lgkmcnt(2)
    v_mov_b32 v126, v125
    v_mov_b32 v127, 0
    v_mfma_f32_16x16x32_bf16 v[52:55], a[168:171], v[72:75], v[52:55]
    ds_read_b128 v[68:71], v119 offset:16384
    v_mfma_f32_16x16x32_bf16 v[56:59], a[172:175], v[72:75], v[56:59]
    buffer_load_dword v124, v124, s[36:39], s88 offen sc1
    v_mfma_f32_16x16x32_bf16 v[60:63], v[72:75], a[176:179], v[60:63]
    s_waitcnt lgkmcnt(2)
    v_lshl_add_u64 v[126:127], v[126:127], 0, s[52:53]
    v_mfma_f32_16x16x32_bf16 v[52:55], a[180:183], v[76:79], v[52:55]
    ds_read_b128 v[72:75], v118 offset:18432
    v_mfma_f32_16x16x32_bf16 v[56:59], a[184:187], v[76:79], v[56:59]
    global_load_dword v126, v[126:127], off
    v_mfma_f32_16x16x32_bf16 v[60:63], v[76:79], a[188:191], v[60:63]
    s_waitcnt lgkmcnt(2)
    v_mfma_f32_16x16x32_bf16 v[40:43], a[0:3], v[64:67], 0
    ds_read_b128 v[76:79], v119 offset:18432
    v_mfma_f32_16x16x32_bf16 v[44:47], a[4:7], v[64:67], 0
    v_mfma_f32_16x16x32_bf16 v[48:51], v[64:67], a[8:11], 0
    s_waitcnt lgkmcnt(2)
    v_fma_f32 v56, v115, v84, v56
    v_fma_f32 v57, v115, v85, v57
    v_fma_f32 v58, v115, v86, v58
    v_mfma_f32_16x16x32_bf16 v[40:43], a[12:15], v[68:71], v[40:43]
    ds_read_b128 v[64:67], v118 offset:20480
    v_fma_f32 v59, v115, v87, v59
    v_mul_f32 v56, v114, v56
    v_mfma_f32_16x16x32_bf16 v[44:47], a[16:19], v[68:71], v[44:47]
    v_mul_f32 v57, v114, v57
    v_mul_f32 v58, v114, v58
    v_mfma_f32_16x16x32_bf16 v[48:51], v[68:71], a[20:23], v[48:51]
    s_waitcnt lgkmcnt(2)
    v_mul_f32 v59, v114, v59
    v_cvt_pk_bf16_f32 v98, v56, v57
    v_cvt_pk_bf16_f32 v99, v58, v59
    v_mfma_f32_16x16x32_bf16 v[40:43], a[24:27], v[72:75], v[40:43]
    ds_read_b128 v[68:71], v119 offset:20480
    v_fma_f32 v52, v115, v80, v52
    v_mfma_f32_16x16x32_bf16 v[44:47], a[28:31], v[72:75], v[44:47]
    v_fma_f32 v53, v115, v81, v53
    v_fma_f32 v54, v115, v82, v54
    v_min_u32 v93, -2, v93
    v_mfma_f32_16x16x32_bf16 v[48:51], v[72:75], a[32:35], v[48:51]
    s_waitcnt lgkmcnt(2)
    buffer_store_dwordx4 v[90:93], v16, s[36:39], s84 offen sc1
    v_mov_b32 v117, -1
    v_mfma_f32_16x16x32_bf16 v[40:43], a[36:39], v[76:79], v[40:43]
    ds_read_b128 v[72:75], v118 offset:22528
    v_fma_f32 v55, v115, v83, v55
    v_cvt_pk_bf16_f32 v104, v52, v53
    v_mfma_f32_16x16x32_bf16 v[44:47], a[40:43], v[76:79], v[44:47]
    s_add_u32 s75, s84, 0x10000
    buffer_store_dwordx4 v[114:117], v16, s[36:39], s75 offen sc1
    s_add_u32 s84, s84, 0x8000
    v_mfma_f32_16x16x32_bf16 v[48:51], v[76:79], a[44:47], v[48:51]
    s_waitcnt lgkmcnt(2)
    v_cvt_pk_bf16_f32 v105, v54, v55
    v_mul_f32 v116, 0x3eb8aa3b, v114
    v_mfma_f32_16x16x16_bf16 v[52:55], v[90:91], v[102:103], v[30:33]
    v_mfma_f32_16x16x16_bf16 v[56:59], v[98:99], v[102:103], v[30:33]
    v_fma_f32 v60, v110, v88, v60
    v_fma_f32 v61, v111, v88, v61
    v_fma_f32 v62, v112, v88, v62
    v_mfma_f32_16x16x32_bf16 v[40:43], a[48:51], v[64:67], v[40:43]
    ds_read_b128 v[76:79], v119 offset:22528
    v_fma_f32 v63, v113, v88, v63
    v_mul_f32 v60, v106, v60
    v_mfma_f32_16x16x32_bf16 v[44:47], a[52:55], v[64:67], v[44:47]
    v_cndmask_b32 v52, v56, v52, s[60:61]
    v_cndmask_b32 v53, v57, v53, s[62:63]
    v_mfma_f32_16x16x32_bf16 v[48:51], v[64:67], a[56:59], v[48:51]
    s_waitcnt lgkmcnt(2)
    v_cndmask_b32 v54, v58, v54, s[64:65]
    v_cndmask_b32 v55, v59, v55, s[66:67]
    v_max3_f32 v56, v52, v53, v54
    v_mfma_f32_16x16x32_bf16 v[40:43], a[60:63], v[68:71], v[40:43]
    ds_read_b128 v[64:67], v118 offset:24576
    v_max_f32 v56, v56, v55
    v_mfma_f32_16x16x32_bf16 v[44:47], a[64:67], v[68:71], v[44:47]
    v_mov_b32 v57, v56
    v_mul_f32 v61, v107, v61
    v_mul_f32 v62, v108, v62
    v_mfma_f32_16x16x32_bf16 v[48:51], v[68:71], a[68:71], v[48:51]
    s_waitcnt lgkmcnt(2)
    v_permlane32_swap_b32 v57, v56
    v_mfma_f32_16x16x32_bf16 v[40:43], a[72:75], v[72:75], v[40:43]
    ds_read_b128 v[68:71], v119 offset:24576
    v_max_f32 v56, v56, v57
    v_mov_b32 v57, v56
    v_mfma_f32_16x16x32_bf16 v[44:47], a[76:79], v[72:75], v[44:47]
    v_mul_f32 v63, v109, v63
    v_permlane16_swap_b32 v57, v56
    v_mfma_f32_16x16x32_bf16 v[48:51], v[72:75], a[80:83], v[48:51]
    s_waitcnt lgkmcnt(2)
    v_max_f32 v56, v56, v57
    v_mul_f32 v56, v56, v89
    v_mfma_f32_16x16x32_bf16 v[40:43], a[84:87], v[76:79], v[40:43]
    ds_read_b128 v[72:75], v118 offset:26624
    v_fma_f32 v52, v52, v89, -v56
    v_mfma_f32_16x16x32_bf16 v[44:47], a[88:91], v[76:79], v[44:47]
    v_fma_f32 v53, v53, v89, -v56
    v_fma_f32 v54, v54, v89, -v56
    v_fma_f32 v55, v55, v89, -v56
    v_mfma_f32_16x16x32_bf16 v[48:51], v[76:79], a[92:95], v[48:51]
    s_waitcnt lgkmcnt(2)
    v_exp_f32 v52, v52
    v_mfma_f32_16x16x32_bf16 v[40:43], a[96:99], v[64:67], v[40:43]
    v_exp_f32 v53, v53
    s_waitcnt vmcnt(9)
    s_barrier
    ds_read_b128 v[76:79], v119 offset:26624
    v_mfma_f32_16x16x32_bf16 v[44:47], a[100:103], v[64:67], v[44:47]
    ds_read_b64_tr_b16 a[192:193], v122 offset:24576
    v_mfma_f32_16x16x32_bf16 v[48:51], v[64:67], a[104:107], v[48:51]
    s_waitcnt lgkmcnt(3)
    ds_read_b64_tr_b16 a[194:195], v122 offset:25088
    ds_read_b64_tr_b16 a[196:197], v122 offset:25600
    ds_read_b64_tr_b16 a[198:199], v122 offset:26112
    v_mfma_f32_16x16x32_bf16 v[40:43], a[108:111], v[68:71], v[40:43]
    ds_read_b128 v[64:67], v118 offset:28672
    ds_read_b64_tr_b16 a[200:201], v122 offset:26624
    v_mfma_f32_16x16x32_bf16 v[44:47], a[112:115], v[68:71], v[44:47]
    ds_read_b64_tr_b16 a[202:203], v122 offset:27136
    ds_read_b64_tr_b16 a[204:205], v122 offset:36864
    ds_read_b64_tr_b16 a[206:207], v122 offset:37376
    v_mfma_f32_16x16x32_bf16 v[48:51], v[68:71], a[116:119], v[48:51]
    s_waitcnt lgkmcnt(10)
    ds_read_b64_tr_b16 a[208:209], v122 offset:37888
    ds_read_b64_tr_b16 a[210:211], v122 offset:38400
    v_mfma_f32_16x16x32_bf16 v[40:43], a[120:123], v[72:75], v[40:43]
    ds_read_b128 v[68:71], v119 offset:28672
    ds_read_b64_tr_b16 a[212:213], v122 offset:38912
    ds_read_b64_tr_b16 a[214:215], v122 offset:39424
    v_mfma_f32_16x16x32_bf16 v[44:47], a[124:127], v[72:75], v[44:47]
    ds_read_b64_tr_b16 a[216:217], v123 offset:0
    ds_read_b64_tr_b16 a[218:219], v123 offset:512
    v_mfma_f32_16x16x32_bf16 v[48:51], v[72:75], a[128:131], v[48:51]
    s_waitcnt lgkmcnt(14)
    ds_read_b64_tr_b16 a[220:221], v123 offset:1024
    ds_read_b64_tr_b16 a[222:223], v123 offset:1536
    ds_read_b64_tr_b16 a[224:225], v123 offset:2048
    v_mfma_f32_16x16x32_bf16 v[40:43], a[132:135], v[76:79], v[40:43]
    s_lshl_b32 s76, s2, 7
    s_lshl_b32 s77, s68, 12
    ds_read_b128 v[72:75], v118 offset:30720
    v_mfma_f32_16x16x32_bf16 v[44:47], a[136:139], v[76:79], v[44:47]
    ds_read_b64_tr_b16 a[226:227], v123 offset:2560
    ds_read_b64_tr_b16 a[228:229], v123 offset:12288
    ds_read_b64_tr_b16 a[230:231], v123 offset:12800
    v_mfma_f32_16x16x32_bf16 v[48:51], v[76:79], a[140:143], v[48:51]
    s_add_u32 s76, s76, s77
    s_waitcnt lgkmcnt(14)
    ds_read_b64_tr_b16 a[232:233], v123 offset:13312
    ds_read_b64_tr_b16 a[234:235], v123 offset:13824
    v_lshlrev_b32 v125, 5, v22
    v_mfma_f32_16x16x32_bf16 v[40:43], a[144:147], v[64:67], v[40:43]
    s_mov_b64 s[40:41], s[24:25]
    ds_read_b128 v[76:79], v119 offset:30720
    ds_read_b64_tr_b16 a[236:237], v123 offset:14336
    v_mfma_f32_16x16x32_bf16 v[44:47], a[148:151], v[64:67], v[44:47]
    ds_read_b64_tr_b16 a[238:239], v123 offset:14848
    v_exp_f32 v54, v54
    v_exp_f32 v55, v55
    v_mfma_f32_16x16x32_bf16 v[48:51], v[64:67], a[152:155], v[48:51]
    s_mov_b64 s[40:41], s[16:17]
    s_waitcnt lgkmcnt(14)
    v_cvt_pk_bf16_f32 v58, v52, v53
    v_mfma_f32_16x16x32_bf16 v[40:43], a[156:159], v[68:71], v[40:43]
    ds_read_b128 v[64:67], v118 offset:0
    v_cvt_pk_bf16_f32 v59, v54, v55
    v_cvt_pk_bf16_f32 v94, v60, v61
    v_cvt_pk_bf16_f32 v95, v62, v63
    v_mfma_f32_16x16x32_bf16 v[44:47], a[160:163], v[68:71], v[44:47]
    ds_read2_b32 v[114:115], v23 offset0:16 offset1:80
    ds_read_b128 v[106:109], v24 offset:64
    ds_read_b128 v[110:113], v24 offset:320
    v_mfma_f32_16x16x32_bf16 v[48:51], v[68:71], a[164:167], v[48:51]
    v_and_b32 v60, v38, v58
    v_and_b32 v61, v39, v59
    v_xor_b32 v62, v60, v58
    v_xor_b32 v63, v61, v59
    s_nop 1
    v_mfma_f32_16x16x32_bf16 v[56:59], v[34:37], v[60:63], 0
    v_mfma_f32_16x16x32_bf16 v[52:55], v[92:95], v[60:63], 0
    s_nop 6
    v_rcp_f32 v56, v56
    s_nop 0
    v_mul_f32 v52, v56, v52
    v_mul_f32 v53, v56, v53
    v_mul_f32 v54, v56, v54
    v_mul_f32 v55, v56, v55
    v_cvt_pk_bf16_f32 v60, v52, v53
    v_cvt_pk_bf16_f32 v61, v54, v55
    buffer_store_dwordx2 v[60:61], v19, s[36:39], s91 offen offset:0
    s_waitcnt lgkmcnt(12)
    v_mfma_f32_16x16x32_bf16 v[40:43], a[168:171], v[72:75], v[40:43]
    ds_read_b128 v[68:71], v119 offset:0
    v_mfma_f32_16x16x32_bf16 v[44:47], a[172:175], v[72:75], v[44:47]
    v_mfma_f32_16x16x32_bf16 v[48:51], v[72:75], a[176:179], v[48:51]
    s_waitcnt lgkmcnt(7)
    v_mfma_f32_16x16x32_bf16 v[40:43], a[180:183], v[76:79], v[40:43]
    ds_read_b128 v[72:75], v118 offset:2048
    v_mfma_f32_16x16x32_bf16 v[44:47], a[184:187], v[76:79], v[44:47]
    v_mfma_f32_16x16x32_bf16 v[48:51], v[76:79], a[188:191], v[48:51]
    s_waitcnt lgkmcnt(5)
    v_mfma_f32_16x16x32_bf16 v[52:55], a[0:3], v[64:67], 0
    ds_read_b128 v[76:79], v119 offset:2048
    v_mfma_f32_16x16x32_bf16 v[56:59], a[4:7], v[64:67], 0
    v_mfma_f32_16x16x32_bf16 v[60:63], v[64:67], a[8:11], 0
    s_waitcnt lgkmcnt(2)
    v_mfma_f32_16x16x32_bf16 v[52:55], a[12:15], v[68:71], v[52:55]
    ds_read_b128 v[64:67], v118 offset:4096
    v_fma_f32 v44, v115, v84, v44
    v_fma_f32 v45, v115, v85, v45
    v_mfma_f32_16x16x32_bf16 v[56:59], a[16:19], v[68:71], v[56:59]
    v_fma_f32 v46, v115, v86, v46
    v_fma_f32 v47, v115, v87, v47
    v_mul_f32 v44, v114, v44
    v_mfma_f32_16x16x32_bf16 v[60:63], v[68:71], a[20:23], v[60:63]
    s_waitcnt lgkmcnt(2)
    v_mul_f32 v45, v114, v45
    v_mul_f32 v46, v114, v46
    v_mfma_f32_16x16x32_bf16 v[52:55], a[24:27], v[72:75], v[52:55]
    ds_read_b128 v[68:71], v119 offset:4096
    v_mul_f32 v47, v114, v47
    v_cvt_pk_bf16_f32 v100, v44, v45
    v_mfma_f32_16x16x32_bf16 v[56:59], a[28:31], v[72:75], v[56:59]
    v_cvt_pk_bf16_f32 v101, v46, v47
    v_fma_f32 v40, v115, v80, v40
    v_mfma_f32_16x16x32_bf16 v[60:63], v[72:75], a[32:35], v[60:63]
    s_waitcnt lgkmcnt(2)
    v_fma_f32 v41, v115, v81, v41
    v_fma_f32 v42, v115, v82, v42
    v_fma_f32 v43, v115, v83, v43
    v_mfma_f32_16x16x32_bf16 v[52:55], a[36:39], v[76:79], v[52:55]
    ds_read_b128 v[72:75], v118 offset:6144
    v_cvt_pk_bf16_f32 v102, v40, v41
    v_mfma_f32_16x16x32_bf16 v[56:59], a[40:43], v[76:79], v[56:59]
    v_cvt_pk_bf16_f32 v103, v42, v43
    v_mul_f32 v89, 0x3eb8aa3b, v114
    v_mfma_f32_16x16x16_bf16 v[40:43], v[98:99], v[104:105], v[30:33]
    v_mfma_f32_16x16x16_bf16 v[44:47], v[100:101], v[104:105], v[30:33]
    v_fma_f32 v48, v110, v88, v48
    v_fma_f32 v49, v111, v88, v49
    v_fma_f32 v50, v112, v88, v50
    v_mfma_f32_16x16x32_bf16 v[60:63], v[76:79], a[44:47], v[60:63]
    s_waitcnt lgkmcnt(2)
    v_fma_f32 v51, v113, v88, v51
    v_mul_f32 v48, v106, v48
    v_mul_f32 v49, v107, v49
    v_mfma_f32_16x16x32_bf16 v[52:55], a[48:51], v[64:67], v[52:55]
    s_barrier
    ds_read_b128 v[76:79], v119 offset:6144
    v_mfma_f32_16x16x32_bf16 v[56:59], a[52:55], v[64:67], v[56:59]
    v_cndmask_b32 v40, v44, v40, s[60:61]
    v_cndmask_b32 v41, v45, v41, s[62:63]
    v_cndmask_b32 v42, v46, v42, s[64:65]
    v_mfma_f32_16x16x32_bf16 v[60:63], v[64:67], a[56:59], v[60:63]
    s_waitcnt lgkmcnt(2)
    v_cndmask_b32 v43, v47, v43, s[66:67]
    v_max3_f32 v44, v40, v41, v42
    v_mfma_f32_16x16x32_bf16 v[52:55], a[60:63], v[68:71], v[52:55]
    ds_read_b128 v[64:67], v118 offset:8192
    v_max_f32 v44, v44, v43
    v_mov_b32 v45, v44
    v_mfma_f32_16x16x32_bf16 v[56:59], a[64:67], v[68:71], v[56:59]
    v_mul_f32 v50, v108, v50
    v_permlane32_swap_b32 v45, v44
    v_mfma_f32_16x16x32_bf16 v[60:63], v[68:71], a[68:71], v[60:63]
    s_waitcnt lgkmcnt(2)
    v_max_f32 v44, v44, v45
    v_mov_b32 v45, v44
    v_mfma_f32_16x16x32_bf16 v[52:55], a[72:75], v[72:75], v[52:55]
    s_add_u32 s49, s101, 2
    s_and_b32 s49, s49, 7
    s_mul_i32 s49, s49, 196608
    s_add_u32 m0, s48, 65536
    ds_read_b128 v[68:71], v119 offset:8192
    v_mfma_f32_16x16x32_bf16 v[56:59], a[76:79], v[72:75], v[56:59]
    buffer_load_dwordx4 v120, s[20:23], s49 offen offset:0 lds
    v_permlane16_swap_b32 v45, v44
    v_mfma_f32_16x16x32_bf16 v[60:63], v[72:75], a[80:83], v[60:63]
    s_waitcnt lgkmcnt(2)
    buffer_load_dwordx4 v120, s[20:23], s49 offen offset:1024 lds
    v_max_f32 v44, v44, v45
    v_mfma_f32_16x16x32_bf16 v[52:55], a[84:87], v[76:79], v[52:55]
    ds_read_b128 v[72:75], v118 offset:10240
    v_mul_f32 v44, v44, v116
    v_fma_f32 v40, v40, v116, -v44
    v_mfma_f32_16x16x32_bf16 v[56:59], a[88:91], v[76:79], v[56:59]
    buffer_load_dwordx4 v120, s[20:23], s49 offen offset:2048 lds
    v_fma_f32 v41, v41, v116, -v44
    s_add_u32 m0, s48, 68608
    v_mfma_f32_16x16x32_bf16 v[60:63], v[76:79], a[92:95], v[60:63]
    s_waitcnt lgkmcnt(2)
    buffer_load_dwordx4 v121, s[20:23], s49 offen offset:0 lds
    v_fma_f32 v42, v42, v116, -v44
    v_mfma_f32_16x16x32_bf16 v[52:55], a[96:99], v[64:67], v[52:55]
    ds_read_b128 v[76:79], v119 offset:10240
    v_fma_f32 v43, v43, v116, -v44
    v_exp_f32 v40, v40
    v_mfma_f32_16x16x32_bf16 v[56:59], a[100:103], v[64:67], v[56:59]
    buffer_load_dwordx4 v121, s[20:23], s49 offen offset:1024 lds
    v_mfma_f32_16x16x32_bf16 v[60:63], v[64:67], a[104:107], v[60:63]
    s_waitcnt lgkmcnt(2)
    buffer_load_dwordx4 v121, s[20:23], s49 offen offset:2048 lds
    v_exp_f32 v41, v41
    v_mfma_f32_16x16x32_bf16 v[52:55], a[108:111], v[68:71], v[52:55]
    s_add_u32 s49, s101, 3
    s_and_b32 s49, s49, 7
    s_mul_i32 s49, s49, 196608
    s_add_u32 m0, s48, 90112
    ds_read_b128 v[64:67], v118 offset:12288
    v_mfma_f32_16x16x32_bf16 v[56:59], a[112:115], v[68:71], v[56:59]
    buffer_load_dwordx4 v120, s[20:23], s49 offen offset:0 lds
    v_exp_f32 v42, v42
    v_mfma_f32_16x16x32_bf16 v[60:63], v[68:71], a[116:119], v[60:63]
    s_waitcnt lgkmcnt(2)
    buffer_load_dwordx4 v120, s[20:23], s49 offen offset:1024 lds
    v_exp_f32 v43, v43
    v_mfma_f32_16x16x32_bf16 v[52:55], a[120:123], v[72:75], v[52:55]
    ds_read_b128 v[68:71], v119 offset:12288
    v_mfma_f32_16x16x32_bf16 v[56:59], a[124:127], v[72:75], v[56:59]
    buffer_load_dwordx4 v120, s[20:23], s49 offen offset:2048 lds
    v_cvt_pk_bf16_f32 v46, v40, v41
    s_add_u32 m0, s48, 93184
    v_mfma_f32_16x16x32_bf16 v[60:63], v[72:75], a[128:131], v[60:63]
    s_waitcnt lgkmcnt(2)
    buffer_load_dwordx4 v121, s[20:23], s49 offen offset:0 lds
    v_cvt_pk_bf16_f32 v47, v42, v43
    v_mul_f32 v51, v109, v51
    v_mfma_f32_16x16x32_bf16 v[52:55], a[132:135], v[76:79], v[52:55]
    ds_read_b128 v[72:75], v118 offset:14336
    v_cvt_pk_bf16_f32 v96, v48, v49
    v_mfma_f32_16x16x32_bf16 v[56:59], a[136:139], v[76:79], v[56:59]
    buffer_load_dwordx4 v121, s[20:23], s49 offen offset:1024 lds
    v_cvt_pk_bf16_f32 v97, v50, v51
    v_and_b32 v48, v38, v46
    v_mfma_f32_16x16x32_bf16 v[60:63], v[76:79], a[140:143], v[60:63]
    s_waitcnt lgkmcnt(2)
    buffer_load_dwordx4 v121, s[20:23], s49 offen offset:2048 lds
    ds_read2_b32 v[114:115], v23 offset0:0 offset1:64
    v_mfma_f32_16x16x32_bf16 v[52:55], a[144:147], v[64:67], v[52:55]
    s_add_u32 s49, s101, 4
    s_and_b32 s49, s49, 7
    s_mul_i32 s49, s49, 196608
    s_add_u32 m0, s48, 133120
    ds_read_b128 v[76:79], v119 offset:14336
    v_mfma_f32_16x16x32_bf16 v[56:59], a[148:151], v[64:67], v[56:59]
    buffer_load_dwordx4 v120, s[20:23], s49 offen offset:0 lds
    ds_read_b128 v[106:109], v24 offset:0
    ds_read_b128 v[110:113], v24 offset:256
    v_mfma_f32_16x16x32_bf16 v[60:63], v[64:67], a[152:155], v[60:63]
    s_waitcnt lgkmcnt(5)
    buffer_load_dwordx4 v120, s[20:23], s49 offen offset:1024 lds
    v_and_b32 v49, v39, v47
    v_mfma_f32_16x16x32_bf16 v[52:55], a[156:159], v[68:71], v[52:55]
    v_xor_b32 v50, v48, v46
    v_xor_b32 v51, v49, v47
    v_mfma_f32_16x16x32_bf16 v[56:59], a[160:163], v[68:71], v[56:59]
    buffer_load_dwordx4 v120, s[20:23], s49 offen offset:2048 lds
    v_mfma_f32_16x16x32_bf16 v[44:47], v[34:37], v[48:51], 0
    v_mfma_f32_16x16x32_bf16 v[40:43], v[94:97], v[48:51], 0
    s_add_u32 m0, s48, 136192
    v_mfma_f32_16x16x32_bf16 v[60:63], v[68:71], a[164:167], v[60:63]
    buffer_load_dwordx4 v121, s[20:23], s49 offen offset:0 lds
    s_nop 3
    v_rcp_f32 v44, v44
    s_nop 0
    v_mul_f32 v40, v44, v40
    v_mul_f32 v41, v44, v41
    v_mul_f32 v42, v44, v42
    v_mul_f32 v43, v44, v43
    v_cvt_pk_bf16_f32 v48, v40, v41
    v_cvt_pk_bf16_f32 v49, v42, v43
    buffer_store_dwordx2 v[48:49], v19, s[36:39], s90 offen offset:0
    s_waitcnt lgkmcnt(4)
    v_mfma_f32_16x16x32_bf16 v[52:55], a[168:171], v[72:75], v[52:55]
    v_mfma_f32_16x16x32_bf16 v[56:59], a[172:175], v[72:75], v[56:59]
    buffer_load_dwordx4 v121, s[20:23], s49 offen offset:1024 lds
    v_mfma_f32_16x16x32_bf16 v[60:63], v[72:75], a[176:179], v[60:63]
    s_waitcnt lgkmcnt(2)
    buffer_load_dwordx4 v121, s[20:23], s49 offen offset:2048 lds
    v_mfma_f32_16x16x32_bf16 v[52:55], a[180:183], v[76:79], v[52:55]
    v_mfma_f32_16x16x32_bf16 v[56:59], a[184:187], v[76:79], v[56:59]
    v_mfma_f32_16x16x32_bf16 v[60:63], v[76:79], a[188:191], v[60:63]
    v_min_f32 v64, s100, v30
    s_waitcnt vmcnt(28)
    v_cmp_ne_u32 vcc, 1, v29
    v_min_f32 v65, s100, v31
    s_cbranch_vccnz L_slow_3
L_back_4:
    v_min_f32 v66, s100, v32
    v_fma_f32 v52, v115, v80, v52
    v_fma_f32 v56, v115, v84, v56
    v_fma_f32 v57, v115, v85, v57
    v_fma_f32 v58, v115, v86, v58
    v_fma_f32 v59, v115, v87, v59
    v_mul_f32 v56, v114, v56
    v_mul_f32 v57, v114, v57
    v_mul_f32 v58, v114, v58
    v_mul_f32 v59, v114, v59
    v_cvt_pk_bf16_f32 v98, v56, v57
    v_cvt_pk_bf16_f32 v99, v58, v59
    v_mfma_f32_16x16x16_bf16 v[40:43], v[100:101], v[102:103], v[30:33]
    s_waitcnt lgkmcnt(0)
    v_fma_f32 v60, v110, v88, v60
    v_mfma_f32_16x16x16_bf16 v[44:47], v[98:99], v[102:103], v[30:33]
    v_fma_f32 v61, v111, v88, v61
    v_fma_f32 v62, v112, v88, v62
    v_fma_f32 v63, v113, v88, v63
    v_fma_f32 v53, v115, v81, v53
    v_mul_f32 v60, v106, v60
    v_fma_f32 v54, v115, v82, v54
    v_mul_f32 v61, v107, v61
    v_fma_f32 v55, v115, v83, v55
    v_cndmask_b32 v40, v44, v40, s[60:61]
    v_cndmask_b32 v41, v45, v41, s[62:63]
    v_cndmask_b32 v42, v46, v42, s[64:65]
    v_cndmask_b32 v43, v47, v43, s[66:67]
    v_max3_f32 v44, v40, v41, v42
    v_max_f32 v44, v44, v43
    v_mov_b32 v45, v44
    v_mul_f32 v62, v108, v62
    v_cvt_pk_bf16_f32 v104, v52, v53
    v_permlane32_swap_b32 v45, v44
    v_max_f32 v44, v44, v45
    v_mov_b32 v45, v44
    v_mul_f32 v63, v109, v63
    v_cvt_pk_bf16_f32 v105, v54, v55
    v_permlane16_swap_b32 v45, v44
    v_max_f32 v44, v44, v45
    v_mul_f32 v44, v44, v89
    v_fma_f32 v40, v40, v89, -v44
    v_fma_f32 v41, v41, v89, -v44
    v_fma_f32 v42, v42, v89, -v44
    v_fma_f32 v43, v43, v89, -v44
    v_exp_f32 v40, v40
    v_exp_f32 v41, v41
    v_exp_f32 v42, v42
    v_exp_f32 v43, v43
    v_cvt_pk_bf16_f32 v46, v40, v41
    v_cvt_pk_bf16_f32 v47, v42, v43
    v_cvt_pk_bf16_f32 v94, v60, v61
    buffer_load_dwordx4 v[90:93], v16, s[36:39], s85 offen sc1
    v_mul_f32 v116, 0x3eb8aa3b, v114
    v_cvt_pk_bf16_f32 v95, v62, v63
    v_and_b32 v50, v38, v46
    v_and_b32 v51, v39, v47
    v_xor_b32 v48, v50, v46
    v_xor_b32 v49, v51, v47
    v_min_f32 v67, s100, v33
    s_nop 0
    v_mfma_f32_16x16x32_bf16 v[44:47], v[34:37], v[48:51], 0
    v_mfma_f32_16x16x32_bf16 v[40:43], v[94:97], v[48:51], 0
    s_nop 6
    v_rcp_f32 v44, v44
    s_nop 0
    v_mul_f32 v40, v44, v40
    v_mul_f32 v41, v44, v41
    v_mul_f32 v42, v44, v42
    v_mul_f32 v43, v44, v43
    v_cvt_pk_bf16_f32 v48, v40, v41
    v_cvt_pk_bf16_f32 v49, v42, v43
    buffer_store_dwordx2 v[48:49], v19, s[36:39], s89 offen offset:0
    v_mfma_f32_16x16x32_bf16 v[68:71], a[192:195], v[34:37], 0
    v_mfma_f32_16x16x32_bf16 v[72:75], a[196:199], v[34:37], 0
    v_mfma_f32_16x16x32_bf16 v[76:79], v[34:37], a[200:203], 0
    v_mfma_f32_16x16x32_bf16 v[68:71], a[204:207], v[34:37], v[68:71]
    v_mfma_f32_16x16x32_bf16 v[72:75], a[208:211], v[34:37], v[72:75]
    v_mfma_f32_16x16x32_bf16 v[76:79], v[34:37], a[212:215], v[76:79]
    s_waitcnt vmcnt(15)
    s_barrier
    s_waitcnt vmcnt(0)
    buffer_store_dword v25, off, s[36:39], s83 offset:0
    buffer_store_dword v25, off, s[36:39], s83 offset:896
    ds_read_b64_tr_b16 a[240:241], v122 offset:0
    ds_read_b64_tr_b16 a[242:243], v122 offset:512
    ds_read_b64_tr_b16 a[244:245], v122 offset:1024
    ds_read_b64_tr_b16 a[246:247], v122 offset:1536
    ds_read_b64_tr_b16 a[248:249], v122 offset:2048
    ds_read_b64_tr_b16 a[250:251], v122 offset:2560
    ds_read_b64_tr_b16 a[252:253], v122 offset:12288
    ds_read_b64_tr_b16 a[254:255], v122 offset:12800
    ds_read_b64_tr_b16 v[128:129], v122 offset:13312
    ds_read_b64_tr_b16 v[130:131], v122 offset:13824
    ds_read_b64_tr_b16 v[132:133], v122 offset:14336
    ds_read_b64_tr_b16 v[134:135], v122 offset:14848
    v_mfma_f32_16x16x32_bf16 v[68:71], a[216:219], v[34:37], v[68:71]
    v_mfma_f32_16x16x32_bf16 v[72:75], a[220:223], v[34:37], v[72:75]
    v_mfma_f32_16x16x32_bf16 v[76:79], v[34:37], a[224:227], v[76:79]
    v_mfma_f32_16x16x32_bf16 v[68:71], a[228:231], v[34:37], v[68:71]
    v_mfma_f32_16x16x32_bf16 v[72:75], a[232:235], v[34:37], v[72:75]
    v_mfma_f32_16x16x32_bf16 v[76:79], v[34:37], a[236:239], v[76:79]
    s_waitcnt lgkmcnt(0)
    s_barrier
    s_add_u32 s49, s101, 5
    s_and_b32 s49, s49, 7
    s_mul_i32 s49, s49, 196608
    s_add_u32 m0, s48, 65536
    s_nop 0
    buffer_load_dwordx4 v120, s[20:23], s49 offen offset:0 lds
    ds_read_b64_tr_b16 v[136:137], v122 offset:24576
    ds_read_b64_tr_b16 v[138:139], v122 offset:25088
    ds_read_b64_tr_b16 v[140:141], v122 offset:25600
    v_mfma_f32_16x16x32_bf16 v[68:71], a[240:243], v[34:37], v[68:71]
    buffer_load_dwordx4 v120, s[20:23], s49 offen offset:1024 lds
    ds_read_b64_tr_b16 v[142:143], v122 offset:26112
    ds_read_b64_tr_b16 v[144:145], v122 offset:26624
    ds_read_b64_tr_b16 v[146:147], v122 offset:27136
    v_mfma_f32_16x16x32_bf16 v[72:75], a[244:247], v[34:37], v[72:75]
    buffer_load_dwordx4 v120, s[20:23], s49 offen offset:2048 lds
    ds_read_b64_tr_b16 v[148:149], v122 offset:36864
    ds_read_b64_tr_b16 v[150:151], v122 offset:37376
    ds_read_b64_tr_b16 v[152:153], v122 offset:37888
    v_mfma_f32_16x16x32_bf16 v[76:79], v[34:37], a[248:251], v[76:79]
    s_add_u32 m0, s48, 68608
    s_nop 0
    buffer_load_dwordx4 v121, s[20:23], s49 offen offset:0 lds
    ds_read_b64_tr_b16 v[154:155], v122 offset:38400
    ds_read_b64_tr_b16 v[156:157], v122 offset:38912
    ds_read_b64_tr_b16 v[158:159], v122 offset:39424
    v_mfma_f32_16x16x32_bf16 v[68:71], a[252:255], v[34:37], v[68:71]
    buffer_load_dwordx4 v121, s[20:23], s49 offen offset:1024 lds
    v_mfma_f32_16x16x32_bf16 v[72:75], v[128:131], v[34:37], v[72:75]
    buffer_load_dwordx4 v121, s[20:23], s49 offen offset:2048 lds
    v_mfma_f32_16x16x32_bf16 v[76:79], v[34:37], v[132:135], v[76:79]
    s_waitcnt lgkmcnt(0)
    s_barrier
    ds_read_b64_tr_b16 v[160:161], v123 offset:0
    ds_read_b64_tr_b16 v[162:163], v123 offset:512
    ds_read_b64_tr_b16 v[164:165], v123 offset:1024
    ds_read_b64_tr_b16 v[166:167], v123 offset:1536
    ds_read_b64_tr_b16 v[168:169], v123 offset:2048
    ds_read_b64_tr_b16 v[170:171], v123 offset:2560
    ds_read_b64_tr_b16 v[172:173], v123 offset:12288
    ds_read_b64_tr_b16 v[174:175], v123 offset:12800
    ds_read_b64_tr_b16 v[176:177], v123 offset:13312
    ds_read_b64_tr_b16 v[178:179], v123 offset:13824
    ds_read_b64_tr_b16 v[180:181], v123 offset:14336
    ds_read_b64_tr_b16 v[182:183], v123 offset:14848
    s_add_u32 s49, s101, 6
    s_and_b32 s49, s49, 7
    s_mul_i32 s49, s49, 196608
    s_add_u32 m0, s48, 90112
    v_cmp_eq_u32 vcc, -1, v93
    v_mfma_f32_16x16x32_bf16 v[68:71], v[136:139], v[34:37], v[68:71]
    v_mfma_f32_16x16x32_bf16 v[72:75], v[140:143], v[34:37], v[72:75]
    v_mfma_f32_16x16x32_bf16 v[76:79], v[34:37], v[144:147], v[76:79]
    s_cbranch_vccnz L_slow_9
L_back_10:
    s_add_u32 s85, s85, 0x8000
    v_mfma_f32_16x16x16_bf16 v[52:55], v[98:99], v[104:105], v[30:33]
    v_mfma_f32_16x16x16_bf16 v[56:59], v[90:91], v[104:105], v[64:67]
    v_mfma_f32_16x16x32_bf16 v[68:71], v[148:151], v[34:37], v[68:71]
    v_mfma_f32_16x16x32_bf16 v[72:75], v[152:155], v[34:37], v[72:75]
    v_mfma_f32_16x16x32_bf16 v[76:79], v[34:37], v[156:159], v[76:79]
    buffer_load_dwordx4 v120, s[20:23], s49 offen offset:0 lds
    buffer_load_dwordx4 v120, s[20:23], s49 offen offset:1024 lds
    buffer_load_dwordx4 v120, s[20:23], s49 offen offset:2048 lds
    s_add_u32 m0, s48, 93184
    s_nop 0
    buffer_load_dwordx4 v121, s[20:23], s49 offen offset:0 lds
    v_cndmask_b32 v52, v56, v52, s[60:61]
    v_cndmask_b32 v53, v57, v53, s[62:63]
    v_cndmask_b32 v54, v58, v54, s[64:65]
    v_cndmask_b32 v55, v59, v55, s[66:67]
    v_max3_f32 v56, v52, v53, v54
    v_max_f32 v56, v56, v55
    v_mov_b32 v57, v56
    buffer_load_dwordx4 v121, s[20:23], s49 offen offset:1024 lds
    buffer_load_dwordx4 v121, s[20:23], s49 offen offset:2048 lds
    v_permlane32_swap_b32 v57, v56
    v_max_f32 v56, v56, v57
    v_mov_b32 v57, v56
    s_nop 1
    v_permlane16_swap_b32 v57, v56
    v_max_f32 v56, v56, v57
    v_mul_f32 v56, v56, v116
    v_fma_f32 v52, v52, v116, -v56
    v_fma_f32 v53, v53, v116, -v56
    v_fma_f32 v54, v54, v116, -v56
    v_fma_f32 v55, v55, v116, -v56
    v_exp_f32 v52, v52
    v_exp_f32 v53, v53
    v_exp_f32 v54, v54
    v_exp_f32 v55, v55
    v_cvt_pk_bf16_f32 v58, v52, v53
    v_cvt_pk_bf16_f32 v59, v54, v55
    v_and_b32 v62, v38, v58
    v_and_b32 v63, v39, v59
    v_xor_b32 v60, v62, v58
    v_xor_b32 v61, v63, v59
    s_nop 1
    v_mfma_f32_16x16x32_bf16 v[56:59], v[34:37], v[60:63], 0
    v_mfma_f32_16x16x32_bf16 v[52:55], v[92:95], v[60:63], 0
    s_nop 6
    v_rcp_f32 v56, v56
    s_nop 0
    v_mul_f32 v52, v56, v52
    v_mul_f32 v53, v56, v53
    v_mul_f32 v54, v56, v54
    v_mul_f32 v55, v56, v55
    v_cvt_pk_bf16_f32 v60, v52, v53
    v_cvt_pk_bf16_f32 v61, v54, v55
    buffer_store_dwordx2 v[60:61], v19, s[36:39], s88 offen offset:0
    s_waitcnt vmcnt(7) lgkmcnt(0)
    s_barrier
    buffer_load_dword v29, v22, s[36:39], s82 offen offset:0 sc1
    s_add_u32 s49, s101, 7
    s_and_b32 s49, s49, 7
    s_mul_i32 s49, s49, 196608
    s_add_u32 m0, s48, 133120
    s_nop 0
    buffer_load_dwordx4 v120, s[20:23], s49 offen offset:0 lds
    ds_read_b64_tr_b16 v[184:185], v122 offset:0
    ds_read_b64_tr_b16 v[186:187], v122 offset:512
    ds_read_b64_tr_b16 v[188:189], v122 offset:1024
    v_mfma_f32_16x16x32_bf16 v[68:71], v[160:163], v[34:37], v[68:71]
    buffer_load_dwordx4 v120, s[20:23], s49 offen offset:1024 lds
    ds_read_b64_tr_b16 v[190:191], v122 offset:1536
    ds_read_b64_tr_b16 v[192:193], v122 offset:2048
    ds_read_b64_tr_b16 v[194:195], v122 offset:2560
    v_mfma_f32_16x16x32_bf16 v[72:75], v[164:167], v[34:37], v[72:75]
    buffer_load_dwordx4 v120, s[20:23], s49 offen offset:2048 lds
    ds_read_b64_tr_b16 v[196:197], v122 offset:12288
    ds_read_b64_tr_b16 v[198:199], v122 offset:12800
    ds_read_b64_tr_b16 v[200:201], v122 offset:13312
    v_mfma_f32_16x16x32_bf16 v[76:79], v[34:37], v[168:171], v[76:79]
    s_add_u32 m0, s48, 136192
    s_nop 0
    buffer_load_dwordx4 v121, s[20:23], s49 offen offset:0 lds
    ds_read_b64_tr_b16 v[202:203], v122 offset:13824
    ds_read_b64_tr_b16 v[204:205], v122 offset:14336
    ds_read_b64_tr_b16 v[206:207], v122 offset:14848
    v_mfma_f32_16x16x32_bf16 v[68:71], v[172:175], v[34:37], v[68:71]
    buffer_load_dwordx4 v121, s[20:23], s49 offen offset:1024 lds
    v_mfma_f32_16x16x32_bf16 v[72:75], v[176:179], v[34:37], v[72:75]
    buffer_load_dwordx4 v121, s[20:23], s49 offen offset:2048 lds
    v_mfma_f32_16x16x32_bf16 v[76:79], v[34:37], v[180:183], v[76:79]
    s_waitcnt vmcnt(8) lgkmcnt(0)
    s_barrier
    s_waitcnt vmcnt(7)
    buffer_store_dword v25, off, s[36:39], s83 offset:256
    s_add_u32 s3, s19, 0
    s_and_b32 s3, s3, 0x7ffff
    s_add_u32 m0, s81, 65536
    s_nop 0
    buffer_load_dwordx4 v17, s[40:43], s3 offen offset:0 lds
    ds_read_b64_tr_b16 v[208:209], v122 offset:24576
    ds_read_b64_tr_b16 v[210:211], v122 offset:25088
    ds_read_b64_tr_b16 v[212:213], v122 offset:25600
    ds_read_b64_tr_b16 v[214:215], v122 offset:26112
    ds_read_b64_tr_b16 v[216:217], v122 offset:26624
    ds_read_b64_tr_b16 v[218:219], v122 offset:27136
    v_mfma_f32_16x16x32_bf16 v[68:71], v[184:187], v[34:37], v[68:71]
    s_add_u32 m0, s81, 65568
    s_nop 0
    buffer_load_dwordx4 v17, s[40:43], s3 offen offset:1024 lds
    ds_read_b64_tr_b16 v[220:221], v122 offset:36864
    ds_read_b64_tr_b16 v[222:223], v122 offset:37376
    ds_read_b64_tr_b16 v[224:225], v122 offset:37888
    ds_read_b64_tr_b16 v[226:227], v122 offset:38400
    ds_read_b64_tr_b16 v[228:229], v122 offset:38912
    ds_read_b64_tr_b16 v[230:231], v122 offset:39424
    v_mfma_f32_16x16x32_bf16 v[72:75], v[188:191], v[34:37], v[72:75]
    v_mfma_f32_16x16x32_bf16 v[76:79], v[34:37], v[192:195], v[76:79]
    s_add_u32 m0, s81, 65600
    s_nop 0
    buffer_load_dwordx4 v17, s[40:43], s3 offen offset:2048 lds
    v_mfma_f32_16x16x32_bf16 v[68:71], v[196:199], v[34:37], v[68:71]
    s_add_u32 m0, s81, 65632
    s_nop 0
    buffer_load_dwordx4 v17, s[40:43], s3 offen offset:3072 lds
    v_mfma_f32_16x16x32_bf16 v[72:75], v[200:203], v[34:37], v[72:75]
    v_mfma_f32_16x16x32_bf16 v[76:79], v[34:37], v[204:207], v[76:79]
    s_waitcnt vmcnt(5) lgkmcnt(0)
    s_barrier
    s_add_u32 s3, s19, 131072
    s_and_b32 s3, s3, 0x7ffff
    s_add_u32 m0, s81, 82432
    s_nop 0
    buffer_load_dwordx4 v17, s[40:43], s3 offen offset:0 lds
    ds_read_b64_tr_b16 v[232:233], v123 offset:0
    ds_read_b64_tr_b16 v[234:235], v123 offset:512
    s_add_u32 m0, s81, 82464
    s_nop 0
    buffer_load_dwordx4 v17, s[40:43], s3 offen offset:1024 lds
    ds_read_b64_tr_b16 v[236:237], v123 offset:1024
    ds_read_b64_tr_b16 v[238:239], v123 offset:1536
    v_mfma_f32_16x16x32_bf16 v[68:71], v[208:211], v[34:37], v[68:71]
    s_add_u32 m0, s81, 82496
    s_nop 0
    buffer_load_dwordx4 v17, s[40:43], s3 offen offset:2048 lds
    ds_read_b64_tr_b16 v[240:241], v123 offset:2048
    ds_read_b64_tr_b16 v[242:243], v123 offset:2560
    v_mfma_f32_16x16x32_bf16 v[72:75], v[212:215], v[34:37], v[72:75]
    s_add_u32 m0, s81, 82528
    s_nop 0
    buffer_load_dwordx4 v17, s[40:43], s3 offen offset:3072 lds
    ds_read_b64_tr_b16 v[244:245], v123 offset:12288
    ds_read_b64_tr_b16 v[246:247], v123 offset:12800
    v_mfma_f32_16x16x32_bf16 v[76:79], v[34:37], v[216:219], v[76:79]
    s_add_u32 s3, s19, 262144
    s_and_b32 s3, s3, 0x7ffff
    s_add_u32 m0, s81, 99328
    s_nop 0
    buffer_load_dwordx4 v17, s[40:43], s3 offen offset:0 lds
    ds_read_b64_tr_b16 v[248:249], v123 offset:13312
    ds_read_b64_tr_b16 v[250:251], v123 offset:13824
    s_add_u32 m0, s81, 99360
    s_nop 0
    buffer_load_dwordx4 v17, s[40:43], s3 offen offset:1024 lds
    ds_read_b64_tr_b16 v[252:253], v123 offset:14336
    ds_read_b64_tr_b16 v[254:255], v123 offset:14848
    v_mfma_f32_16x16x32_bf16 v[68:71], v[220:223], v[34:37], v[68:71]
    s_add_u32 m0, s81, 99392
    s_nop 0
    buffer_load_dwordx4 v17, s[40:43], s3 offen offset:2048 lds
    v_mfma_f32_16x16x32_bf16 v[72:75], v[224:227], v[34:37], v[72:75]
    s_add_u32 m0, s81, 99424
    s_nop 0
    buffer_load_dwordx4 v17, s[40:43], s3 offen offset:3072 lds
    v_mfma_f32_16x16x32_bf16 v[76:79], v[34:37], v[228:231], v[76:79]
    v_cmp_gt_u32 vcc, s72, v29
    s_cbranch_vccnz L_slow_12
L_back_13:
    s_add_u32 m0, s80, 49152
    s_nop 0
    buffer_load_dwordx4 v16, s[36:39], s95 offen offset:0 sc1 lds
    buffer_load_dwordx4 v16, s[36:39], s95 offen offset:1024 sc1 lds
    buffer_load_dwordx4 v16, s[36:39], s95 offen offset:2048 sc1 lds
    buffer_load_dwordx4 v16, s[36:39], s95 offen offset:3072 sc1 lds
    s_add_u32 m0, s80, 32768
    s_nop 0
    buffer_load_dwordx4 v16, s[36:39], s94 offen offset:0 sc1 lds
    buffer_load_dwordx4 v16, s[36:39], s94 offen offset:1024 sc1 lds
    buffer_load_dwordx4 v16, s[36:39], s94 offen offset:2048 sc1 lds
    buffer_load_dwordx4 v16, s[36:39], s94 offen offset:3072 sc1 lds
    s_mov_b64 s[40:41], s[24:25]
    buffer_load_dword v30, v125, s[40:43], s76 offen
    s_waitcnt lgkmcnt(10)
    v_mfma_f32_16x16x32_bf16 v[68:71], v[232:235], v[34:37], v[68:71]
    s_waitcnt lgkmcnt(8)
    v_mfma_f32_16x16x32_bf16 v[72:75], v[236:239], v[34:37], v[72:75]
    s_waitcnt lgkmcnt(6)
    v_mfma_f32_16x16x32_bf16 v[76:79], v[34:37], v[240:243], v[76:79]
    s_waitcnt lgkmcnt(4)
    v_mfma_f32_16x16x32_bf16 v[68:71], v[244:247], v[34:37], v[68:71]
    s_waitcnt lgkmcnt(2)
    v_mfma_f32_16x16x32_bf16 v[72:75], v[248:251], v[34:37], v[72:75]
    s_waitcnt lgkmcnt(0)
    v_mfma_f32_16x16x32_bf16 v[76:79], v[34:37], v[252:255], v[76:79]
    s_lshl_b32 s74, s68, 8
    v_add_u32 v116, s74, v24
    v_add_u32 v117, s74, v23
    s_nop 0
    ds_write_b128 v116, v[68:71] offset:3072
    s_nop 0
    ds_write_b128 v116, v[72:75] offset:3136
    s_nop 0
    ds_write_b32 v117, v76 offset:3200
    s_waitcnt vmcnt(1) lgkmcnt(0)
L_w:
    s_barrier
    ds_read_b64_tr_b16 v[40:41], v18 offset:0
    ds_read_b64_tr_b16 v[42:43], v18 offset:256
    ds_read_b128 v[104:107], v16 offset:49152
    ds_read_b64_tr_b16 v[44:45], v18 offset:4224
    ds_read_b64_tr_b16 v[46:47], v18 offset:4480
    ds_read_b128 v[108:111], v16 offset:50176
    ds_read_b64_tr_b16 v[48:49], v18 offset:8448
    ds_read_b64_tr_b16 v[50:51], v18 offset:8704
    ds_read_b128 v[112:115], v16 offset:51200
    ds_read_b64_tr_b16 v[52:53], v18 offset:12672
    ds_read_b64_tr_b16 v[54:55], v18 offset:12928
    ds_read_b128 v[116:119], v16 offset:52224
    ds_read_b128 v[120:123], v16 offset:53248
    ds_read_b128 v[124:127], v16 offset:54272
    ds_read_b64_tr_b16 v[56:57], v18 offset:16896
    ds_read_b64_tr_b16 v[58:59], v18 offset:17152
    ds_read_b128 v[32:35], v16 offset:55296
    s_waitcnt lgkmcnt(14)
    v_mfma_f32_16x16x32_bf16 v[12:15], v[40:43], v[104:107], v[12:15]
    ds_read_b64_tr_b16 v[60:61], v18 offset:21120
    ds_read_b64_tr_b16 v[62:63], v18 offset:21376
    ds_read_b128 v[104:107], v16 offset:56320
    s_waitcnt lgkmcnt(14)
    v_mfma_f32_16x16x32_bf16 v[12:15], v[44:47], v[108:111], v[12:15]
    ds_read_b64_tr_b16 v[64:65], v18 offset:25344
    ds_read_b64_tr_b16 v[66:67], v18 offset:25600
    ds_read_b128 v[108:111], v16 offset:57344
    s_waitcnt vmcnt(4)
    buffer_store_dword v25, off, s[36:39], s83 offset:256
    buffer_load_dword v29, v22, s[36:39], s82 offen offset:896 sc1
    s_waitcnt lgkmcnt(14)
    v_mfma_f32_16x16x32_bf16 v[12:15], v[48:51], v[112:115], v[12:15]
    ds_read_b64_tr_b16 v[68:69], v18 offset:29568
    ds_read_b64_tr_b16 v[70:71], v18 offset:29824
    ds_read_b128 v[112:115], v16 offset:58368
    s_waitcnt lgkmcnt(14)
    v_mfma_f32_16x16x32_bf16 v[12:15], v[52:55], v[116:119], v[12:15]
    ds_read_b64_tr_b16 v[72:73], v18 offset:33792
    ds_read_b64_tr_b16 v[74:75], v18 offset:34048
    ds_read_b128 v[116:119], v16 offset:59392
    s_waitcnt lgkmcnt(13)
    v_mfma_f32_16x16x32_bf16 v[12:15], v[56:59], v[120:123], v[12:15]
    ds_read_b64_tr_b16 v[76:77], v18 offset:38016
    ds_read_b64_tr_b16 v[78:79], v18 offset:38272
    ds_read_b128 v[120:123], v16 offset:60416
    s_waitcnt lgkmcnt(13)
    v_mfma_f32_16x16x32_bf16 v[12:15], v[60:63], v[124:127], v[12:15]
    ds_read_b64_tr_b16 v[80:81], v18 offset:42240
    ds_read_b64_tr_b16 v[82:83], v18 offset:42496
    ds_read_b128 v[124:127], v16 offset:61440
    s_waitcnt lgkmcnt(13)
    v_mfma_f32_16x16x32_bf16 v[12:15], v[64:67], v[32:35], v[12:15]
    ds_read_b64_tr_b16 v[84:85], v18 offset:46464
    ds_read_b64_tr_b16 v[86:87], v18 offset:46720
    ds_read_b128 v[32:35], v16 offset:62464
    s_waitcnt lgkmcnt(13)
    v_mfma_f32_16x16x32_bf16 v[12:15], v[68:71], v[104:107], v[12:15]
    ds_read_b64_tr_b16 v[88:89], v18 offset:50688
    ds_read_b64_tr_b16 v[90:91], v18 offset:50944
    ds_read_b128 v[104:107], v16 offset:63488
    s_waitcnt vmcnt(0)
    v_cmp_gt_u32 vcc, s72, v29
    s_add_u32 m0, s80, 16384
    s_bitcmp1_b32 s72, 0
    s_cselect_b64 s[40:41], s[24:25], s[16:17]
    s_waitcnt lgkmcnt(13)
    v_mfma_f32_16x16x32_bf16 v[12:15], v[72:75], v[108:111], v[12:15]
    ds_read_b64_tr_b16 v[92:93], v18 offset:54912
    ds_read_b64_tr_b16 v[94:95], v18 offset:55168
    ds_read_b128 v[108:111], v16 offset:64512
    s_waitcnt lgkmcnt(13)
    v_mfma_f32_16x16x32_bf16 v[12:15], v[76:79], v[112:115], v[12:15]
    ds_read_b64_tr_b16 v[96:97], v18 offset:59136
    ds_read_b64_tr_b16 v[98:99], v18 offset:59392
    s_cbranch_vccnz L_slow_21
L_back_22:
    buffer_load_dwordx4 v16, s[36:39], s93 offen offset:0 sc1 lds
    s_waitcnt lgkmcnt(12)
    v_mfma_f32_16x16x32_bf16 v[12:15], v[80:83], v[116:119], v[12:15]
    ds_read_b64_tr_b16 v[100:101], v18 offset:63360
    ds_read_b64_tr_b16 v[102:103], v18 offset:63616
    s_waitcnt lgkmcnt(11)
    v_mfma_f32_16x16x32_bf16 v[12:15], v[84:87], v[120:123], v[12:15]
    buffer_load_dwordx4 v16, s[36:39], s93 offen offset:1024 sc1 lds
    s_waitcnt lgkmcnt(8)
    v_mfma_f32_16x16x32_bf16 v[12:15], v[88:91], v[124:127], v[12:15]
    buffer_load_dword v29, v22, s[36:39], s82 offen offset:256 sc1
    s_waitcnt lgkmcnt(5)
    v_mfma_f32_16x16x32_bf16 v[12:15], v[92:95], v[32:35], v[12:15]
    buffer_load_dwordx4 v16, s[36:39], s93 offen offset:2048 sc1 lds
    s_waitcnt lgkmcnt(2)
    v_mfma_f32_16x16x32_bf16 v[12:15], v[96:99], v[104:107], v[12:15]
    s_waitcnt lgkmcnt(0)
    v_mfma_f32_16x16x32_bf16 v[12:15], v[100:103], v[108:111], v[12:15]
    s_barrier
    ds_read_b128 v[112:115], v16 offset:32768
    ds_read_b128 v[116:119], v16 offset:33792
    ds_read_b128 v[120:123], v16 offset:34816
    ds_read_b128 v[124:127], v16 offset:35840
    ds_read_b128 v[32:35], v16 offset:36864
    ds_read_b128 v[104:107], v16 offset:37888
    s_nop 0
    v_cvt_pk_bf16_f32 v36, v12, v13
    v_cvt_pk_bf16_f32 v37, v14, v15
    buffer_store_dwordx2 v[36:37], v19, s[36:39], s99 offen offset:0
    ds_read_b128 v[108:111], v16 offset:38912
    buffer_load_dwordx4 v16, s[36:39], s93 offen offset:3072 sc1 lds
    s_waitcnt lgkmcnt(6)
    v_mfma_f32_16x16x32_bf16 v[8:11], v[40:43], v[112:115], v[8:11]
    ds_read_b128 v[112:115], v16 offset:39936
    s_waitcnt lgkmcnt(6)
    v_mfma_f32_16x16x32_bf16 v[8:11], v[44:47], v[116:119], v[8:11]
    ds_read_b128 v[116:119], v16 offset:40960
    s_waitcnt lgkmcnt(6)
    v_mfma_f32_16x16x32_bf16 v[8:11], v[48:51], v[120:123], v[8:11]
    ds_read_b128 v[120:123], v16 offset:41984
    s_waitcnt lgkmcnt(6)
    v_mfma_f32_16x16x32_bf16 v[8:11], v[52:55], v[124:127], v[8:11]
    ds_read_b128 v[124:127], v16 offset:43008
    v_mul_f32 v39, v12, v12
    v_add_f32 v38, v12, v13
    v_fmac_f32 v39, v13, v13
    s_waitcnt lgkmcnt(6)
    v_mfma_f32_16x16x32_bf16 v[8:11], v[56:59], v[32:35], v[8:11]
    ds_read_b128 v[32:35], v16 offset:44032
    v_add_f32 v38, v38, v14
    s_waitcnt vmcnt(3)
    v_cmp_gt_u32 vcc, s72, v29
    s_add_u32 m0, s80, 0
    s_waitcnt lgkmcnt(6)
    v_mfma_f32_16x16x32_bf16 v[8:11], v[60:63], v[104:107], v[8:11]
    ds_read_b128 v[104:107], v16 offset:45056
    v_fmac_f32 v39, v14, v14
    v_add_f32 v38, v38, v15
    v_fmac_f32 v39, v15, v15
    s_waitcnt lgkmcnt(6)
    v_mfma_f32_16x16x32_bf16 v[8:11], v[64:67], v[108:111], v[8:11]
    ds_read_b128 v[108:111], v16 offset:46080
    v_permlane32_swap_b32 v38, v39
    s_cbranch_vccnz L_slow_15
L_back_16:
    buffer_load_dwordx4 v16, s[36:39], s92 offen offset:0 sc1 lds
    s_waitcnt lgkmcnt(6)
    v_mfma_f32_16x16x32_bf16 v[8:11], v[68:71], v[112:115], v[8:11]
    ds_read_b128 v[112:115], v16 offset:47104
    v_add_f32 v38, v38, v39
    v_mov_b32 v39, v38
    s_waitcnt lgkmcnt(6)
    v_mfma_f32_16x16x32_bf16 v[8:11], v[72:75], v[116:119], v[8:11]
    ds_read_b128 v[116:119], v16 offset:48128
    buffer_load_dwordx4 v16, s[36:39], s92 offen offset:1024 sc1 lds
    v_permlane16_swap_b32 v39, v38
    v_add_f32 v38, v38, v39
    s_waitcnt lgkmcnt(6)
    v_mfma_f32_16x16x32_bf16 v[8:11], v[76:79], v[120:123], v[8:11]
    ds_write_b32 v26, v38 offset:512
    s_waitcnt lgkmcnt(6)
    v_mfma_f32_16x16x32_bf16 v[8:11], v[80:83], v[124:127], v[8:11]
    buffer_load_dwordx4 v16, s[36:39], s92 offen offset:2048 sc1 lds
    s_waitcnt lgkmcnt(5)
    v_mfma_f32_16x16x32_bf16 v[8:11], v[84:87], v[32:35], v[8:11]
    s_waitcnt lgkmcnt(4)
    v_mfma_f32_16x16x32_bf16 v[8:11], v[88:91], v[104:107], v[8:11]
    buffer_load_dwordx4 v16, s[36:39], s92 offen offset:3072 sc1 lds
    s_waitcnt lgkmcnt(3)
    v_mfma_f32_16x16x32_bf16 v[8:11], v[92:95], v[108:111], v[8:11]
    s_waitcnt vmcnt(5)
    buffer_store_dword v25, off, s[36:39], s83 offset:384
    s_waitcnt lgkmcnt(2)
    v_mfma_f32_16x16x32_bf16 v[8:11], v[96:99], v[112:115], v[8:11]
    s_waitcnt lgkmcnt(1)
    v_mfma_f32_16x16x32_bf16 v[8:11], v[100:103], v[116:119], v[8:11]
    s_nop 7
    v_cvt_pk_bf16_f32 v36, v8, v9
    v_cvt_pk_bf16_f32 v37, v10, v11
    buffer_store_dwordx2 v[36:37], v19, s[36:39], s98 offen offset:0
    v_mul_f32 v39, v8, v8
    v_add_f32 v38, v8, v9
    v_fmac_f32 v39, v9, v9
    v_add_f32 v38, v38, v10
    v_fmac_f32 v39, v10, v10
    v_add_f32 v38, v38, v11
    v_fmac_f32 v39, v11, v11
    s_nop 1
    v_permlane32_swap_b32 v38, v39
    v_add_f32 v38, v38, v39
    v_mov_b32 v39, v38
    s_nop 1
    v_permlane16_swap_b32 v39, v38
    v_add_f32 v38, v38, v39
    ds_write_b32 v26, v38 offset:0
    s_waitcnt lgkmcnt(0)
    s_barrier
    ds_read_b128 v[36:39], v28 offset:0
    s_waitcnt lgkmcnt(0)
    v_add_f32 v36, v36, v37
    v_add_f32 v38, v38, v39
    v_add_f32 v36, v36, v38
    buffer_store_dword v36, v21, s[36:39], s87 offen offset:2048
    buffer_load_dword v29, v22, s[36:39], s82 offen offset:384 sc1
    s_waitcnt vmcnt(8)
    s_barrier
    ds_read_b128 v[120:123], v16 offset:16384
    ds_read_b128 v[124:127], v16 offset:17408
    ds_read_b128 v[32:35], v16 offset:18432
    ds_read_b128 v[104:107], v16 offset:19456
    ds_read_b128 v[108:111], v16 offset:20480
    ds_read_b128 v[112:115], v16 offset:21504
    ds_read_b128 v[116:119], v16 offset:22528
    s_waitcnt lgkmcnt(6)
    v_mfma_f32_16x16x32_bf16 v[4:7], v[40:43], v[120:123], v[4:7]
    ds_read_b128 v[120:123], v16 offset:23552
    s_waitcnt lgkmcnt(6)
    v_mfma_f32_16x16x32_bf16 v[4:7], v[44:47], v[124:127], v[4:7]
    ds_read_b128 v[124:127], v16 offset:24576
    s_waitcnt lgkmcnt(6)
    v_mfma_f32_16x16x32_bf16 v[4:7], v[48:51], v[32:35], v[4:7]
    ds_read_b128 v[32:35], v16 offset:25600
    s_waitcnt lgkmcnt(6)
    v_mfma_f32_16x16x32_bf16 v[4:7], v[52:55], v[104:107], v[4:7]
    ds_read_b128 v[104:107], v16 offset:26624
    s_waitcnt lgkmcnt(6)
    v_mfma_f32_16x16x32_bf16 v[4:7], v[56:59], v[108:111], v[4:7]
    ds_read_b128 v[108:111], v16 offset:27648
    s_waitcnt lgkmcnt(6)
    v_mfma_f32_16x16x32_bf16 v[4:7], v[60:63], v[112:115], v[4:7]
    ds_read_b128 v[112:115], v16 offset:28672
    s_waitcnt lgkmcnt(6)
    v_mfma_f32_16x16x32_bf16 v[4:7], v[64:67], v[116:119], v[4:7]
    ds_read_b128 v[116:119], v16 offset:29696
    s_waitcnt vmcnt(0)
    v_cmp_gt_u32 vcc, s72, v29
    s_add_u32 m0, s80, 49152
    buffer_store_dword v25, off, s[36:39], s83 offset:512
    s_waitcnt lgkmcnt(6)
    v_mfma_f32_16x16x32_bf16 v[4:7], v[68:71], v[120:123], v[4:7]
    ds_read_b128 v[120:123], v16 offset:30720
    s_waitcnt lgkmcnt(6)
    v_mfma_f32_16x16x32_bf16 v[4:7], v[72:75], v[124:127], v[4:7]
    ds_read_b128 v[124:127], v16 offset:31744
    s_cbranch_vccnz L_slow_18
L_back_19:
    buffer_load_dwordx4 v16, s[36:39], s7 offen offset:0 sc1 lds
    s_waitcnt lgkmcnt(6)
    v_mfma_f32_16x16x32_bf16 v[4:7], v[76:79], v[32:35], v[4:7]
    s_barrier
    ds_read_b128 v[32:35], v16 offset:0
    s_waitcnt lgkmcnt(6)
    v_mfma_f32_16x16x32_bf16 v[4:7], v[80:83], v[104:107], v[4:7]
    ds_read_b128 v[104:107], v16 offset:1024
    buffer_load_dwordx4 v16, s[36:39], s7 offen offset:1024 sc1 lds
    s_waitcnt lgkmcnt(6)
    v_mfma_f32_16x16x32_bf16 v[4:7], v[84:87], v[108:111], v[4:7]
    ds_read_b128 v[108:111], v16 offset:2048
    s_waitcnt lgkmcnt(6)
    v_mfma_f32_16x16x32_bf16 v[4:7], v[88:91], v[112:115], v[4:7]
    ds_read_b128 v[112:115], v16 offset:3072
    buffer_load_dwordx4 v16, s[36:39], s7 offen offset:2048 sc1 lds
    s_waitcnt lgkmcnt(6)
    v_mfma_f32_16x16x32_bf16 v[4:7], v[92:95], v[116:119], v[4:7]
    ds_read_b128 v[116:119], v16 offset:4096
    s_waitcnt lgkmcnt(6)
    v_mfma_f32_16x16x32_bf16 v[4:7], v[96:99], v[120:123], v[4:7]
    ds_read_b128 v[120:123], v16 offset:5120
    buffer_load_dwordx4 v16, s[36:39], s7 offen offset:3072 sc1 lds
    s_waitcnt lgkmcnt(6)
    v_mfma_f32_16x16x32_bf16 v[4:7], v[100:103], v[124:127], v[4:7]
    ds_read_b128 v[124:127], v16 offset:6144
    s_waitcnt lgkmcnt(6)
    v_mfma_f32_16x16x32_bf16 v[0:3], v[40:43], v[32:35], v[0:3]
    ds_read_b128 v[32:35], v16 offset:7168
    s_waitcnt lgkmcnt(6)
    v_mfma_f32_16x16x32_bf16 v[0:3], v[44:47], v[104:107], v[0:3]
    ds_read_b128 v[104:107], v16 offset:8192
    s_waitcnt lgkmcnt(6)
    v_mfma_f32_16x16x32_bf16 v[0:3], v[48:51], v[108:111], v[0:3]
    ds_read_b128 v[108:111], v16 offset:9216
    v_cvt_pk_bf16_f32 v36, v4, v5
    v_cvt_pk_bf16_f32 v37, v6, v7
    s_waitcnt lgkmcnt(6)
    v_mfma_f32_16x16x32_bf16 v[0:3], v[52:55], v[112:115], v[0:3]
    ds_read_b128 v[112:115], v16 offset:10240
    buffer_store_dwordx2 v[36:37], v19, s[36:39], s97 offen offset:0
    s_waitcnt lgkmcnt(6)
    v_mfma_f32_16x16x32_bf16 v[0:3], v[56:59], v[116:119], v[0:3]
    ds_read_b128 v[116:119], v16 offset:11264
    v_mul_f32 v39, v4, v4
    s_waitcnt lgkmcnt(6)
    v_mfma_f32_16x16x32_bf16 v[0:3], v[60:63], v[120:123], v[0:3]
    ds_read_b128 v[120:123], v16 offset:12288
    v_add_f32 v38, v4, v5
    s_waitcnt lgkmcnt(6)
    v_mfma_f32_16x16x32_bf16 v[0:3], v[64:67], v[124:127], v[0:3]
    ds_read_b128 v[124:127], v16 offset:13312
    v_fmac_f32 v39, v5, v5
    s_waitcnt lgkmcnt(6)
    v_mfma_f32_16x16x32_bf16 v[0:3], v[68:71], v[32:35], v[0:3]
    ds_read_b128 v[32:35], v16 offset:14336
    v_add_f32 v38, v38, v6
    s_waitcnt lgkmcnt(6)
    v_mfma_f32_16x16x32_bf16 v[0:3], v[72:75], v[104:107], v[0:3]
    ds_read_b128 v[104:107], v16 offset:15360
    v_fmac_f32 v39, v6, v6
    s_waitcnt lgkmcnt(6)
    v_mfma_f32_16x16x32_bf16 v[0:3], v[76:79], v[108:111], v[0:3]
    v_add_f32 v38, v38, v7
    v_fmac_f32 v39, v7, v7
    s_waitcnt lgkmcnt(5)
    v_mfma_f32_16x16x32_bf16 v[0:3], v[80:83], v[112:115], v[0:3]
    buffer_load_dword v29, v22, s[36:39], s82 offen offset:512 sc1
    v_permlane32_swap_b32 v38, v39
    s_waitcnt lgkmcnt(4)
    v_mfma_f32_16x16x32_bf16 v[0:3], v[84:87], v[116:119], v[0:3]
    v_add_f32 v38, v38, v39
    v_mov_b32 v39, v38
    s_waitcnt lgkmcnt(3)
    v_mfma_f32_16x16x32_bf16 v[0:3], v[88:91], v[120:123], v[0:3]
    s_waitcnt vmcnt(2)
    s_barrier
    ds_read_b128 v[64:67], v16 offset:49152
    s_waitcnt lgkmcnt(3)
    v_mfma_f32_16x16x32_bf16 v[0:3], v[92:95], v[124:127], v[0:3]
    ds_read_b128 v[68:71], v16 offset:50176
    v_permlane16_swap_b32 v39, v38
    s_waitcnt lgkmcnt(3)
    v_mfma_f32_16x16x32_bf16 v[0:3], v[96:99], v[32:35], v[0:3]
    ds_read_b128 v[72:75], v16 offset:51200
    s_waitcnt lgkmcnt(3)
    v_mfma_f32_16x16x32_bf16 v[0:3], v[100:103], v[104:107], v[0:3]
    v_add_f32 v38, v38, v39
    ds_write_b32 v26, v38 offset:1024
    s_bitcmp1_b32 s72, 0
    s_cbranch_scc1 L_qkvB
L_qkvA:
    s_waitcnt lgkmcnt(3)
    v_mfma_f32_16x16x32_bf16 v[40:43], a[0:3], v[64:67], 0
    ds_read_b128 v[76:79], v16 offset:52224
    v_mfma_f32_16x16x32_bf16 v[44:47], a[4:7], v[64:67], 0
    s_waitcnt vmcnt(1)
    buffer_store_dword v25, off, s[36:39], s83 offset:640
    v_cvt_pk_bf16_f32 v36, v0, v1
    v_cvt_pk_bf16_f32 v37, v2, v3
    v_mfma_f32_16x16x32_bf16 v[48:51], v[64:67], a[8:11], 0
    s_waitcnt lgkmcnt(3)
    buffer_store_dwordx2 v[36:37], v19, s[36:39], s96 offen offset:0
    v_mul_f32 v39, v0, v0
    v_mfma_f32_16x16x32_bf16 v[40:43], a[12:15], v[68:71], v[40:43]
    ds_read_b128 v[64:67], v16 offset:53248
    v_add_f32 v38, v0, v1
    v_fmac_f32 v39, v1, v1
    v_mfma_f32_16x16x32_bf16 v[44:47], a[16:19], v[68:71], v[44:47]
    v_add_f32 v38, v38, v2
    v_fmac_f32 v39, v2, v2
    v_mfma_f32_16x16x32_bf16 v[48:51], v[68:71], a[20:23], v[48:51]
    s_waitcnt lgkmcnt(3)
    v_add_f32 v38, v38, v3
    v_fmac_f32 v39, v3, v3
    v_mfma_f32_16x16x32_bf16 v[40:43], a[24:27], v[72:75], v[40:43]
    ds_read_b128 v[68:71], v16 offset:54272
    v_permlane32_swap_b32 v38, v39
    v_mfma_f32_16x16x32_bf16 v[44:47], a[28:31], v[72:75], v[44:47]
    s_waitcnt vmcnt(2)
    v_add_f32 v38, v38, v39
    v_mov_b32 v39, v38
    v_cmp_gt_u32 vcc, s72, v29
    v_mfma_f32_16x16x32_bf16 v[48:51], v[72:75], a[32:35], v[48:51]
    s_waitcnt lgkmcnt(2)
    v_permlane16_swap_b32 v39, v38
    v_mfma_f32_16x16x32_bf16 v[40:43], a[36:39], v[76:79], v[40:43]
    s_cbranch_vccnz L_slow_24
L_back_25:
    v_add_f32 v38, v38, v39
    ds_write_b32 v26, v38 offset:512
    ds_read_b128 v[72:75], v16 offset:55296
    v_mfma_f32_16x16x32_bf16 v[44:47], a[40:43], v[76:79], v[44:47]
    s_lshl_b32 s74, s68, 8
    buffer_load_dwordx4 v[118:121], v16, s[36:39], s86 offen offset:2048 sc1
    v_add_u32 v84, s74, v24
    v_add_u32 v88, s74, v23
    v_mfma_f32_16x16x32_bf16 v[48:51], v[76:79], a[44:47], v[48:51]
    s_waitcnt lgkmcnt(3)
    buffer_load_dwordx4 v[122:125], v16, s[36:39], s86 offen offset:3072 sc1
    ds_read_b128 v[80:83], v84 offset:2048
    v_mfma_f32_16x16x32_bf16 v[40:43], a[48:51], v[64:67], v[40:43]
    ds_read_b128 v[76:79], v16 offset:56320
    ds_read_b128 v[84:87], v84 offset:2112
    ds_read_b32 v88, v88 offset:2176
    v_mfma_f32_16x16x32_bf16 v[44:47], a[52:55], v[64:67], v[44:47]
    s_add_u32 m0, s80, 32768
    ds_read_b128 v[30:33], v28 offset:3584
    ds_read_b64 v[38:39], v28 offset:4608
    v_mfma_f32_16x16x32_bf16 v[48:51], v[64:67], a[56:59], v[48:51]
    s_waitcnt lgkmcnt(8)
    buffer_load_dwordx4 v16, s[36:39], s6 offen offset:0 sc1 lds
    v_mov_b32 v34, 0x3f803f80
    v_mov_b32 v35, 0x3f803f80
    v_mfma_f32_16x16x32_bf16 v[40:43], a[60:63], v[68:71], v[40:43]
    s_waitcnt lgkmcnt(7)
    s_barrier
    ds_read_b128 v[64:67], v16 offset:57344
    v_mfma_f32_16x16x32_bf16 v[44:47], a[64:67], v[68:71], v[44:47]
    ds_read_b128 v[106:109], v28 offset:512
    v_mov_b32 v36, 0x3f803f80
    v_mov_b32 v37, 0x3f803f80
    v_mfma_f32_16x16x32_bf16 v[48:51], v[68:71], a[68:71], v[48:51]
    s_waitcnt lgkmcnt(8)
    buffer_load_dwordx4 v16, s[36:39], s6 offen offset:1024 sc1 lds
    v_mfma_f32_16x16x32_bf16 v[40:43], a[72:75], v[72:75], v[40:43]
    ds_read_b128 v[68:71], v16 offset:58368
    v_mfma_f32_16x16x32_bf16 v[44:47], a[76:79], v[72:75], v[44:47]
    v_mfma_f32_16x16x32_bf16 v[48:51], v[72:75], a[80:83], v[48:51]
    s_waitcnt lgkmcnt(7)
    buffer_load_dwordx4 v16, s[36:39], s6 offen offset:2048 sc1 lds
    v_mfma_f32_16x16x32_bf16 v[40:43], a[84:87], v[76:79], v[40:43]
    s_waitcnt lgkmcnt(1)
    ds_read_b128 v[72:75], v16 offset:59392
    v_add_f32 v106, v106, v107
    v_add_f32 v108, v108, v109
    v_mfma_f32_16x16x32_bf16 v[44:47], a[88:91], v[76:79], v[44:47]
    v_add_f32 v106, v106, v108
    v_mfma_f32_16x16x32_bf16 v[48:51], v[76:79], a[92:95], v[48:51]
    buffer_load_dwordx4 v16, s[36:39], s6 offen offset:3072 sc1 lds
    buffer_store_dword v106, v21, s[36:39], s87 offen offset:0
    v_mfma_f32_16x16x32_bf16 v[40:43], a[96:99], v[64:67], v[40:43]
    ds_read_b128 v[76:79], v16 offset:60416
    v_mfma_f32_16x16x32_bf16 v[44:47], a[100:103], v[64:67], v[44:47]
    v_mfma_f32_16x16x32_bf16 v[48:51], v[64:67], a[104:107], v[48:51]
    s_waitcnt lgkmcnt(2)
    s_waitcnt vmcnt(5)
    v_add_f32 v118, v118, v122
    v_add_f32 v120, v120, v124
    v_mfma_f32_16x16x32_bf16 v[40:43], a[108:111], v[68:71], v[40:43]
    ds_read_b128 v[64:67], v16 offset:61440
    v_add_f32 v119, v119, v123
    v_add_f32 v121, v121, v125
    v_mfma_f32_16x16x32_bf16 v[44:47], a[112:115], v[68:71], v[44:47]
    buffer_load_dword v29, v22, s[36:39], s82 offen offset:640 sc1
    v_permlane32_swap_b32 v118, v120
    v_mfma_f32_16x16x32_bf16 v[48:51], v[68:71], a[116:119], v[48:51]
    s_waitcnt lgkmcnt(2)
    v_permlane32_swap_b32 v119, v121
    v_mfma_f32_16x16x32_bf16 v[40:43], a[120:123], v[72:75], v[40:43]
    s_add_u32 s3, s19, 0
    s_and_b32 s3, s3, 0x7ffff
    ds_read_b128 v[68:71], v16 offset:62464
    v_mfma_f32_16x16x32_bf16 v[44:47], a[124:127], v[72:75], v[44:47]
    s_add_u32 m0, s81, 65536
    v_add_f32 v118, v118, v120
    v_add_f32 v119, v119, v121
    v_mfma_f32_16x16x32_bf16 v[48:51], v[72:75], a[128:131], v[48:51]
    s_waitcnt lgkmcnt(2)
    buffer_load_dwordx4 v17, s[40:43], s3 offen offset:0 lds
    v_permlane16_swap_b32 v118, v119
    v_mfma_f32_16x16x32_bf16 v[40:43], a[132:135], v[76:79], v[40:43]
    ds_read_b128 v[72:75], v16 offset:63488
    v_add_f32 v118, v118, v119
    v_mfma_f32_16x16x32_bf16 v[44:47], a[136:139], v[76:79], v[44:47]
    v_mul_f32 v119, 0x3b000000, v118
    v_mul_f32 v118, 0x3b000000, v118
    v_mfma_f32_16x16x32_bf16 v[48:51], v[76:79], a[140:143], v[48:51]
    s_waitcnt lgkmcnt(2)
    v_permlane16_swap_b32 v118, v119
    v_fma_f32 v119, -v118, v118, v119
    v_mfma_f32_16x16x32_bf16 v[40:43], a[144:147], v[64:67], v[40:43]
    ds_read_b128 v[76:79], v16 offset:64512
    v_max_f32 v119, 0, v119
    v_cvt_pk_bf16_f32 v119, v118, v119
    v_mfma_f32_16x16x32_bf16 v[44:47], a[148:151], v[64:67], v[44:47]
    v_lshlrev_b32 v118, 16, v119
    v_and_b32 v119, 0xffff0000, v119
    v_mfma_f32_16x16x32_bf16 v[48:51], v[64:67], a[152:155], v[48:51]
    s_waitcnt lgkmcnt(2)
    v_add_f32 v119, 0x3727c5ac, v119
    v_cvt_pk_bf16_f32 v119, v119, v119
    v_and_b32 v119, 0xffff0000, v119
    v_mfma_f32_16x16x32_bf16 v[40:43], a[156:159], v[68:71], v[40:43]
    s_waitcnt vmcnt(3)
    s_barrier
    ds_read_b128 v[64:67], v16 offset:32768
    v_mfma_f32_16x16x32_bf16 v[44:47], a[160:163], v[68:71], v[44:47]
    s_waitcnt vmcnt(1)
    v_cmp_gt_u32 vcc, s72, v29
    buffer_store_dword v25, off, s[36:39], s83 offset:768
    v_add_u32 v25, 1, v25
    v_mfma_f32_16x16x32_bf16 v[48:51], v[68:71], a[164:167], v[48:51]
    s_waitcnt lgkmcnt(2)
    v_sqrt_f32 v119, v119
    v_mfma_f32_16x16x32_bf16 v[40:43], a[168:171], v[72:75], v[40:43]
    ds_read_b128 v[68:71], v16 offset:33792
    v_xor_b32 v118, 0x80000000, v118
    v_mfma_f32_16x16x32_bf16 v[44:47], a[172:175], v[72:75], v[44:47]
    s_cbranch_vccnz L_slow_27
L_back_28:
    s_add_u32 m0, s80, 16384
    v_cvt_pk_bf16_f32 v119, v119, v119
    v_and_b32 v119, 0xffff0000, v119
    v_mfma_f32_16x16x32_bf16 v[48:51], v[72:75], a[176:179], v[48:51]
    s_waitcnt lgkmcnt(2)
    buffer_load_dwordx4 v16, s[36:39], s5 offen offset:0 sc1 lds
    v_rcp_f32 v119, v119
    v_mfma_f32_16x16x32_bf16 v[40:43], a[180:183], v[76:79], v[40:43]
    ds_read_b128 v[72:75], v16 offset:34816
    ds_write2_b32 v27, v119, v118 offset0:32 offset1:96
    v_mfma_f32_16x16x32_bf16 v[44:47], a[184:187], v[76:79], v[44:47]
    ds_read2_b32 v[114:115], v23 offset0:48 offset1:112
    ds_read_b128 v[106:109], v24 offset:192
    ds_read_b128 v[110:113], v24 offset:448
    v_mfma_f32_16x16x32_bf16 v[48:51], v[76:79], a[188:191], v[48:51]
    s_waitcnt lgkmcnt(6)
    buffer_load_dwordx4 v16, s[36:39], s5 offen offset:1024 sc1 lds
    v_mfma_f32_16x16x32_bf16 v[52:55], a[0:3], v[64:67], 0
    ds_read_b128 v[76:79], v16 offset:35840
    v_mfma_f32_16x16x32_bf16 v[56:59], a[4:7], v[64:67], 0
    v_mfma_f32_16x16x32_bf16 v[60:63], v[64:67], a[8:11], 0
    s_waitcnt lgkmcnt(6)
    buffer_load_dwordx4 v16, s[36:39], s5 offen offset:2048 sc1 lds
    s_waitcnt lgkmcnt(3)
    v_fma_f32 v44, v115, v84, v44
    v_mfma_f32_16x16x32_bf16 v[52:55], a[12:15], v[68:71], v[52:55]
    ds_read_b128 v[64:67], v16 offset:36864
    v_fma_f32 v45, v115, v85, v45
    v_fma_f32 v46, v115, v86, v46
    v_mfma_f32_16x16x32_bf16 v[56:59], a[16:19], v[68:71], v[56:59]
    v_fma_f32 v47, v115, v87, v47
    v_mul_f32 v44, v114, v44
    v_mfma_f32_16x16x32_bf16 v[60:63], v[68:71], a[20:23], v[60:63]
    buffer_load_dwordx4 v16, s[36:39], s5 offen offset:3072 sc1 lds
    v_mul_f32 v45, v114, v45
    v_mul_f32 v46, v114, v46
    v_mfma_f32_16x16x32_bf16 v[52:55], a[24:27], v[72:75], v[52:55]
    ds_read_b128 v[68:71], v16 offset:37888
    v_mul_f32 v47, v114, v47
    v_mfma_f32_16x16x32_bf16 v[56:59], a[28:31], v[72:75], v[56:59]
    v_cvt_pk_bf16_f32 v90, v44, v45
    v_cvt_pk_bf16_f32 v91, v46, v47
    s_waitcnt lgkmcnt(3)
    v_fma_f32 v48, v110, v88, v48
    v_mfma_f32_16x16x32_bf16 v[60:63], v[72:75], a[32:35], v[60:63]
    s_waitcnt lgkmcnt(2)
    v_fma_f32 v49, v111, v88, v49
    v_mfma_f32_16x16x32_bf16 v[52:55], a[36:39], v[76:79], v[52:55]
    ds_read_b128 v[72:75], v16 offset:38912
    v_fma_f32 v50, v112, v88, v50
    v_fma_f32 v51, v113, v88, v51
    v_mfma_f32_16x16x32_bf16 v[56:59], a[40:43], v[76:79], v[56:59]
    s_add_u32 m0, s81, 65568
    v_mul_f32 v48, v106, v48
    v_mul_f32 v49, v107, v49
    v_mfma_f32_16x16x32_bf16 v[60:63], v[76:79], a[44:47], v[60:63]
    s_waitcnt lgkmcnt(2)
    buffer_load_dwordx4 v17, s[40:43], s3 offen offset:1024 lds
    v_mul_f32 v50, v108, v50
    v_mfma_f32_16x16x32_bf16 v[52:55], a[48:51], v[64:67], v[52:55]
    ds_read_b128 v[76:79], v16 offset:39936
    v_mul_f32 v51, v109, v51
    v_cvt_pk_bf16_f32 v92, v48, v49
    v_mfma_f32_16x16x32_bf16 v[56:59], a[52:55], v[64:67], v[56:59]
    buffer_load_dword v29, v22, s[36:39], s82 offen offset:768 sc1
    v_cvt_pk_bf16_f32 v93, v50, v51
    v_mfma_f32_16x16x32_bf16 v[60:63], v[64:67], a[56:59], v[60:63]
    s_waitcnt lgkmcnt(2)
    v_fma_f32 v40, v115, v80, v40
    v_fma_f32 v41, v115, v81, v41
    v_fma_f32 v42, v115, v82, v42
    v_mfma_f32_16x16x32_bf16 v[52:55], a[60:63], v[68:71], v[52:55]
    ds_read_b128 v[64:67], v16 offset:40960
    v_fma_f32 v43, v115, v83, v43
    v_mfma_f32_16x16x32_bf16 v[56:59], a[64:67], v[68:71], v[56:59]
    v_cvt_pk_bf16_f32 v102, v40, v41
    v_cvt_pk_bf16_f32 v103, v42, v43
    v_mul_f32 v89, 0x3eb8aa3b, v114
    v_mfma_f32_16x16x32_bf16 v[60:63], v[68:71], a[68:71], v[60:63]
    s_waitcnt lgkmcnt(2)
    ds_read2_b32 v[114:115], v23 offset0:32 offset1:96
    ds_read_b128 v[106:109], v24 offset:128
    v_mfma_f32_16x16x32_bf16 v[52:55], a[72:75], v[72:75], v[52:55]
    ds_read_b128 v[68:71], v16 offset:41984
    ds_read_b128 v[110:113], v24 offset:384
    v_mfma_f32_16x16x32_bf16 v[56:59], a[76:79], v[72:75], v[56:59]
    s_add_u32 m0, s81, 65600
    v_mfma_f32_16x16x32_bf16 v[60:63], v[72:75], a[80:83], v[60:63]
    s_waitcnt lgkmcnt(5)
    buffer_load_dwordx4 v17, s[40:43], s3 offen offset:2048 lds
    v_mfma_f32_16x16x32_bf16 v[52:55], a[84:87], v[76:79], v[52:55]
    ds_read_b128 v[72:75], v16 offset:43008
    v_mfma_f32_16x16x32_bf16 v[56:59], a[88:91], v[76:79], v[56:59]
    v_mfma_f32_16x16x32_bf16 v[60:63], v[76:79], a[92:95], v[60:63]
    s_waitcnt lgkmcnt(5)
    v_mfma_f32_16x16x32_bf16 v[52:55], a[96:99], v[64:67], v[52:55]
    ds_read_b128 v[76:79], v16 offset:44032
    v_mfma_f32_16x16x32_bf16 v[56:59], a[100:103], v[64:67], v[56:59]
    s_waitcnt vmcnt(1)
    v_cmp_gt_u32 vcc, s72, v29
    v_mfma_f32_16x16x32_bf16 v[60:63], v[64:67], a[104:107], v[60:63]
    s_waitcnt lgkmcnt(3)
    v_mfma_f32_16x16x32_bf16 v[52:55], a[108:111], v[68:71], v[52:55]
    s_cbranch_vccnz L_slow_30
L_back_31:
    s_add_u32 s72, s72, 1
    ds_read_b128 v[64:67], v16 offset:45056
    v_mfma_f32_16x16x32_bf16 v[56:59], a[112:115], v[68:71], v[56:59]
    buffer_load_dwordx4 v[118:121], v16, s[36:39], s86 offen offset:0 sc1
    v_mfma_f32_16x16x32_bf16 v[60:63], v[68:71], a[116:119], v[60:63]
    s_waitcnt lgkmcnt(2)
    buffer_load_dwordx4 v[122:125], v16, s[36:39], s86 offen offset:1024 sc1
    v_mfma_f32_16x16x32_bf16 v[52:55], a[120:123], v[72:75], v[52:55]
    ds_read_b128 v[68:71], v16 offset:46080
    v_mfma_f32_16x16x32_bf16 v[56:59], a[124:127], v[72:75], v[56:59]
    s_add_u32 m0, s80, 0
    v_mfma_f32_16x16x32_bf16 v[60:63], v[72:75], a[128:131], v[60:63]
    s_waitcnt lgkmcnt(2)
    buffer_load_dwordx4 v16, s[36:39], s4 offen offset:0 sc1 lds
    v_mfma_f32_16x16x32_bf16 v[52:55], a[132:135], v[76:79], v[52:55]
    ds_read_b128 v[72:75], v16 offset:47104
    v_mfma_f32_16x16x32_bf16 v[56:59], a[136:139], v[76:79], v[56:59]
    v_mfma_f32_16x16x32_bf16 v[60:63], v[76:79], a[140:143], v[60:63]
    s_waitcnt lgkmcnt(2)
    buffer_load_dwordx4 v16, s[36:39], s4 offen offset:1024 sc1 lds
    v_mfma_f32_16x16x32_bf16 v[52:55], a[144:147], v[64:67], v[52:55]
    ds_read_b128 v[76:79], v16 offset:48128
    v_mfma_f32_16x16x32_bf16 v[56:59], a[148:151], v[64:67], v[56:59]
    v_mfma_f32_16x16x32_bf16 v[60:63], v[64:67], a[152:155], v[60:63]
    s_waitcnt lgkmcnt(2)
    buffer_load_dwordx4 v16, s[36:39], s4 offen offset:2048 sc1 lds
    v_mfma_f32_16x16x32_bf16 v[52:55], a[156:159], v[68:71], v[52:55]
    s_barrier
    ds_read_b128 v[64:67], v16 offset:16384
    v_mfma_f32_16x16x32_bf16 v[56:59], a[160:163], v[68:71], v[56:59]
    v_mfma_f32_16x16x32_bf16 v[60:63], v[68:71], a[164:167], v[60:63]
    s_waitcnt lgkmcnt(2)
    buffer_load_dwordx4 v16, s[36:39], s4 offen offset:3072 sc1 lds
    v_mfma_f32_16x16x32_bf16 v[52:55], a[168:171], v[72:75], v[52:55]
    ds_read_b128 v[68:71], v16 offset:17408
    v_mfma_f32_16x16x32_bf16 v[56:59], a[172:175], v[72:75], v[56:59]
    v_min_u32 v93, -2, v93
    v_mfma_f32_16x16x32_bf16 v[60:63], v[72:75], a[176:179], v[60:63]
    s_waitcnt lgkmcnt(2)
    buffer_store_dwordx4 v[90:93], v16, s[36:39], s84 offen sc1
    v_mfma_f32_16x16x32_bf16 v[52:55], a[180:183], v[76:79], v[52:55]
    ds_read_b128 v[72:75], v16 offset:18432
    s_waitcnt vmcnt(5)
    v_add_f32 v118, v118, v122
    v_mfma_f32_16x16x32_bf16 v[56:59], a[184:187], v[76:79], v[56:59]
    s_add_u32 s84, s84, 0x8000
    v_add_f32 v120, v120, v124
    v_add_f32 v119, v119, v123
    v_mfma_f32_16x16x32_bf16 v[60:63], v[76:79], a[188:191], v[60:63]
    v_add_f32 v121, v121, v125
    v_permlane32_swap_b32 v118, v120
    s_waitcnt lgkmcnt(2)
    v_mfma_f32_16x16x32_bf16 v[40:43], a[0:3], v[64:67], 0
    ds_read_b128 v[76:79], v16 offset:19456
    v_permlane32_swap_b32 v119, v121
    v_mfma_f32_16x16x32_bf16 v[44:47], a[4:7], v[64:67], 0
    s_add_u32 m0, s81, 65632
    v_add_f32 v118, v118, v120
    v_add_f32 v119, v119, v121
    v_mfma_f32_16x16x32_bf16 v[48:51], v[64:67], a[8:11], 0
    s_waitcnt lgkmcnt(2)
    buffer_load_dwordx4 v17, s[40:43], s3 offen offset:3072 lds
    v_permlane16_swap_b32 v118, v119
    v_mfma_f32_16x16x32_bf16 v[40:43], a[12:15], v[68:71], v[40:43]
    ds_read_b128 v[64:67], v16 offset:20480
    v_add_f32 v118, v118, v119
    v_mfma_f32_16x16x32_bf16 v[44:47], a[16:19], v[68:71], v[44:47]
    v_mul_f32 v119, 0x3b000000, v118
    v_mul_f32 v118, 0x3b000000, v118
    v_fma_f32 v56, v115, v84, v56
    v_mfma_f32_16x16x32_bf16 v[48:51], v[68:71], a[20:23], v[48:51]
    s_waitcnt lgkmcnt(2)
    v_permlane16_swap_b32 v118, v119
    v_fma_f32 v119, -v118, v118, v119
    v_mfma_f32_16x16x32_bf16 v[40:43], a[24:27], v[72:75], v[40:43]
    s_add_u32 s3, s19, 131072
    s_and_b32 s3, s3, 0x7ffff
    ds_read_b128 v[68:71], v16 offset:21504
    v_mfma_f32_16x16x32_bf16 v[44:47], a[28:31], v[72:75], v[44:47]
    s_add_u32 m0, s81, 82432
    v_max_f32 v119, 0, v119
    v_cvt_pk_bf16_f32 v119, v118, v119
    v_lshlrev_b32 v118, 16, v119
    v_mfma_f32_16x16x32_bf16 v[48:51], v[72:75], a[32:35], v[48:51]
    s_waitcnt lgkmcnt(2)
    buffer_load_dwordx4 v17, s[40:43], s3 offen offset:0 lds
    v_and_b32 v119, 0xffff0000, v119
    v_mfma_f32_16x16x32_bf16 v[40:43], a[36:39], v[76:79], v[40:43]
    ds_read_b128 v[72:75], v16 offset:22528
    v_add_f32 v119, 0x3727c5ac, v119
    v_cvt_pk_bf16_f32 v119, v119, v119
    v_mfma_f32_16x16x32_bf16 v[44:47], a[40:43], v[76:79], v[44:47]
    v_and_b32 v119, 0xffff0000, v119
    v_sqrt_f32 v119, v119
    v_mfma_f32_16x16x32_bf16 v[48:51], v[76:79], a[44:47], v[48:51]
    s_waitcnt lgkmcnt(2)
    v_xor_b32 v118, 0x80000000, v118
    v_cvt_pk_bf16_f32 v119, v119, v119
    v_mfma_f32_16x16x32_bf16 v[40:43], a[48:51], v[64:67], v[40:43]
    ds_read_b128 v[76:79], v16 offset:23552
    v_and_b32 v119, 0xffff0000, v119
    v_rcp_f32 v119, v119
    v_mfma_f32_16x16x32_bf16 v[44:47], a[52:55], v[64:67], v[44:47]
    s_add_u32 m0, s81, 82464
    ds_write2_b32 v27, v119, v118 offset0:0 offset1:64
    v_mfma_f32_16x16x32_bf16 v[48:51], v[64:67], a[56:59], v[48:51]
    s_waitcnt lgkmcnt(3)
    buffer_load_dwordx4 v17, s[40:43], s3 offen offset:1024 lds
    v_fma_f32 v57, v115, v85, v57
    v_fma_f32 v58, v115, v86, v58
    v_mfma_f32_16x16x32_bf16 v[40:43], a[60:63], v[68:71], v[40:43]
    ds_read_b128 v[64:67], v16 offset:24576
    v_fma_f32 v59, v115, v87, v59
    v_mul_f32 v56, v114, v56
    v_mfma_f32_16x16x32_bf16 v[44:47], a[64:67], v[68:71], v[44:47]
    v_mul_f32 v57, v114, v57
    v_mul_f32 v58, v114, v58
    v_mul_f32 v59, v114, v59
    v_mfma_f32_16x16x32_bf16 v[48:51], v[68:71], a[68:71], v[48:51]
    s_waitcnt lgkmcnt(3)
    v_cvt_pk_bf16_f32 v98, v56, v57
    v_cvt_pk_bf16_f32 v99, v58, v59
    v_fma_f32 v52, v115, v80, v52
    v_mfma_f32_16x16x32_bf16 v[40:43], a[72:75], v[72:75], v[40:43]
    ds_read_b128 v[68:71], v16 offset:25600
    v_fma_f32 v53, v115, v81, v53
    v_mfma_f32_16x16x32_bf16 v[44:47], a[76:79], v[72:75], v[44:47]
    s_add_u32 m0, s81, 82496
    v_fma_f32 v54, v115, v82, v54
    v_fma_f32 v55, v115, v83, v55
    v_cvt_pk_bf16_f32 v104, v52, v53
    v_mfma_f32_16x16x32_bf16 v[48:51], v[72:75], a[80:83], v[48:51]
    s_waitcnt lgkmcnt(3)
    buffer_load_dwordx4 v17, s[40:43], s3 offen offset:2048 lds
    v_cvt_pk_bf16_f32 v105, v54, v55
    v_mfma_f32_16x16x32_bf16 v[40:43], a[84:87], v[76:79], v[40:43]
    ds_read_b128 v[72:75], v16 offset:26624
    v_mul_f32 v116, 0x3eb8aa3b, v114
    v_mfma_f32_16x16x16_bf16 v[52:55], v[90:91], v[102:103], v[30:33]
    v_mfma_f32_16x16x16_bf16 v[56:59], v[98:99], v[102:103], v[30:33]
    v_fma_f32 v60, v110, v88, v60
    v_fma_f32 v61, v111, v88, v61
    v_fma_f32 v62, v112, v88, v62
    v_mfma_f32_16x16x32_bf16 v[44:47], a[88:91], v[76:79], v[44:47]
    v_fma_f32 v63, v113, v88, v63
    v_mul_f32 v60, v106, v60
    v_mul_f32 v61, v107, v61
    v_mfma_f32_16x16x32_bf16 v[48:51], v[76:79], a[92:95], v[48:51]
    s_waitcnt lgkmcnt(2)
    v_cndmask_b32 v52, v56, v52, s[60:61]
    v_cndmask_b32 v53, v57, v53, s[62:63]
    v_cndmask_b32 v54, v58, v54, s[64:65]
    v_mfma_f32_16x16x32_bf16 v[40:43], a[96:99], v[64:67], v[40:43]
    ds_read_b128 v[76:79], v16 offset:27648
    v_cndmask_b32 v55, v59, v55, s[66:67]
    v_max3_f32 v56, v52, v53, v54
    v_mfma_f32_16x16x32_bf16 v[44:47], a[100:103], v[64:67], v[44:47]
    s_add_u32 m0, s81, 82528
    v_max_f32 v56, v56, v55
    v_mov_b32 v57, v56
    v_mfma_f32_16x16x32_bf16 v[48:51], v[64:67], a[104:107], v[48:51]
    s_waitcnt lgkmcnt(2)
    buffer_load_dwordx4 v17, s[40:43], s3 offen offset:3072 lds
    v_permlane32_swap_b32 v57, v56
    v_mfma_f32_16x16x32_bf16 v[40:43], a[108:111], v[68:71], v[40:43]
    ds_read_b128 v[64:67], v16 offset:28672
    v_max_f32 v56, v56, v57
    v_mov_b32 v57, v56
    v_mfma_f32_16x16x32_bf16 v[44:47], a[112:115], v[68:71], v[44:47]
    v_mul_f32 v62, v108, v62
    v_permlane16_swap_b32 v57, v56
    v_mfma_f32_16x16x32_bf16 v[48:51], v[68:71], a[116:119], v[48:51]
    s_waitcnt lgkmcnt(2)
    v_max_f32 v56, v56, v57
    v_mul_f32 v56, v56, v89
    v_fma_f32 v52, v52, v89, -v56
    v_mfma_f32_16x16x32_bf16 v[40:43], a[120:123], v[72:75], v[40:43]
    s_add_u32 s3, s19, 262144
    s_and_b32 s3, s3, 0x7ffff
    ds_read_b128 v[68:71], v16 offset:29696
    v_fma_f32 v53, v53, v89, -v56
    v_mfma_f32_16x16x32_bf16 v[44:47], a[124:127], v[72:75], v[44:47]
    s_add_u32 m0, s81, 99328
    v_fma_f32 v54, v54, v89, -v56
    v_fma_f32 v55, v55, v89, -v56
    v_mfma_f32_16x16x32_bf16 v[48:51], v[72:75], a[128:131], v[48:51]
    s_waitcnt lgkmcnt(2)
    buffer_load_dwordx4 v17, s[40:43], s3 offen offset:0 lds
    v_exp_f32 v52, v52
    v_mfma_f32_16x16x32_bf16 v[40:43], a[132:135], v[76:79], v[40:43]
    ds_read_b128 v[72:75], v16 offset:30720
    v_exp_f32 v53, v53
    v_mfma_f32_16x16x32_bf16 v[44:47], a[136:139], v[76:79], v[44:47]
    v_exp_f32 v54, v54
    v_mfma_f32_16x16x32_bf16 v[48:51], v[76:79], a[140:143], v[48:51]
    s_waitcnt lgkmcnt(2)
    v_exp_f32 v55, v55
    v_cvt_pk_bf16_f32 v58, v52, v53
    v_mfma_f32_16x16x32_bf16 v[40:43], a[144:147], v[64:67], v[40:43]
    ds_read_b128 v[76:79], v16 offset:31744
    v_cvt_pk_bf16_f32 v59, v54, v55
    v_mul_f32 v63, v109, v63
    v_mfma_f32_16x16x32_bf16 v[44:47], a[148:151], v[64:67], v[44:47]
    s_add_u32 m0, s81, 99360
    v_cvt_pk_bf16_f32 v94, v60, v61
    v_cvt_pk_bf16_f32 v95, v62, v63
    v_mfma_f32_16x16x32_bf16 v[48:51], v[64:67], a[152:155], v[48:51]
    s_waitcnt lgkmcnt(2)
    buffer_load_dwordx4 v17, s[40:43], s3 offen offset:1024 lds
    ds_read2_b32 v[114:115], v23 offset0:16 offset1:80
    ds_read_b128 v[106:109], v24 offset:64
    v_mfma_f32_16x16x32_bf16 v[40:43], a[156:159], v[68:71], v[40:43]
    ds_read_b128 v[110:113], v24 offset:320
    s_waitcnt vmcnt(8)
    s_barrier
    ds_read_b128 v[64:67], v16 offset:0
    v_mfma_f32_16x16x32_bf16 v[44:47], a[160:163], v[68:71], v[44:47]
    v_and_b32 v60, v38, v58
    v_and_b32 v61, v39, v59
    v_xor_b32 v62, v60, v58
    v_xor_b32 v63, v61, v59
    v_mfma_f32_16x16x32_bf16 v[48:51], v[68:71], a[164:167], v[48:51]
    s_nop 0
    v_mfma_f32_16x16x32_bf16 v[56:59], v[34:37], v[60:63], 0
    v_mfma_f32_16x16x32_bf16 v[52:55], v[92:95], v[60:63], 0
    s_nop 6
    v_rcp_f32 v56, v56
    s_nop 0
    v_mul_f32 v52, v56, v52
    v_mul_f32 v53, v56, v53
    v_mul_f32 v54, v56, v54
    v_mul_f32 v55, v56, v55
    v_cvt_pk_bf16_f32 v60, v52, v53
    v_cvt_pk_bf16_f32 v61, v54, v55
    buffer_store_dwordx2 v[60:61], v19, s[36:39], s91 offen offset:0
    s_waitcnt lgkmcnt(5)
    v_mfma_f32_16x16x32_bf16 v[40:43], a[168:171], v[72:75], v[40:43]
    ds_read_b128 v[68:71], v16 offset:1024
    v_mfma_f32_16x16x32_bf16 v[44:47], a[172:175], v[72:75], v[44:47]
    s_add_u32 m0, s81, 99392
    v_mfma_f32_16x16x32_bf16 v[48:51], v[72:75], a[176:179], v[48:51]
    s_waitcnt lgkmcnt(5)
    buffer_load_dwordx4 v17, s[40:43], s3 offen offset:2048 lds
    v_mfma_f32_16x16x32_bf16 v[40:43], a[180:183], v[76:79], v[40:43]
    ds_read_b128 v[72:75], v16 offset:2048
    v_mfma_f32_16x16x32_bf16 v[44:47], a[184:187], v[76:79], v[44:47]
    s_add_u32 m0, s81, 99424
    v_mfma_f32_16x16x32_bf16 v[48:51], v[76:79], a[188:191], v[48:51]
    buffer_load_dwordx4 v17, s[40:43], s3 offen offset:3072 lds
    s_waitcnt lgkmcnt(2)
    v_mfma_f32_16x16x32_bf16 v[56:59], a[4:7], v[64:67], 0
    ds_read_b128 v[76:79], v16 offset:3072
    v_mfma_f32_16x16x32_bf16 v[60:63], v[64:67], a[8:11], 0
    s_waitcnt lgkmcnt(2)
    v_fma_f32 v44, v115, v84, v44
    v_fma_f32 v45, v115, v85, v45
    v_fma_f32 v46, v115, v86, v46
    v_mfma_f32_16x16x32_bf16 v[56:59], a[16:19], v[68:71], v[56:59]
    ds_read_b128 v[64:67], v16 offset:4096
    v_fma_f32 v47, v115, v87, v47
    v_mul_f32 v44, v114, v44
    v_mfma_f32_16x16x32_bf16 v[60:63], v[68:71], a[20:23], v[60:63]
    s_add_u32 s3, s19, 393216
    s_and_b32 s3, s3, 0x7ffff
    s_waitcnt lgkmcnt(2)
    v_mul_f32 v45, v114, v45
    v_mul_f32 v46, v114, v46
    v_mfma_f32_16x16x32_bf16 v[56:59], a[28:31], v[72:75], v[56:59]
    s_add_u32 m0, s81, 116224
    ds_read_b128 v[68:71], v16 offset:5120
    v_mul_f32 v47, v114, v47
    v_cvt_pk_bf16_f32 v100, v44, v45
    v_mfma_f32_16x16x32_bf16 v[60:63], v[72:75], a[32:35], v[60:63]
    s_waitcnt lgkmcnt(2)
    buffer_load_dwordx4 v17, s[40:43], s3 offen offset:0 lds
    v_cvt_pk_bf16_f32 v101, v46, v47
    v_mfma_f32_16x16x32_bf16 v[56:59], a[40:43], v[76:79], v[56:59]
    ds_read_b128 v[72:75], v16 offset:6144
    v_fma_f32 v40, v115, v80, v40
    v_fma_f32 v41, v115, v81, v41
    v_mfma_f32_16x16x32_bf16 v[60:63], v[76:79], a[44:47], v[60:63]
    s_waitcnt lgkmcnt(2)
    v_fma_f32 v42, v115, v82, v42
    v_fma_f32 v43, v115, v83, v43
    v_cvt_pk_bf16_f32 v102, v40, v41
    v_mfma_f32_16x16x32_bf16 v[56:59], a[52:55], v[64:67], v[56:59]
    ds_read_b128 v[76:79], v16 offset:7168
    v_cvt_pk_bf16_f32 v103, v42, v43
    v_mul_f32 v89, 0x3eb8aa3b, v114
    v_mfma_f32_16x16x32_bf16 v[60:63], v[64:67], a[56:59], v[60:63]
    s_waitcnt lgkmcnt(2)
    v_mfma_f32_16x16x16_bf16 v[40:43], v[98:99], v[104:105], v[30:33]
    v_mfma_f32_16x16x16_bf16 v[44:47], v[100:101], v[104:105], v[30:33]
    v_fma_f32 v48, v110, v88, v48
    v_fma_f32 v49, v111, v88, v49
    v_fma_f32 v50, v112, v88, v50
    v_mfma_f32_16x16x32_bf16 v[56:59], a[64:67], v[68:71], v[56:59]
    s_waitcnt vmcnt(3)
    buffer_store_dword v25, off, s[36:39], s83 offset:0
    ds_read_b128 v[64:67], v16 offset:8192
    v_fma_f32 v51, v113, v88, v51
    v_mfma_f32_16x16x32_bf16 v[60:63], v[68:71], a[68:71], v[60:63]
    s_waitcnt lgkmcnt(2)
    buffer_load_dwordx4 v[90:93], v16, s[36:39], s85 offen sc1
    v_cndmask_b32 v40, v44, v40, s[60:61]
    v_cndmask_b32 v41, v45, v41, s[62:63]
    v_mfma_f32_16x16x32_bf16 v[56:59], a[76:79], v[72:75], v[56:59]
    ds_read_b128 v[68:71], v16 offset:9216
    v_cndmask_b32 v42, v46, v42, s[64:65]
    v_cndmask_b32 v43, v47, v43, s[66:67]
    v_mfma_f32_16x16x32_bf16 v[60:63], v[72:75], a[80:83], v[60:63]
    s_waitcnt lgkmcnt(2)
    v_max3_f32 v44, v40, v41, v42
    v_max_f32 v44, v44, v43
    v_mov_b32 v45, v44
    v_mfma_f32_16x16x32_bf16 v[56:59], a[88:91], v[76:79], v[56:59]
    s_add_u32 m0, s81, 116256
    ds_read_b128 v[72:75], v16 offset:10240
    v_permlane32_swap_b32 v45, v44
    v_mfma_f32_16x16x32_bf16 v[60:63], v[76:79], a[92:95], v[60:63]
    s_waitcnt lgkmcnt(2)
    buffer_load_dwordx4 v17, s[40:43], s3 offen offset:1024 lds
    v_max_f32 v44, v44, v45
    v_mfma_f32_16x16x32_bf16 v[56:59], a[100:103], v[64:67], v[56:59]
    ds_read_b128 v[76:79], v16 offset:11264
    v_mov_b32 v45, v44
    v_mul_f32 v48, v106, v48
    v_mfma_f32_16x16x32_bf16 v[60:63], v[64:67], a[104:107], v[60:63]
    s_waitcnt lgkmcnt(2)
    v_permlane16_swap_b32 v45, v44
    v_max_f32 v44, v44, v45
    v_mfma_f32_16x16x32_bf16 v[56:59], a[112:115], v[68:71], v[56:59]
    ds_read_b128 v[64:67], v16 offset:12288
    v_mul_f32 v44, v44, v116
    v_fma_f32 v40, v40, v116, -v44
    v_mfma_f32_16x16x32_bf16 v[60:63], v[68:71], a[116:119], v[60:63]
    s_waitcnt lgkmcnt(2)
    v_fma_f32 v41, v41, v116, -v44
    v_fma_f32 v42, v42, v116, -v44
    v_fma_f32 v43, v43, v116, -v44
    v_mfma_f32_16x16x32_bf16 v[56:59], a[124:127], v[72:75], v[56:59]
    s_add_u32 m0, s81, 116288
    ds_read_b128 v[68:71], v16 offset:13312
    v_exp_f32 v40, v40
    v_mfma_f32_16x16x32_bf16 v[60:63], v[72:75], a[128:131], v[60:63]
    s_waitcnt lgkmcnt(2)
    buffer_load_dwordx4 v17, s[40:43], s3 offen offset:2048 lds
    v_exp_f32 v41, v41
    v_mfma_f32_16x16x32_bf16 v[56:59], a[136:139], v[76:79], v[56:59]
    ds_read_b128 v[72:75], v16 offset:14336
    v_exp_f32 v42, v42
    v_mfma_f32_16x16x32_bf16 v[60:63], v[76:79], a[140:143], v[60:63]
    s_waitcnt lgkmcnt(2)
    v_exp_f32 v43, v43
    v_mfma_f32_16x16x32_bf16 v[56:59], a[148:151], v[64:67], v[56:59]
    ds_read_b128 v[76:79], v16 offset:15360
    v_cvt_pk_bf16_f32 v46, v40, v41
    v_cvt_pk_bf16_f32 v47, v42, v43
    v_mfma_f32_16x16x32_bf16 v[60:63], v[64:67], a[152:155], v[60:63]
    s_waitcnt lgkmcnt(2)
    v_mul_f32 v49, v107, v49
    v_mul_f32 v50, v108, v50
    v_mul_f32 v51, v109, v51
    v_mfma_f32_16x16x32_bf16 v[56:59], a[160:163], v[68:71], v[56:59]
    s_add_u32 m0, s81, 116320
    ds_read_b128 v[64:67], v16 offset:0
    v_cvt_pk_bf16_f32 v96, v48, v49
    v_mfma_f32_16x16x32_bf16 v[60:63], v[68:71], a[164:167], v[60:63]
    s_waitcnt lgkmcnt(2)
    buffer_load_dwordx4 v17, s[40:43], s3 offen offset:3072 lds
    v_cvt_pk_bf16_f32 v97, v50, v51
    v_and_b32 v48, v38, v46
    v_mfma_f32_16x16x32_bf16 v[56:59], a[172:175], v[72:75], v[56:59]
    ds_read_b128 v[68:71], v16 offset:1024
    ds_read2_b32 v[114:115], v23 offset0:0 offset1:64
    ds_read_b128 v[106:109], v24 offset:0
    v_mfma_f32_16x16x32_bf16 v[60:63], v[72:75], a[176:179], v[60:63]
    s_waitcnt lgkmcnt(4)
    ds_read_b128 v[110:113], v24 offset:256
    v_and_b32 v49, v39, v47
    v_xor_b32 v50, v48, v46
    v_mfma_f32_16x16x32_bf16 v[56:59], a[184:187], v[76:79], v[56:59]
    ds_read_b128 v[72:75], v16 offset:2048
    v_xor_b32 v51, v49, v47
    v_mfma_f32_16x16x32_bf16 v[60:63], v[76:79], a[188:191], v[60:63]
    s_waitcnt lgkmcnt(5)
    ds_read_b128 v[76:79], v16 offset:3072
    v_mfma_f32_16x16x32_bf16 v[44:47], v[34:37], v[48:51], 0
    v_mfma_f32_16x16x32_bf16 v[40:43], v[94:97], v[48:51], 0
    v_min_f32 v118, s100, v30
    v_min_f32 v119, s100, v31
    v_min_f32 v120, s100, v32
    v_min_f32 v121, s100, v33
    v_mfma_f32_16x16x32_bf16 v[52:55], a[0:3], v[64:67], 0
    ds_read_b128 v[64:67], v16 offset:4096
    s_nop 0
    v_rcp_f32 v44, v44
    s_nop 0
    v_mul_f32 v40, v44, v40
    v_mul_f32 v41, v44, v41
    v_mul_f32 v42, v44, v42
    v_mul_f32 v43, v44, v43
    v_cvt_pk_bf16_f32 v48, v40, v41
    v_cvt_pk_bf16_f32 v49, v42, v43
    buffer_store_dwordx2 v[48:49], v19, s[36:39], s90 offen offset:0
    s_waitcnt lgkmcnt(6)
    v_mfma_f32_16x16x32_bf16 v[52:55], a[12:15], v[68:71], v[52:55]
    s_waitcnt lgkmcnt(2)
    buffer_load_dword v29, v22, s[36:39], s82 offen offset:0 sc1
    ds_read_b128 v[68:71], v16 offset:5120
    v_fma_f32 v56, v115, v84, v56
    v_fma_f32 v57, v115, v85, v57
    v_mfma_f32_16x16x32_bf16 v[52:55], a[24:27], v[72:75], v[52:55]
    s_waitcnt lgkmcnt(2)
    ds_read_b128 v[72:75], v16 offset:6144
    v_fma_f32 v58, v115, v86, v58
    v_fma_f32 v59, v115, v87, v59
    v_mul_f32 v56, v114, v56
    v_mfma_f32_16x16x32_bf16 v[52:55], a[36:39], v[76:79], v[52:55]
    s_waitcnt lgkmcnt(2)
    ds_read_b128 v[76:79], v16 offset:7168
    v_mul_f32 v57, v114, v57
    v_mul_f32 v58, v114, v58
    v_mul_f32 v59, v114, v59
    v_mfma_f32_16x16x32_bf16 v[52:55], a[48:51], v[64:67], v[52:55]
    s_waitcnt lgkmcnt(2)
    ds_read_b128 v[64:67], v16 offset:8192
    v_cvt_pk_bf16_f32 v98, v56, v57
    v_cvt_pk_bf16_f32 v99, v58, v59
    v_mfma_f32_16x16x16_bf16 v[40:43], v[100:101], v[102:103], v[30:33]
    v_fma_f32 v60, v110, v88, v60
    v_mfma_f32_16x16x16_bf16 v[44:47], v[98:99], v[102:103], v[30:33]
    v_fma_f32 v61, v111, v88, v61
    v_fma_f32 v62, v112, v88, v62
    v_fma_f32 v63, v113, v88, v63
    v_mul_f32 v60, v106, v60
    v_mfma_f32_16x16x32_bf16 v[52:55], a[60:63], v[68:71], v[52:55]
    s_waitcnt lgkmcnt(2)
    ds_read_b128 v[68:71], v16 offset:9216
    v_mul_f32 v61, v107, v61
    v_cndmask_b32 v40, v44, v40, s[60:61]
    v_cndmask_b32 v41, v45, v41, s[62:63]
    v_cndmask_b32 v42, v46, v42, s[64:65]
    v_mfma_f32_16x16x32_bf16 v[52:55], a[72:75], v[72:75], v[52:55]
    s_waitcnt lgkmcnt(2)
    ds_read_b128 v[72:75], v16 offset:10240
    v_cndmask_b32 v43, v47, v43, s[66:67]
    v_max3_f32 v44, v40, v41, v42
    v_max_f32 v44, v44, v43
    v_mfma_f32_16x16x32_bf16 v[52:55], a[84:87], v[76:79], v[52:55]
    s_waitcnt lgkmcnt(2)
    ds_read_b128 v[76:79], v16 offset:11264
    v_mov_b32 v45, v44
    v_mul_f32 v62, v108, v62
    v_mul_f32 v63, v109, v63
    v_mfma_f32_16x16x32_bf16 v[52:55], a[96:99], v[64:67], v[52:55]
    s_waitcnt lgkmcnt(2)
    ds_read_b128 v[64:67], v16 offset:12288
    v_permlane32_swap_b32 v45, v44
    v_max_f32 v44, v44, v45
    v_mfma_f32_16x16x32_bf16 v[52:55], a[108:111], v[68:71], v[52:55]
    s_waitcnt vmcnt(1)
    s_waitcnt lgkmcnt(2)
    buffer_store_dword v25, off, s[36:39], s83 offset:128
    ds_read_b128 v[68:71], v16 offset:13312
    v_mov_b32 v45, v44
    s_waitcnt vmcnt(1)
    v_cmp_gt_u32 vcc, s72, v29
    v_mfma_f32_16x16x32_bf16 v[52:55], a[120:123], v[72:75], v[52:55]
    s_cbranch_vccnz L_slow_33
L_back_34:
    s_add_u32 m0, s80, 49152
    s_waitcnt lgkmcnt(2)
    ds_read_b128 v[72:75], v16 offset:14336
    v_permlane16_swap_b32 v45, v44
    v_mfma_f32_16x16x32_bf16 v[52:55], a[132:135], v[76:79], v[52:55]
    s_waitcnt lgkmcnt(2)
    buffer_load_dwordx4 v16, s[36:39], s95 offen offset:0 sc1 lds
    ds_read_b128 v[76:79], v16 offset:15360
    v_max_f32 v44, v44, v45
    v_mul_f32 v44, v44, v89
    v_mfma_f32_16x16x32_bf16 v[52:55], a[144:147], v[64:67], v[52:55]
    s_waitcnt lgkmcnt(2)
    buffer_load_dwordx4 v16, s[36:39], s95 offen offset:1024 sc1 lds
    v_fma_f32 v40, v40, v89, -v44
    v_fma_f32 v41, v41, v89, -v44
    v_fma_f32 v42, v42, v89, -v44
    v_mfma_f32_16x16x32_bf16 v[52:55], a[156:159], v[68:71], v[52:55]
    s_waitcnt lgkmcnt(1)
    buffer_load_dwordx4 v16, s[36:39], s95 offen offset:2048 sc1 lds
    v_fma_f32 v43, v43, v89, -v44
    v_exp_f32 v40, v40
    v_mfma_f32_16x16x32_bf16 v[52:55], a[168:171], v[72:75], v[52:55]
    s_waitcnt lgkmcnt(0)
    buffer_load_dwordx4 v16, s[36:39], s95 offen offset:3072 sc1 lds
    v_exp_f32 v41, v41
    v_exp_f32 v42, v42
    v_mfma_f32_16x16x32_bf16 v[52:55], a[180:183], v[76:79], v[52:55]
    v_exp_f32 v43, v43
    v_cvt_pk_bf16_f32 v46, v40, v41
    v_cvt_pk_bf16_f32 v47, v42, v43
    v_cvt_pk_bf16_f32 v94, v60, v61
    v_cvt_pk_bf16_f32 v95, v62, v63
    v_and_b32 v50, v38, v46
    v_and_b32 v51, v39, v47
    v_xor_b32 v48, v50, v46
    v_xor_b32 v49, v51, v47
    s_nop 1
    v_mfma_f32_16x16x32_bf16 v[44:47], v[34:37], v[48:51], 0
    v_mfma_f32_16x16x32_bf16 v[40:43], v[94:97], v[48:51], 0
    v_fma_f32 v52, v115, v80, v52
    v_fma_f32 v53, v115, v81, v53
    v_fma_f32 v54, v115, v82, v54
    v_fma_f32 v55, v115, v83, v55
    v_cvt_pk_bf16_f32 v104, v52, v53
    v_cvt_pk_bf16_f32 v105, v54, v55
    v_mul_f32 v116, 0x3eb8aa3b, v114
    v_cmp_eq_u32 vcc, -1, v93
    v_rcp_f32 v44, v44
    s_nop 0
    v_mul_f32 v40, v44, v40
    v_mul_f32 v41, v44, v41
    v_mul_f32 v42, v44, v42
    s_cbranch_vccnz L_slow_36
L_back_37:
    s_add_u32 s85, s85, 0x8000
    v_mfma_f32_16x16x16_bf16 v[52:55], v[98:99], v[104:105], v[30:33]
    v_mfma_f32_16x16x16_bf16 v[56:59], v[90:91], v[104:105], v[118:121]
    v_mul_f32 v43, v44, v43
    v_cvt_pk_bf16_f32 v48, v40, v41
    v_cvt_pk_bf16_f32 v49, v42, v43
    buffer_store_dwordx2 v[48:49], v19, s[36:39], s89 offen offset:0
    s_nop 3
    v_cndmask_b32 v52, v56, v52, s[60:61]
    v_cndmask_b32 v53, v57, v53, s[62:63]
    v_cndmask_b32 v54, v58, v54, s[64:65]
    v_cndmask_b32 v55, v59, v55, s[66:67]
    v_max3_f32 v56, v52, v53, v54
    v_max_f32 v56, v56, v55
    v_mov_b32 v57, v56
    s_nop 1
    v_permlane32_swap_b32 v57, v56
    v_max_f32 v56, v56, v57
    v_mov_b32 v57, v56
    s_nop 1
    v_permlane16_swap_b32 v57, v56
    v_max_f32 v56, v56, v57
    v_mul_f32 v56, v56, v116
    buffer_load_dword v29, v22, s[36:39], s82 offen offset:128 sc1
    v_fma_f32 v52, v52, v116, -v56
    v_fma_f32 v53, v53, v116, -v56
    v_fma_f32 v54, v54, v116, -v56
    v_fma_f32 v55, v55, v116, -v56
    v_exp_f32 v52, v52
    v_exp_f32 v53, v53
    v_exp_f32 v54, v54
    v_exp_f32 v55, v55
    v_cvt_pk_bf16_f32 v58, v52, v53
    v_cvt_pk_bf16_f32 v59, v54, v55
    v_and_b32 v62, v38, v58
    v_and_b32 v63, v39, v59
    v_xor_b32 v60, v62, v58
    v_xor_b32 v61, v63, v59
    s_nop 1
    v_mfma_f32_16x16x32_bf16 v[56:59], v[34:37], v[60:63], 0
    v_mfma_f32_16x16x32_bf16 v[52:55], v[92:95], v[60:63], 0
    s_nop 6
    v_rcp_f32 v56, v56
    s_nop 0
    v_mul_f32 v52, v56, v52
    v_mul_f32 v53, v56, v53
    v_mul_f32 v54, v56, v54
    v_mul_f32 v55, v56, v55
    v_cvt_pk_bf16_f32 v60, v52, v53
    s_waitcnt vmcnt(1)
    buffer_store_dword v25, off, s[36:39], s83 offset:896
    v_cvt_pk_bf16_f32 v61, v54, v55
    buffer_store_dwordx2 v[60:61], v19, s[36:39], s88 offen offset:0
    s_waitcnt vmcnt(2)
    v_cmp_gt_u32 vcc, s72, v29
    s_cbranch_vccnz L_slow_39
L_back_40:
    s_add_u32 m0, s80, 32768
    s_nop 0
    buffer_load_dwordx4 v16, s[36:39], s94 offen offset:0 sc1 lds
    buffer_load_dwordx4 v16, s[36:39], s94 offen offset:1024 sc1 lds
    buffer_load_dwordx4 v16, s[36:39], s94 offen offset:2048 sc1 lds
    buffer_load_dwordx4 v16, s[36:39], s94 offen offset:3072 sc1 lds
    s_branch L_w
L_qkvB:
    s_waitcnt lgkmcnt(3)
    v_mfma_f32_16x16x32_bf16 v[40:43], a[192:195], v[64:67], 0
    ds_read_b128 v[76:79], v16 offset:52224
    v_mfma_f32_16x16x32_bf16 v[44:47], a[196:199], v[64:67], 0
    s_waitcnt vmcnt(1)
    buffer_store_dword v25, off, s[36:39], s83 offset:640
    v_cvt_pk_bf16_f32 v36, v0, v1
    v_cvt_pk_bf16_f32 v37, v2, v3
    v_mfma_f32_16x16x32_bf16 v[48:51], v[64:67], a[200:203], 0
    s_waitcnt lgkmcnt(3)
    buffer_store_dwordx2 v[36:37], v19, s[36:39], s96 offen offset:0
    v_mul_f32 v39, v0, v0
    v_mfma_f32_16x16x32_bf16 v[40:43], a[204:207], v[68:71], v[40:43]
    ds_read_b128 v[64:67], v16 offset:53248
    v_add_f32 v38, v0, v1
    v_fmac_f32 v39, v1, v1
    v_mfma_f32_16x16x32_bf16 v[44:47], a[208:211], v[68:71], v[44:47]
    v_add_f32 v38, v38, v2
    v_fmac_f32 v39, v2, v2
    v_mfma_f32_16x16x32_bf16 v[48:51], v[68:71], a[212:215], v[48:51]
    s_waitcnt lgkmcnt(3)
    v_add_f32 v38, v38, v3
    v_fmac_f32 v39, v3, v3
    v_mfma_f32_16x16x32_bf16 v[40:43], a[216:219], v[72:75], v[40:43]
    ds_read_b128 v[68:71], v16 offset:54272
    v_permlane32_swap_b32 v38, v39
    v_mfma_f32_16x16x32_bf16 v[44:47], a[220:223], v[72:75], v[44:47]
    s_waitcnt vmcnt(2)
    v_add_f32 v38, v38, v39
    v_mov_b32 v39, v38
    v_cmp_gt_u32 vcc, s72, v29
    v_mfma_f32_16x16x32_bf16 v[48:51], v[72:75], a[224:227], v[48:51]
    s_waitcnt lgkmcnt(2)
    v_permlane16_swap_b32 v39, v38
    v_mfma_f32_16x16x32_bf16 v[40:43], a[228:231], v[76:79], v[40:43]
    s_cbranch_vccnz L_slow_42
L_back_43:
    v_add_f32 v38, v38, v39
    ds_write_b32 v26, v38 offset:512
    ds_read_b128 v[72:75], v16 offset:55296
    v_mfma_f32_16x16x32_bf16 v[44:47], a[232:235], v[76:79], v[44:47]
    s_lshl_b32 s74, s68, 8
    buffer_load_dwordx4 v[118:121], v16, s[36:39], s86 offen offset:2048 sc1
    v_add_u32 v84, s74, v24
    v_add_u32 v88, s74, v23
    v_mfma_f32_16x16x32_bf16 v[48:51], v[76:79], a[236:239], v[48:51]
    s_waitcnt lgkmcnt(3)
    buffer_load_dwordx4 v[122:125], v16, s[36:39], s86 offen offset:3072 sc1
    ds_read_b128 v[80:83], v84 offset:3072
    v_mfma_f32_16x16x32_bf16 v[40:43], a[240:243], v[64:67], v[40:43]
    ds_read_b128 v[76:79], v16 offset:56320
    ds_read_b128 v[84:87], v84 offset:3136
    ds_read_b32 v88, v88 offset:3200
    v_mfma_f32_16x16x32_bf16 v[44:47], a[244:247], v[64:67], v[44:47]
    s_add_u32 m0, s80, 32768
    ds_read_b128 v[30:33], v28 offset:3584
    ds_read_b64 v[38:39], v28 offset:4608
    v_mfma_f32_16x16x32_bf16 v[48:51], v[64:67], a[248:251], v[48:51]
    s_waitcnt lgkmcnt(8)
    buffer_load_dwordx4 v16, s[36:39], s6 offen offset:0 sc1 lds
    v_mov_b32 v34, 0x3f803f80
    v_mov_b32 v35, 0x3f803f80
    v_mfma_f32_16x16x32_bf16 v[40:43], a[252:255], v[68:71], v[40:43]
    s_waitcnt lgkmcnt(7)
    s_barrier
    ds_read_b128 v[64:67], v16 offset:57344
    v_mfma_f32_16x16x32_bf16 v[44:47], v[128:131], v[68:71], v[44:47]
    ds_read_b128 v[106:109], v28 offset:512
    v_mov_b32 v36, 0x3f803f80
    v_mov_b32 v37, 0x3f803f80
    v_mfma_f32_16x16x32_bf16 v[48:51], v[68:71], v[132:135], v[48:51]
    s_waitcnt lgkmcnt(8)
    buffer_load_dwordx4 v16, s[36:39], s6 offen offset:1024 sc1 lds
    v_mfma_f32_16x16x32_bf16 v[40:43], v[136:139], v[72:75], v[40:43]
    ds_read_b128 v[68:71], v16 offset:58368
    v_mfma_f32_16x16x32_bf16 v[44:47], v[140:143], v[72:75], v[44:47]
    v_mfma_f32_16x16x32_bf16 v[48:51], v[72:75], v[144:147], v[48:51]
    s_waitcnt lgkmcnt(7)
    buffer_load_dwordx4 v16, s[36:39], s6 offen offset:2048 sc1 lds
    v_mfma_f32_16x16x32_bf16 v[40:43], v[148:151], v[76:79], v[40:43]
    s_waitcnt lgkmcnt(1)
    ds_read_b128 v[72:75], v16 offset:59392
    v_add_f32 v106, v106, v107
    v_add_f32 v108, v108, v109
    v_mfma_f32_16x16x32_bf16 v[44:47], v[152:155], v[76:79], v[44:47]
    v_add_f32 v106, v106, v108
    v_mfma_f32_16x16x32_bf16 v[48:51], v[76:79], v[156:159], v[48:51]
    buffer_load_dwordx4 v16, s[36:39], s6 offen offset:3072 sc1 lds
    buffer_store_dword v106, v21, s[36:39], s87 offen offset:0
    v_mfma_f32_16x16x32_bf16 v[40:43], v[160:163], v[64:67], v[40:43]
    ds_read_b128 v[76:79], v16 offset:60416
    v_mfma_f32_16x16x32_bf16 v[44:47], v[164:167], v[64:67], v[44:47]
    v_mfma_f32_16x16x32_bf16 v[48:51], v[64:67], v[168:171], v[48:51]
    s_waitcnt lgkmcnt(2)
    s_waitcnt vmcnt(5)
    v_add_f32 v118, v118, v122
    v_add_f32 v120, v120, v124
    v_mfma_f32_16x16x32_bf16 v[40:43], v[172:175], v[68:71], v[40:43]
    ds_read_b128 v[64:67], v16 offset:61440
    v_add_f32 v119, v119, v123
    v_add_f32 v121, v121, v125
    v_mfma_f32_16x16x32_bf16 v[44:47], v[176:179], v[68:71], v[44:47]
    buffer_load_dword v29, v22, s[36:39], s82 offen offset:640 sc1
    v_permlane32_swap_b32 v118, v120
    v_mfma_f32_16x16x32_bf16 v[48:51], v[68:71], v[180:183], v[48:51]
    s_waitcnt lgkmcnt(2)
    v_permlane32_swap_b32 v119, v121
    v_mfma_f32_16x16x32_bf16 v[40:43], v[184:187], v[72:75], v[40:43]
    s_add_u32 s3, s19, 0
    s_and_b32 s3, s3, 0x7ffff
    ds_read_b128 v[68:71], v16 offset:62464
    v_mfma_f32_16x16x32_bf16 v[44:47], v[188:191], v[72:75], v[44:47]
    s_add_u32 m0, s81, 65536
    v_add_f32 v118, v118, v120
    v_add_f32 v119, v119, v121
    v_mfma_f32_16x16x32_bf16 v[48:51], v[72:75], v[192:195], v[48:51]
    s_waitcnt lgkmcnt(2)
    buffer_load_dwordx4 v17, s[40:43], s3 offen offset:0 lds
    v_permlane16_swap_b32 v118, v119
    v_mfma_f32_16x16x32_bf16 v[40:43], v[196:199], v[76:79], v[40:43]
    ds_read_b128 v[72:75], v16 offset:63488
    v_add_f32 v118, v118, v119
    v_mfma_f32_16x16x32_bf16 v[44:47], v[200:203], v[76:79], v[44:47]
    v_mul_f32 v119, 0x3b000000, v118
    v_mul_f32 v118, 0x3b000000, v118
    v_mfma_f32_16x16x32_bf16 v[48:51], v[76:79], v[204:207], v[48:51]
    s_waitcnt lgkmcnt(2)
    v_permlane16_swap_b32 v118, v119
    v_fma_f32 v119, -v118, v118, v119
    v_mfma_f32_16x16x32_bf16 v[40:43], v[208:211], v[64:67], v[40:43]
    ds_read_b128 v[76:79], v16 offset:64512
    v_max_f32 v119, 0, v119
    v_cvt_pk_bf16_f32 v119, v118, v119
    v_mfma_f32_16x16x32_bf16 v[44:47], v[212:215], v[64:67], v[44:47]
    v_lshlrev_b32 v118, 16, v119
    v_and_b32 v119, 0xffff0000, v119
    v_mfma_f32_16x16x32_bf16 v[48:51], v[64:67], v[216:219], v[48:51]
    s_waitcnt lgkmcnt(2)
    v_add_f32 v119, 0x3727c5ac, v119
    v_cvt_pk_bf16_f32 v119, v119, v119
    v_and_b32 v119, 0xffff0000, v119
    v_mfma_f32_16x16x32_bf16 v[40:43], v[220:223], v[68:71], v[40:43]
    s_waitcnt vmcnt(3)
    s_barrier
    ds_read_b128 v[64:67], v16 offset:32768
    v_mfma_f32_16x16x32_bf16 v[44:47], v[224:227], v[68:71], v[44:47]
    s_waitcnt vmcnt(1)
    v_cmp_gt_u32 vcc, s72, v29
    buffer_store_dword v25, off, s[36:39], s83 offset:768
    v_add_u32 v25, 1, v25
    v_mfma_f32_16x16x32_bf16 v[48:51], v[68:71], v[228:231], v[48:51]
    s_waitcnt lgkmcnt(2)
    v_sqrt_f32 v119, v119
    v_mfma_f32_16x16x32_bf16 v[40:43], v[232:235], v[72:75], v[40:43]
    ds_read_b128 v[68:71], v16 offset:33792
    v_xor_b32 v118, 0x80000000, v118
    v_mfma_f32_16x16x32_bf16 v[44:47], v[236:239], v[72:75], v[44:47]
    s_cbranch_vccnz L_slow_45
L_back_46:
    s_add_u32 m0, s80, 16384
    v_cvt_pk_bf16_f32 v119, v119, v119
    v_and_b32 v119, 0xffff0000, v119
    v_mfma_f32_16x16x32_bf16 v[48:51], v[72:75], v[240:243], v[48:51]
    s_waitcnt lgkmcnt(2)
    buffer_load_dwordx4 v16, s[36:39], s5 offen offset:0 sc1 lds
    v_rcp_f32 v119, v119
    v_mfma_f32_16x16x32_bf16 v[40:43], v[244:247], v[76:79], v[40:43]
    ds_read_b128 v[72:75], v16 offset:34816
    ds_write2_b32 v27, v119, v118 offset0:32 offset1:96
    v_mfma_f32_16x16x32_bf16 v[44:47], v[248:251], v[76:79], v[44:47]
    ds_read2_b32 v[114:115], v23 offset0:48 offset1:112
    ds_read_b128 v[106:109], v24 offset:192
    ds_read_b128 v[110:113], v24 offset:448
    v_mfma_f32_16x16x32_bf16 v[48:51], v[76:79], v[252:255], v[48:51]
    s_waitcnt lgkmcnt(6)
    buffer_load_dwordx4 v16, s[36:39], s5 offen offset:1024 sc1 lds
    v_mfma_f32_16x16x32_bf16 v[52:55], a[192:195], v[64:67], 0
    ds_read_b128 v[76:79], v16 offset:35840
    v_mfma_f32_16x16x32_bf16 v[56:59], a[196:199], v[64:67], 0
    v_mfma_f32_16x16x32_bf16 v[60:63], v[64:67], a[200:203], 0
    s_waitcnt lgkmcnt(6)
    buffer_load_dwordx4 v16, s[36:39], s5 offen offset:2048 sc1 lds
    s_waitcnt lgkmcnt(3)
    v_fma_f32 v44, v115, v84, v44
    v_mfma_f32_16x16x32_bf16 v[52:55], a[204:207], v[68:71], v[52:55]
    ds_read_b128 v[64:67], v16 offset:36864
    v_fma_f32 v45, v115, v85, v45
    v_fma_f32 v46, v115, v86, v46
    v_mfma_f32_16x16x32_bf16 v[56:59], a[208:211], v[68:71], v[56:59]
    v_fma_f32 v47, v115, v87, v47
    v_mul_f32 v44, v114, v44
    v_mfma_f32_16x16x32_bf16 v[60:63], v[68:71], a[212:215], v[60:63]
    buffer_load_dwordx4 v16, s[36:39], s5 offen offset:3072 sc1 lds
    v_mul_f32 v45, v114, v45
    v_mul_f32 v46, v114, v46
    v_mfma_f32_16x16x32_bf16 v[52:55], a[216:219], v[72:75], v[52:55]
    ds_read_b128 v[68:71], v16 offset:37888
    v_mul_f32 v47, v114, v47
    v_mfma_f32_16x16x32_bf16 v[56:59], a[220:223], v[72:75], v[56:59]
    v_cvt_pk_bf16_f32 v90, v44, v45
    v_cvt_pk_bf16_f32 v91, v46, v47
    s_waitcnt lgkmcnt(3)
    v_fma_f32 v48, v110, v88, v48
    v_mfma_f32_16x16x32_bf16 v[60:63], v[72:75], a[224:227], v[60:63]
    s_waitcnt lgkmcnt(2)
    v_fma_f32 v49, v111, v88, v49
    v_mfma_f32_16x16x32_bf16 v[52:55], a[228:231], v[76:79], v[52:55]
    ds_read_b128 v[72:75], v16 offset:38912
    v_fma_f32 v50, v112, v88, v50
    v_fma_f32 v51, v113, v88, v51
    v_mfma_f32_16x16x32_bf16 v[56:59], a[232:235], v[76:79], v[56:59]
    s_add_u32 m0, s81, 65568
    v_mul_f32 v48, v106, v48
    v_mul_f32 v49, v107, v49
    v_mfma_f32_16x16x32_bf16 v[60:63], v[76:79], a[236:239], v[60:63]
    s_waitcnt lgkmcnt(2)
    buffer_load_dwordx4 v17, s[40:43], s3 offen offset:1024 lds
    v_mul_f32 v50, v108, v50
    v_mfma_f32_16x16x32_bf16 v[52:55], a[240:243], v[64:67], v[52:55]
    ds_read_b128 v[76:79], v16 offset:39936
    v_mul_f32 v51, v109, v51
    v_cvt_pk_bf16_f32 v92, v48, v49
    v_mfma_f32_16x16x32_bf16 v[56:59], a[244:247], v[64:67], v[56:59]
    buffer_load_dword v29, v22, s[36:39], s82 offen offset:768 sc1
    v_cvt_pk_bf16_f32 v93, v50, v51
    v_mfma_f32_16x16x32_bf16 v[60:63], v[64:67], a[248:251], v[60:63]
    s_waitcnt lgkmcnt(2)
    v_fma_f32 v40, v115, v80, v40
    v_fma_f32 v41, v115, v81, v41
    v_fma_f32 v42, v115, v82, v42
    v_mfma_f32_16x16x32_bf16 v[52:55], a[252:255], v[68:71], v[52:55]
    ds_read_b128 v[64:67], v16 offset:40960
    v_fma_f32 v43, v115, v83, v43
    v_mfma_f32_16x16x32_bf16 v[56:59], v[128:131], v[68:71], v[56:59]
    v_cvt_pk_bf16_f32 v102, v40, v41
    v_cvt_pk_bf16_f32 v103, v42, v43
    v_mul_f32 v89, 0x3eb8aa3b, v114
    v_mfma_f32_16x16x32_bf16 v[60:63], v[68:71], v[132:135], v[60:63]
    s_waitcnt lgkmcnt(2)
    ds_read2_b32 v[114:115], v23 offset0:32 offset1:96
    ds_read_b128 v[106:109], v24 offset:128
    v_mfma_f32_16x16x32_bf16 v[52:55], v[136:139], v[72:75], v[52:55]
    ds_read_b128 v[68:71], v16 offset:41984
    ds_read_b128 v[110:113], v24 offset:384
    v_mfma_f32_16x16x32_bf16 v[56:59], v[140:143], v[72:75], v[56:59]
    s_add_u32 m0, s81, 65600
    v_mfma_f32_16x16x32_bf16 v[60:63], v[72:75], v[144:147], v[60:63]
    s_waitcnt lgkmcnt(5)
    buffer_load_dwordx4 v17, s[40:43], s3 offen offset:2048 lds
    v_mfma_f32_16x16x32_bf16 v[52:55], v[148:151], v[76:79], v[52:55]
    ds_read_b128 v[72:75], v16 offset:43008
    v_mfma_f32_16x16x32_bf16 v[56:59], v[152:155], v[76:79], v[56:59]
    v_mfma_f32_16x16x32_bf16 v[60:63], v[76:79], v[156:159], v[60:63]
    s_waitcnt lgkmcnt(5)
    v_mfma_f32_16x16x32_bf16 v[52:55], v[160:163], v[64:67], v[52:55]
    ds_read_b128 v[76:79], v16 offset:44032
    v_mfma_f32_16x16x32_bf16 v[56:59], v[164:167], v[64:67], v[56:59]
    s_waitcnt vmcnt(1)
    v_cmp_gt_u32 vcc, s72, v29
    v_mfma_f32_16x16x32_bf16 v[60:63], v[64:67], v[168:171], v[60:63]
    s_waitcnt lgkmcnt(3)
    v_mfma_f32_16x16x32_bf16 v[52:55], v[172:175], v[68:71], v[52:55]
    s_cbranch_vccnz L_slow_48
L_back_49:
    s_add_u32 s72, s72, 1
    ds_read_b128 v[64:67], v16 offset:45056
    v_mfma_f32_16x16x32_bf16 v[56:59], v[176:179], v[68:71], v[56:59]
    buffer_load_dwordx4 v[118:121], v16, s[36:39], s86 offen offset:0 sc1
    v_mfma_f32_16x16x32_bf16 v[60:63], v[68:71], v[180:183], v[60:63]
    s_waitcnt lgkmcnt(2)
    buffer_load_dwordx4 v[122:125], v16, s[36:39], s86 offen offset:1024 sc1
    v_mfma_f32_16x16x32_bf16 v[52:55], v[184:187], v[72:75], v[52:55]
    ds_read_b128 v[68:71], v16 offset:46080
    v_mfma_f32_16x16x32_bf16 v[56:59], v[188:191], v[72:75], v[56:59]
    s_add_u32 m0, s80, 0
    v_mfma_f32_16x16x32_bf16 v[60:63], v[72:75], v[192:195], v[60:63]
    s_waitcnt lgkmcnt(2)
    buffer_load_dwordx4 v16, s[36:39], s4 offen offset:0 sc1 lds
    v_mfma_f32_16x16x32_bf16 v[52:55], v[196:199], v[76:79], v[52:55]
    ds_read_b128 v[72:75], v16 offset:47104
    v_mfma_f32_16x16x32_bf16 v[56:59], v[200:203], v[76:79], v[56:59]
    v_mfma_f32_16x16x32_bf16 v[60:63], v[76:79], v[204:207], v[60:63]
    s_waitcnt lgkmcnt(2)
    buffer_load_dwordx4 v16, s[36:39], s4 offen offset:1024 sc1 lds
    v_mfma_f32_16x16x32_bf16 v[52:55], v[208:211], v[64:67], v[52:55]
    ds_read_b128 v[76:79], v16 offset:48128
    v_mfma_f32_16x16x32_bf16 v[56:59], v[212:215], v[64:67], v[56:59]
    v_mfma_f32_16x16x32_bf16 v[60:63], v[64:67], v[216:219], v[60:63]
    s_waitcnt lgkmcnt(2)
    buffer_load_dwordx4 v16, s[36:39], s4 offen offset:2048 sc1 lds
    v_mfma_f32_16x16x32_bf16 v[52:55], v[220:223], v[68:71], v[52:55]
    s_barrier
    ds_read_b128 v[64:67], v16 offset:16384
    v_mfma_f32_16x16x32_bf16 v[56:59], v[224:227], v[68:71], v[56:59]
    v_mfma_f32_16x16x32_bf16 v[60:63], v[68:71], v[228:231], v[60:63]
    s_waitcnt lgkmcnt(2)
    buffer_load_dwordx4 v16, s[36:39], s4 offen offset:3072 sc1 lds
    v_mfma_f32_16x16x32_bf16 v[52:55], v[232:235], v[72:75], v[52:55]
    ds_read_b128 v[68:71], v16 offset:17408
    v_mfma_f32_16x16x32_bf16 v[56:59], v[236:239], v[72:75], v[56:59]
    v_min_u32 v93, -2, v93
    v_mfma_f32_16x16x32_bf16 v[60:63], v[72:75], v[240:243], v[60:63]
    s_waitcnt lgkmcnt(2)
    buffer_store_dwordx4 v[90:93], v16, s[36:39], s84 offen sc1
    v_mov_b32 v117, -1
    v_mfma_f32_16x16x32_bf16 v[52:55], v[244:247], v[76:79], v[52:55]
    ds_read_b128 v[72:75], v16 offset:18432
    s_waitcnt vmcnt(5)
    v_add_f32 v118, v118, v122
    v_mfma_f32_16x16x32_bf16 v[56:59], v[248:251], v[76:79], v[56:59]
    s_add_u32 s75, s84, 0x10000
    buffer_store_dwordx4 v[114:117], v16, s[36:39], s75 offen sc1
    v_add_f32 v120, v120, v124
    s_add_u32 s84, s84, 0x8000
    v_mfma_f32_16x16x32_bf16 v[60:63], v[76:79], v[252:255], v[60:63]
    v_add_f32 v119, v119, v123
    v_add_f32 v121, v121, v125
    s_waitcnt lgkmcnt(2)
    v_mfma_f32_16x16x32_bf16 v[40:43], a[192:195], v[64:67], 0
    ds_read_b128 v[76:79], v16 offset:19456
    v_permlane32_swap_b32 v118, v120
    v_mfma_f32_16x16x32_bf16 v[44:47], a[196:199], v[64:67], 0
    s_add_u32 m0, s81, 65632
    v_permlane32_swap_b32 v119, v121
    v_mfma_f32_16x16x32_bf16 v[48:51], v[64:67], a[200:203], 0
    s_waitcnt lgkmcnt(2)
    buffer_load_dwordx4 v17, s[40:43], s3 offen offset:3072 lds
    v_add_f32 v118, v118, v120
    v_add_f32 v119, v119, v121
    v_mfma_f32_16x16x32_bf16 v[40:43], a[204:207], v[68:71], v[40:43]
    ds_read_b128 v[64:67], v16 offset:20480
    v_permlane16_swap_b32 v118, v119
    v_mfma_f32_16x16x32_bf16 v[44:47], a[208:211], v[68:71], v[44:47]
    v_add_f32 v118, v118, v119
    v_mul_f32 v119, 0x3b000000, v118
    v_mul_f32 v118, 0x3b000000, v118
    v_mfma_f32_16x16x32_bf16 v[48:51], v[68:71], a[212:215], v[48:51]
    s_waitcnt lgkmcnt(2)
    v_permlane16_swap_b32 v118, v119
    v_mfma_f32_16x16x32_bf16 v[40:43], a[216:219], v[72:75], v[40:43]
    s_add_u32 s3, s19, 131072
    s_and_b32 s3, s3, 0x7ffff
    ds_read_b128 v[68:71], v16 offset:21504
    v_fma_f32 v119, -v118, v118, v119
    v_mfma_f32_16x16x32_bf16 v[44:47], a[220:223], v[72:75], v[44:47]
    s_add_u32 m0, s81, 82432
    v_max_f32 v119, 0, v119
    v_cvt_pk_bf16_f32 v119, v118, v119
    v_lshlrev_b32 v118, 16, v119
    v_mfma_f32_16x16x32_bf16 v[48:51], v[72:75], a[224:227], v[48:51]
    s_waitcnt lgkmcnt(2)
    buffer_load_dwordx4 v17, s[40:43], s3 offen offset:0 lds
    v_and_b32 v119, 0xffff0000, v119
    v_mfma_f32_16x16x32_bf16 v[40:43], a[228:231], v[76:79], v[40:43]
    ds_read_b128 v[72:75], v16 offset:22528
    v_add_f32 v119, 0x3727c5ac, v119
    v_cvt_pk_bf16_f32 v119, v119, v119
    v_mfma_f32_16x16x32_bf16 v[44:47], a[232:235], v[76:79], v[44:47]
    v_and_b32 v119, 0xffff0000, v119
    v_sqrt_f32 v119, v119
    v_mfma_f32_16x16x32_bf16 v[48:51], v[76:79], a[236:239], v[48:51]
    s_waitcnt lgkmcnt(2)
    v_xor_b32 v118, 0x80000000, v118
    v_cvt_pk_bf16_f32 v119, v119, v119
    v_mfma_f32_16x16x32_bf16 v[40:43], a[240:243], v[64:67], v[40:43]
    ds_read_b128 v[76:79], v16 offset:23552
    v_and_b32 v119, 0xffff0000, v119
    v_rcp_f32 v119, v119
    v_mfma_f32_16x16x32_bf16 v[44:47], a[244:247], v[64:67], v[44:47]
    s_add_u32 m0, s81, 82464
    ds_write2_b32 v27, v119, v118 offset0:0 offset1:64
    v_mfma_f32_16x16x32_bf16 v[48:51], v[64:67], a[248:251], v[48:51]
    s_waitcnt lgkmcnt(3)
    buffer_load_dwordx4 v17, s[40:43], s3 offen offset:1024 lds
    v_fma_f32 v56, v115, v84, v56
    v_fma_f32 v57, v115, v85, v57
    v_mfma_f32_16x16x32_bf16 v[40:43], a[252:255], v[68:71], v[40:43]
    ds_read_b128 v[64:67], v16 offset:24576
    v_fma_f32 v58, v115, v86, v58
    v_fma_f32 v59, v115, v87, v59
    v_mfma_f32_16x16x32_bf16 v[44:47], v[128:131], v[68:71], v[44:47]
    v_mul_f32 v56, v114, v56
    v_mul_f32 v57, v114, v57
    v_mul_f32 v58, v114, v58
    v_mfma_f32_16x16x32_bf16 v[48:51], v[68:71], v[132:135], v[48:51]
    s_waitcnt lgkmcnt(3)
    v_mul_f32 v59, v114, v59
    v_cvt_pk_bf16_f32 v98, v56, v57
    v_cvt_pk_bf16_f32 v99, v58, v59
    v_mfma_f32_16x16x32_bf16 v[40:43], v[136:139], v[72:75], v[40:43]
    ds_read_b128 v[68:71], v16 offset:25600
    v_fma_f32 v52, v115, v80, v52
    v_mfma_f32_16x16x32_bf16 v[44:47], v[140:143], v[72:75], v[44:47]
    s_add_u32 m0, s81, 82496
    v_fma_f32 v53, v115, v81, v53
    v_fma_f32 v54, v115, v82, v54
    v_fma_f32 v55, v115, v83, v55
    v_mfma_f32_16x16x32_bf16 v[48:51], v[72:75], v[144:147], v[48:51]
    s_waitcnt lgkmcnt(3)
    buffer_load_dwordx4 v17, s[40:43], s3 offen offset:2048 lds
    v_cvt_pk_bf16_f32 v104, v52, v53
    v_cvt_pk_bf16_f32 v105, v54, v55
    v_mfma_f32_16x16x32_bf16 v[40:43], v[148:151], v[76:79], v[40:43]
    ds_read_b128 v[72:75], v16 offset:26624
    v_mul_f32 v116, 0x3eb8aa3b, v114
    v_mfma_f32_16x16x32_bf16 v[44:47], v[152:155], v[76:79], v[44:47]
    v_mfma_f32_16x16x16_bf16 v[52:55], v[90:91], v[102:103], v[30:33]
    v_mfma_f32_16x16x16_bf16 v[56:59], v[98:99], v[102:103], v[30:33]
    v_fma_f32 v60, v110, v88, v60
    v_fma_f32 v61, v111, v88, v61
    v_fma_f32 v62, v112, v88, v62
    v_mfma_f32_16x16x32_bf16 v[48:51], v[76:79], v[156:159], v[48:51]
    s_waitcnt lgkmcnt(2)
    v_fma_f32 v63, v113, v88, v63
    v_mul_f32 v60, v106, v60
    v_mul_f32 v61, v107, v61
    v_mfma_f32_16x16x32_bf16 v[40:43], v[160:163], v[64:67], v[40:43]
    ds_read_b128 v[76:79], v16 offset:27648
    v_cndmask_b32 v52, v56, v52, s[60:61]
    v_cndmask_b32 v53, v57, v53, s[62:63]
    v_mfma_f32_16x16x32_bf16 v[44:47], v[164:167], v[64:67], v[44:47]
    s_add_u32 m0, s81, 82528
    v_cndmask_b32 v54, v58, v54, s[64:65]
    v_cndmask_b32 v55, v59, v55, s[66:67]
    v_max3_f32 v56, v52, v53, v54
    v_mfma_f32_16x16x32_bf16 v[48:51], v[64:67], v[168:171], v[48:51]
    s_waitcnt lgkmcnt(2)
    buffer_load_dwordx4 v17, s[40:43], s3 offen offset:3072 lds
    v_max_f32 v56, v56, v55
    v_mov_b32 v57, v56
    v_mfma_f32_16x16x32_bf16 v[40:43], v[172:175], v[68:71], v[40:43]
    ds_read_b128 v[64:67], v16 offset:28672
    v_permlane32_swap_b32 v57, v56
    v_mfma_f32_16x16x32_bf16 v[44:47], v[176:179], v[68:71], v[44:47]
    v_max_f32 v56, v56, v57
    v_mov_b32 v57, v56
    v_mul_f32 v62, v108, v62
    v_mfma_f32_16x16x32_bf16 v[48:51], v[68:71], v[180:183], v[48:51]
    s_waitcnt lgkmcnt(2)
    v_permlane16_swap_b32 v57, v56
    v_max_f32 v56, v56, v57
    v_mfma_f32_16x16x32_bf16 v[40:43], v[184:187], v[72:75], v[40:43]
    s_add_u32 s3, s19, 262144
    s_and_b32 s3, s3, 0x7ffff
    ds_read_b128 v[68:71], v16 offset:29696
    v_mul_f32 v56, v56, v89
    v_mfma_f32_16x16x32_bf16 v[44:47], v[188:191], v[72:75], v[44:47]
    s_add_u32 m0, s81, 99328
    v_fma_f32 v52, v52, v89, -v56
    v_fma_f32 v53, v53, v89, -v56
    v_fma_f32 v54, v54, v89, -v56
    v_mfma_f32_16x16x32_bf16 v[48:51], v[72:75], v[192:195], v[48:51]
    s_waitcnt lgkmcnt(2)
    buffer_load_dwordx4 v17, s[40:43], s3 offen offset:0 lds
    v_fma_f32 v55, v55, v89, -v56
    v_mfma_f32_16x16x32_bf16 v[40:43], v[196:199], v[76:79], v[40:43]
    ds_read_b128 v[72:75], v16 offset:30720
    v_exp_f32 v52, v52
    v_mfma_f32_16x16x32_bf16 v[44:47], v[200:203], v[76:79], v[44:47]
    v_exp_f32 v53, v53
    v_exp_f32 v54, v54
    v_mfma_f32_16x16x32_bf16 v[48:51], v[76:79], v[204:207], v[48:51]
    s_waitcnt lgkmcnt(2)
    v_exp_f32 v55, v55
    v_mfma_f32_16x16x32_bf16 v[40:43], v[208:211], v[64:67], v[40:43]
    ds_read_b128 v[76:79], v16 offset:31744
    v_cvt_pk_bf16_f32 v58, v52, v53
    v_cvt_pk_bf16_f32 v59, v54, v55
    v_mfma_f32_16x16x32_bf16 v[44:47], v[212:215], v[64:67], v[44:47]
    s_add_u32 m0, s81, 99360
    v_mul_f32 v63, v109, v63
    v_cvt_pk_bf16_f32 v94, v60, v61
    v_cvt_pk_bf16_f32 v95, v62, v63
    v_mfma_f32_16x16x32_bf16 v[48:51], v[64:67], v[216:219], v[48:51]
    s_waitcnt lgkmcnt(2)
    buffer_load_dwordx4 v17, s[40:43], s3 offen offset:1024 lds
    ds_read2_b32 v[114:115], v23 offset0:16 offset1:80
    v_mfma_f32_16x16x32_bf16 v[40:43], v[220:223], v[68:71], v[40:43]
    ds_read_b128 v[106:109], v24 offset:64
    ds_read_b128 v[110:113], v24 offset:320
    s_waitcnt vmcnt(9)
    s_barrier
    ds_read_b128 v[64:67], v16 offset:0
    v_mfma_f32_16x16x32_bf16 v[44:47], v[224:227], v[68:71], v[44:47]
    v_and_b32 v60, v38, v58
    v_and_b32 v61, v39, v59
    v_xor_b32 v62, v60, v58
    v_mfma_f32_16x16x32_bf16 v[48:51], v[68:71], v[228:231], v[48:51]
    v_xor_b32 v63, v61, v59
    s_nop 1
    v_mfma_f32_16x16x32_bf16 v[56:59], v[34:37], v[60:63], 0
    v_mfma_f32_16x16x32_bf16 v[52:55], v[92:95], v[60:63], 0
    s_nop 6
    v_rcp_f32 v56, v56
    s_nop 0
    v_mul_f32 v52, v56, v52
    v_mul_f32 v53, v56, v53
    v_mul_f32 v54, v56, v54
    v_mul_f32 v55, v56, v55
    v_cvt_pk_bf16_f32 v60, v52, v53
    v_cvt_pk_bf16_f32 v61, v54, v55
    buffer_store_dwordx2 v[60:61], v19, s[36:39], s91 offen offset:0
    s_waitcnt lgkmcnt(5)
    v_mfma_f32_16x16x32_bf16 v[40:43], v[232:235], v[72:75], v[40:43]
    ds_read_b128 v[68:71], v16 offset:1024
    v_mfma_f32_16x16x32_bf16 v[44:47], v[236:239], v[72:75], v[44:47]
    s_add_u32 m0, s81, 99392
    v_mfma_f32_16x16x32_bf16 v[48:51], v[72:75], v[240:243], v[48:51]
    s_waitcnt lgkmcnt(5)
    buffer_load_dwordx4 v17, s[40:43], s3 offen offset:2048 lds
    v_mfma_f32_16x16x32_bf16 v[40:43], v[244:247], v[76:79], v[40:43]
    ds_read_b128 v[72:75], v16 offset:2048
    v_mfma_f32_16x16x32_bf16 v[44:47], v[248:251], v[76:79], v[44:47]
    s_add_u32 m0, s81, 99424
    v_mfma_f32_16x16x32_bf16 v[48:51], v[76:79], v[252:255], v[48:51]
    buffer_load_dwordx4 v17, s[40:43], s3 offen offset:3072 lds
    s_waitcnt lgkmcnt(2)
    v_mfma_f32_16x16x32_bf16 v[56:59], a[196:199], v[64:67], 0
    ds_read_b128 v[76:79], v16 offset:3072
    v_mfma_f32_16x16x32_bf16 v[60:63], v[64:67], a[200:203], 0
    s_waitcnt lgkmcnt(2)
    v_fma_f32 v44, v115, v84, v44
    v_fma_f32 v45, v115, v85, v45
    v_fma_f32 v46, v115, v86, v46
    v_mfma_f32_16x16x32_bf16 v[56:59], a[208:211], v[68:71], v[56:59]
    ds_read_b128 v[64:67], v16 offset:4096
    v_fma_f32 v47, v115, v87, v47
    v_mul_f32 v44, v114, v44
    v_mfma_f32_16x16x32_bf16 v[60:63], v[68:71], a[212:215], v[60:63]
    s_add_u32 s3, s19, 393216
    s_and_b32 s3, s3, 0x7ffff
    s_waitcnt lgkmcnt(2)
    v_mul_f32 v45, v114, v45
    v_mul_f32 v46, v114, v46
    v_mfma_f32_16x16x32_bf16 v[56:59], a[220:223], v[72:75], v[56:59]
    s_add_u32 m0, s81, 116224
    ds_read_b128 v[68:71], v16 offset:5120
    v_mul_f32 v47, v114, v47
    v_cvt_pk_bf16_f32 v100, v44, v45
    v_mfma_f32_16x16x32_bf16 v[60:63], v[72:75], a[224:227], v[60:63]
    s_waitcnt lgkmcnt(2)
    buffer_load_dwordx4 v17, s[40:43], s3 offen offset:0 lds
    v_cvt_pk_bf16_f32 v101, v46, v47
    v_mfma_f32_16x16x32_bf16 v[56:59], a[232:235], v[76:79], v[56:59]
    ds_read_b128 v[72:75], v16 offset:6144
    v_fma_f32 v40, v115, v80, v40
    v_fma_f32 v41, v115, v81, v41
    v_mfma_f32_16x16x32_bf16 v[60:63], v[76:79], a[236:239], v[60:63]
    s_waitcnt lgkmcnt(2)
    v_fma_f32 v42, v115, v82, v42
    v_fma_f32 v43, v115, v83, v43
    v_cvt_pk_bf16_f32 v102, v40, v41
    v_mfma_f32_16x16x32_bf16 v[56:59], a[244:247], v[64:67], v[56:59]
    ds_read_b128 v[76:79], v16 offset:7168
    v_cvt_pk_bf16_f32 v103, v42, v43
    v_mul_f32 v89, 0x3eb8aa3b, v114
    v_mfma_f32_16x16x32_bf16 v[60:63], v[64:67], a[248:251], v[60:63]
    s_waitcnt lgkmcnt(2)
    v_mfma_f32_16x16x16_bf16 v[40:43], v[98:99], v[104:105], v[30:33]
    v_mfma_f32_16x16x16_bf16 v[44:47], v[100:101], v[104:105], v[30:33]
    v_fma_f32 v48, v110, v88, v48
    v_fma_f32 v49, v111, v88, v49
    v_fma_f32 v50, v112, v88, v50
    v_mfma_f32_16x16x32_bf16 v[56:59], v[128:131], v[68:71], v[56:59]
    s_waitcnt vmcnt(3)
    buffer_store_dword v25, off, s[36:39], s83 offset:0
    ds_read_b128 v[64:67], v16 offset:8192
    v_fma_f32 v51, v113, v88, v51
    v_mfma_f32_16x16x32_bf16 v[60:63], v[68:71], v[132:135], v[60:63]
    s_waitcnt lgkmcnt(2)
    buffer_load_dwordx4 v[90:93], v16, s[36:39], s85 offen sc1
    v_cndmask_b32 v40, v44, v40, s[60:61]
    v_cndmask_b32 v41, v45, v41, s[62:63]
    v_mfma_f32_16x16x32_bf16 v[56:59], v[140:143], v[72:75], v[56:59]
    ds_read_b128 v[68:71], v16 offset:9216
    v_cndmask_b32 v42, v46, v42, s[64:65]
    v_cndmask_b32 v43, v47, v43, s[66:67]
    v_mfma_f32_16x16x32_bf16 v[60:63], v[72:75], v[144:147], v[60:63]
    s_waitcnt lgkmcnt(2)
    v_max3_f32 v44, v40, v41, v42
    v_max_f32 v44, v44, v43
    v_mov_b32 v45, v44
    v_mfma_f32_16x16x32_bf16 v[56:59], v[152:155], v[76:79], v[56:59]
    s_add_u32 m0, s81, 116256
    ds_read_b128 v[72:75], v16 offset:10240
    v_permlane32_swap_b32 v45, v44
    v_mfma_f32_16x16x32_bf16 v[60:63], v[76:79], v[156:159], v[60:63]
    s_waitcnt lgkmcnt(2)
    buffer_load_dwordx4 v17, s[40:43], s3 offen offset:1024 lds
    v_max_f32 v44, v44, v45
    v_mfma_f32_16x16x32_bf16 v[56:59], v[164:167], v[64:67], v[56:59]
    ds_read_b128 v[76:79], v16 offset:11264
    v_mov_b32 v45, v44
    v_mul_f32 v48, v106, v48
    v_mfma_f32_16x16x32_bf16 v[60:63], v[64:67], v[168:171], v[60:63]
    s_waitcnt lgkmcnt(2)
    v_permlane16_swap_b32 v45, v44
    v_max_f32 v44, v44, v45
    v_mfma_f32_16x16x32_bf16 v[56:59], v[176:179], v[68:71], v[56:59]
    ds_read_b128 v[64:67], v16 offset:12288
    v_mul_f32 v44, v44, v116
    v_fma_f32 v40, v40, v116, -v44
    v_mfma_f32_16x16x32_bf16 v[60:63], v[68:71], v[180:183], v[60:63]
    s_waitcnt lgkmcnt(2)
    v_fma_f32 v41, v41, v116, -v44
    v_fma_f32 v42, v42, v116, -v44
    v_fma_f32 v43, v43, v116, -v44
    v_mfma_f32_16x16x32_bf16 v[56:59], v[188:191], v[72:75], v[56:59]
    s_add_u32 m0, s81, 116288
    ds_read_b128 v[68:71], v16 offset:13312
    v_exp_f32 v40, v40
    v_mfma_f32_16x16x32_bf16 v[60:63], v[72:75], v[192:195], v[60:63]
    s_waitcnt lgkmcnt(2)
    buffer_load_dwordx4 v17, s[40:43], s3 offen offset:2048 lds
    v_exp_f32 v41, v41
    v_mfma_f32_16x16x32_bf16 v[56:59], v[200:203], v[76:79], v[56:59]
    ds_read_b128 v[72:75], v16 offset:14336
    v_exp_f32 v42, v42
    v_mfma_f32_16x16x32_bf16 v[60:63], v[76:79], v[204:207], v[60:63]
    s_waitcnt lgkmcnt(2)
    v_exp_f32 v43, v43
    v_mfma_f32_16x16x32_bf16 v[56:59], v[212:215], v[64:67], v[56:59]
    ds_read_b128 v[76:79], v16 offset:15360
    v_cvt_pk_bf16_f32 v46, v40, v41
    v_cvt_pk_bf16_f32 v47, v42, v43
    v_mfma_f32_16x16x32_bf16 v[60:63], v[64:67], v[216:219], v[60:63]
    s_waitcnt lgkmcnt(2)
    v_mul_f32 v49, v107, v49
    v_mul_f32 v50, v108, v50
    v_mul_f32 v51, v109, v51
    v_mfma_f32_16x16x32_bf16 v[56:59], v[224:227], v[68:71], v[56:59]
    s_add_u32 m0, s81, 116320
    ds_read_b128 v[64:67], v16 offset:0
    v_cvt_pk_bf16_f32 v96, v48, v49
    v_mfma_f32_16x16x32_bf16 v[60:63], v[68:71], v[228:231], v[60:63]
    s_waitcnt lgkmcnt(2)
    buffer_load_dwordx4 v17, s[40:43], s3 offen offset:3072 lds
    v_cvt_pk_bf16_f32 v97, v50, v51
    v_and_b32 v48, v38, v46
    v_mfma_f32_16x16x32_bf16 v[56:59], v[236:239], v[72:75], v[56:59]
    ds_read_b128 v[68:71], v16 offset:1024
    ds_read2_b32 v[114:115], v23 offset0:0 offset1:64
    ds_read_b128 v[106:109], v24 offset:0
    v_mfma_f32_16x16x32_bf16 v[60:63], v[72:75], v[240:243], v[60:63]
    s_waitcnt lgkmcnt(4)
    ds_read_b128 v[110:113], v24 offset:256
    v_and_b32 v49, v39, v47
    v_xor_b32 v50, v48, v46
    v_mfma_f32_16x16x32_bf16 v[56:59], v[248:251], v[76:79], v[56:59]
    ds_read_b128 v[72:75], v16 offset:2048
    v_xor_b32 v51, v49, v47
    v_mfma_f32_16x16x32_bf16 v[60:63], v[76:79], v[252:255], v[60:63]
    s_waitcnt lgkmcnt(5)
    ds_read_b128 v[76:79], v16 offset:3072
    v_mfma_f32_16x16x32_bf16 v[44:47], v[34:37], v[48:51], 0
    v_mfma_f32_16x16x32_bf16 v[40:43], v[94:97], v[48:51], 0
    v_min_f32 v118, s100, v30
    v_min_f32 v119, s100, v31
    v_min_f32 v120, s100, v32
    v_min_f32 v121, s100, v33
    v_mfma_f32_16x16x32_bf16 v[52:55], a[192:195], v[64:67], 0
    ds_read_b128 v[64:67], v16 offset:4096
    s_nop 0
    v_rcp_f32 v44, v44
    s_nop 0
    v_mul_f32 v40, v44, v40
    v_mul_f32 v41, v44, v41
    v_mul_f32 v42, v44, v42
    v_mul_f32 v43, v44, v43
    v_cvt_pk_bf16_f32 v48, v40, v41
    v_cvt_pk_bf16_f32 v49, v42, v43
    buffer_store_dwordx2 v[48:49], v19, s[36:39], s90 offen offset:0
    s_waitcnt lgkmcnt(6)
    v_mfma_f32_16x16x32_bf16 v[52:55], a[204:207], v[68:71], v[52:55]
    s_waitcnt lgkmcnt(2)
    buffer_load_dword v29, v22, s[36:39], s82 offen offset:0 sc1
    ds_read_b128 v[68:71], v16 offset:5120
    v_fma_f32 v56, v115, v84, v56
    v_fma_f32 v57, v115, v85, v57
    v_mfma_f32_16x16x32_bf16 v[52:55], a[216:219], v[72:75], v[52:55]
    s_waitcnt lgkmcnt(2)
    ds_read_b128 v[72:75], v16 offset:6144
    v_fma_f32 v58, v115, v86, v58
    v_fma_f32 v59, v115, v87, v59
    v_mul_f32 v56, v114, v56
    v_mfma_f32_16x16x32_bf16 v[52:55], a[228:231], v[76:79], v[52:55]
    s_waitcnt lgkmcnt(2)
    ds_read_b128 v[76:79], v16 offset:7168
    v_mul_f32 v57, v114, v57
    v_mul_f32 v58, v114, v58
    v_mul_f32 v59, v114, v59
    v_mfma_f32_16x16x32_bf16 v[52:55], a[240:243], v[64:67], v[52:55]
    s_waitcnt lgkmcnt(2)
    ds_read_b128 v[64:67], v16 offset:8192
    v_cvt_pk_bf16_f32 v98, v56, v57
    v_cvt_pk_bf16_f32 v99, v58, v59
    v_mfma_f32_16x16x16_bf16 v[40:43], v[100:101], v[102:103], v[30:33]
    v_fma_f32 v60, v110, v88, v60
    v_mfma_f32_16x16x16_bf16 v[44:47], v[98:99], v[102:103], v[30:33]
    v_fma_f32 v61, v111, v88, v61
    v_fma_f32 v62, v112, v88, v62
    v_fma_f32 v63, v113, v88, v63
    v_mul_f32 v60, v106, v60
    v_mfma_f32_16x16x32_bf16 v[52:55], a[252:255], v[68:71], v[52:55]
    s_waitcnt lgkmcnt(2)
    ds_read_b128 v[68:71], v16 offset:9216
    v_mul_f32 v61, v107, v61
    v_cndmask_b32 v40, v44, v40, s[60:61]
    v_cndmask_b32 v41, v45, v41, s[62:63]
    v_cndmask_b32 v42, v46, v42, s[64:65]
    v_mfma_f32_16x16x32_bf16 v[52:55], v[136:139], v[72:75], v[52:55]
    s_waitcnt lgkmcnt(2)
    ds_read_b128 v[72:75], v16 offset:10240
    v_cndmask_b32 v43, v47, v43, s[66:67]
    v_max3_f32 v44, v40, v41, v42
    v_max_f32 v44, v44, v43
    v_mfma_f32_16x16x32_bf16 v[52:55], v[148:151], v[76:79], v[52:55]
    s_waitcnt lgkmcnt(2)
    ds_read_b128 v[76:79], v16 offset:11264
    v_mov_b32 v45, v44
    v_mul_f32 v62, v108, v62
    v_mul_f32 v63, v109, v63
    v_mfma_f32_16x16x32_bf16 v[52:55], v[160:163], v[64:67], v[52:55]
    s_waitcnt lgkmcnt(2)
    ds_read_b128 v[64:67], v16 offset:12288
    v_permlane32_swap_b32 v45, v44
    v_max_f32 v44, v44, v45
    v_mfma_f32_16x16x32_bf16 v[52:55], v[172:175], v[68:71], v[52:55]
    s_waitcnt vmcnt(1)
    s_waitcnt lgkmcnt(2)
    buffer_store_dword v25, off, s[36:39], s83 offset:128
    ds_read_b128 v[68:71], v16 offset:13312
    v_mov_b32 v45, v44
    s_waitcnt vmcnt(1)
    v_cmp_gt_u32 vcc, s72, v29
    v_mfma_f32_16x16x32_bf16 v[52:55], v[184:187], v[72:75], v[52:55]
    s_cbranch_vccnz L_slow_51
L_back_52:
    s_add_u32 m0, s80, 49152
    s_waitcnt lgkmcnt(2)
    ds_read_b128 v[72:75], v16 offset:14336
    v_permlane16_swap_b32 v45, v44
    v_mfma_f32_16x16x32_bf16 v[52:55], v[196:199], v[76:79], v[52:55]
    s_waitcnt lgkmcnt(2)
    buffer_load_dwordx4 v16, s[36:39], s95 offen offset:0 sc1 lds
    ds_read_b128 v[76:79], v16 offset:15360
    v_max_f32 v44, v44, v45
    v_mul_f32 v44, v44, v89
    v_mfma_f32_16x16x32_bf16 v[52:55], v[208:211], v[64:67], v[52:55]
    s_waitcnt lgkmcnt(2)
    buffer_load_dwordx4 v16, s[36:39], s95 offen offset:1024 sc1 lds
    v_fma_f32 v40, v40, v89, -v44
    v_fma_f32 v41, v41, v89, -v44
    v_fma_f32 v42, v42, v89, -v44
    v_mfma_f32_16x16x32_bf16 v[52:55], v[220:223], v[68:71], v[52:55]
    s_waitcnt lgkmcnt(1)
    buffer_load_dwordx4 v16, s[36:39], s95 offen offset:2048 sc1 lds
    v_fma_f32 v43, v43, v89, -v44
    v_exp_f32 v40, v40
    v_mfma_f32_16x16x32_bf16 v[52:55], v[232:235], v[72:75], v[52:55]
    s_waitcnt lgkmcnt(0)
    buffer_load_dwordx4 v16, s[36:39], s95 offen offset:3072 sc1 lds
    v_exp_f32 v41, v41
    v_exp_f32 v42, v42
    v_mfma_f32_16x16x32_bf16 v[52:55], v[244:247], v[76:79], v[52:55]
    v_exp_f32 v43, v43
    v_cvt_pk_bf16_f32 v46, v40, v41
    v_cvt_pk_bf16_f32 v47, v42, v43
    v_cvt_pk_bf16_f32 v94, v60, v61
    v_cvt_pk_bf16_f32 v95, v62, v63
    v_and_b32 v50, v38, v46
    v_and_b32 v51, v39, v47
    v_xor_b32 v48, v50, v46
    v_xor_b32 v49, v51, v47
    s_nop 1
    v_mfma_f32_16x16x32_bf16 v[44:47], v[34:37], v[48:51], 0
    v_mfma_f32_16x16x32_bf16 v[40:43], v[94:97], v[48:51], 0
    v_fma_f32 v52, v115, v80, v52
    v_fma_f32 v53, v115, v81, v53
    v_fma_f32 v54, v115, v82, v54
    v_fma_f32 v55, v115, v83, v55
    v_cvt_pk_bf16_f32 v104, v52, v53
    v_cvt_pk_bf16_f32 v105, v54, v55
    v_mul_f32 v116, 0x3eb8aa3b, v114
    v_cmp_eq_u32 vcc, -1, v93
    v_rcp_f32 v44, v44
    s_nop 0
    v_mul_f32 v40, v44, v40
    v_mul_f32 v41, v44, v41
    v_mul_f32 v42, v44, v42
    s_cbranch_vccnz L_slow_54
L_back_55:
    s_add_u32 s85, s85, 0x8000
    v_mfma_f32_16x16x16_bf16 v[52:55], v[98:99], v[104:105], v[30:33]
    v_mfma_f32_16x16x16_bf16 v[56:59], v[90:91], v[104:105], v[118:121]
    v_mul_f32 v43, v44, v43
    v_cvt_pk_bf16_f32 v48, v40, v41
    v_cvt_pk_bf16_f32 v49, v42, v43
    buffer_store_dwordx2 v[48:49], v19, s[36:39], s89 offen offset:0
    s_nop 3
    v_cndmask_b32 v52, v56, v52, s[60:61]
    v_cndmask_b32 v53, v57, v53, s[62:63]
    v_cndmask_b32 v54, v58, v54, s[64:65]
    v_cndmask_b32 v55, v59, v55, s[66:67]
    v_max3_f32 v56, v52, v53, v54
    v_max_f32 v56, v56, v55
    v_mov_b32 v57, v56
    s_nop 1
    v_permlane32_swap_b32 v57, v56
    v_max_f32 v56, v56, v57
    v_mov_b32 v57, v56
    s_nop 1
    v_permlane16_swap_b32 v57, v56
    v_max_f32 v56, v56, v57
    v_mul_f32 v56, v56, v116
    buffer_load_dword v29, v22, s[36:39], s82 offen offset:128 sc1
    v_fma_f32 v52, v52, v116, -v56
    v_fma_f32 v53, v53, v116, -v56
    v_fma_f32 v54, v54, v116, -v56
    v_fma_f32 v55, v55, v116, -v56
    v_exp_f32 v52, v52
    v_exp_f32 v53, v53
    v_exp_f32 v54, v54
    v_exp_f32 v55, v55
    v_cvt_pk_bf16_f32 v58, v52, v53
    v_cvt_pk_bf16_f32 v59, v54, v55
    v_and_b32 v62, v38, v58
    v_and_b32 v63, v39, v59
    v_xor_b32 v60, v62, v58
    v_xor_b32 v61, v63, v59
    s_nop 1
    v_mfma_f32_16x16x32_bf16 v[56:59], v[34:37], v[60:63], 0
    v_mfma_f32_16x16x32_bf16 v[52:55], v[92:95], v[60:63], 0
    s_nop 6
    v_rcp_f32 v56, v56
    s_nop 0
    v_mul_f32 v52, v56, v52
    v_mul_f32 v53, v56, v53
    v_mul_f32 v54, v56, v54
    v_mul_f32 v55, v56, v55
    v_cvt_pk_bf16_f32 v60, v52, v53
    s_waitcnt vmcnt(1)
    buffer_store_dword v25, off, s[36:39], s83 offset:896
    v_cvt_pk_bf16_f32 v61, v54, v55
    buffer_store_dwordx2 v[60:61], v19, s[36:39], s88 offen offset:0
    s_waitcnt vmcnt(2)
    v_cmp_gt_u32 vcc, s72, v29
    s_cbranch_vccnz L_slow_57
L_back_58:
    s_add_u32 m0, s80, 32768
    s_nop 0
    buffer_load_dwordx4 v16, s[36:39], s94 offen offset:0 sc1 lds
    buffer_load_dwordx4 v16, s[36:39], s94 offen offset:1024 sc1 lds
    buffer_load_dwordx4 v16, s[36:39], s94 offen offset:2048 sc1 lds
    buffer_load_dwordx4 v16, s[36:39], s94 offen offset:3072 sc1 lds
    s_cmp_lt_u32 s72, 4
    s_cbranch_scc1 L_w
    s_barrier
    ds_read_b64_tr_b16 v[40:41], v18 offset:0
    ds_read_b64_tr_b16 v[42:43], v18 offset:256
    ds_read_b128 v[104:107], v16 offset:49152
    ds_read_b64_tr_b16 v[44:45], v18 offset:4224
    ds_read_b64_tr_b16 v[46:47], v18 offset:4480
    ds_read_b128 v[108:111], v16 offset:50176
    ds_read_b64_tr_b16 v[48:49], v18 offset:8448
    ds_read_b64_tr_b16 v[50:51], v18 offset:8704
    ds_read_b128 v[112:115], v16 offset:51200
    ds_read_b64_tr_b16 v[52:53], v18 offset:12672
    ds_read_b64_tr_b16 v[54:55], v18 offset:12928
    ds_read_b128 v[116:119], v16 offset:52224
    ds_read_b128 v[120:123], v16 offset:53248
    ds_read_b128 v[124:127], v16 offset:54272
    ds_read_b64_tr_b16 v[56:57], v18 offset:16896
    ds_read_b64_tr_b16 v[58:59], v18 offset:17152
    ds_read_b128 v[32:35], v16 offset:55296
    s_waitcnt lgkmcnt(14)
    v_mfma_f32_16x16x32_bf16 v[12:15], v[40:43], v[104:107], v[12:15]
    ds_read_b64_tr_b16 v[60:61], v18 offset:21120
    ds_read_b64_tr_b16 v[62:63], v18 offset:21376
    ds_read_b128 v[104:107], v16 offset:56320
    s_waitcnt lgkmcnt(14)
    v_mfma_f32_16x16x32_bf16 v[12:15], v[44:47], v[108:111], v[12:15]
    ds_read_b64_tr_b16 v[64:65], v18 offset:25344
    ds_read_b64_tr_b16 v[66:67], v18 offset:25600
    ds_read_b128 v[108:111], v16 offset:57344
    s_waitcnt vmcnt(4)
    buffer_store_dword v25, off, s[36:39], s83 offset:256
    buffer_load_dword v29, v22, s[36:39], s82 offen offset:896 sc1
    s_waitcnt lgkmcnt(14)
    v_mfma_f32_16x16x32_bf16 v[12:15], v[48:51], v[112:115], v[12:15]
    ds_read_b64_tr_b16 v[68:69], v18 offset:29568
    ds_read_b64_tr_b16 v[70:71], v18 offset:29824
    ds_read_b128 v[112:115], v16 offset:58368
    s_waitcnt lgkmcnt(14)
    v_mfma_f32_16x16x32_bf16 v[12:15], v[52:55], v[116:119], v[12:15]
    ds_read_b64_tr_b16 v[72:73], v18 offset:33792
    ds_read_b64_tr_b16 v[74:75], v18 offset:34048
    ds_read_b128 v[116:119], v16 offset:59392
    s_waitcnt lgkmcnt(13)
    v_mfma_f32_16x16x32_bf16 v[12:15], v[56:59], v[120:123], v[12:15]
    ds_read_b64_tr_b16 v[76:77], v18 offset:38016
    ds_read_b64_tr_b16 v[78:79], v18 offset:38272
    ds_read_b128 v[120:123], v16 offset:60416
    s_waitcnt lgkmcnt(13)
    v_mfma_f32_16x16x32_bf16 v[12:15], v[60:63], v[124:127], v[12:15]
    ds_read_b64_tr_b16 v[80:81], v18 offset:42240
    ds_read_b64_tr_b16 v[82:83], v18 offset:42496
    ds_read_b128 v[124:127], v16 offset:61440
    s_waitcnt lgkmcnt(13)
    v_mfma_f32_16x16x32_bf16 v[12:15], v[64:67], v[32:35], v[12:15]
    ds_read_b64_tr_b16 v[84:85], v18 offset:46464
    ds_read_b64_tr_b16 v[86:87], v18 offset:46720
    ds_read_b128 v[32:35], v16 offset:62464
    s_waitcnt lgkmcnt(13)
    v_mfma_f32_16x16x32_bf16 v[12:15], v[68:71], v[104:107], v[12:15]
    ds_read_b64_tr_b16 v[88:89], v18 offset:50688
    ds_read_b64_tr_b16 v[90:91], v18 offset:50944
    ds_read_b128 v[104:107], v16 offset:63488
    s_waitcnt vmcnt(0)
    v_cmp_gt_u32 vcc, s72, v29
    s_add_u32 m0, s80, 16384
    s_waitcnt lgkmcnt(13)
    v_mfma_f32_16x16x32_bf16 v[12:15], v[72:75], v[108:111], v[12:15]
    ds_read_b64_tr_b16 v[92:93], v18 offset:54912
    ds_read_b64_tr_b16 v[94:95], v18 offset:55168
    ds_read_b128 v[108:111], v16 offset:64512
    s_waitcnt lgkmcnt(13)
    v_mfma_f32_16x16x32_bf16 v[12:15], v[76:79], v[112:115], v[12:15]
    ds_read_b64_tr_b16 v[96:97], v18 offset:59136
    ds_read_b64_tr_b16 v[98:99], v18 offset:59392
    s_cbranch_vccnz L_slow_63
L_back_64:
    buffer_load_dwordx4 v16, s[36:39], s93 offen offset:0 sc1 lds
    s_waitcnt lgkmcnt(12)
    v_mfma_f32_16x16x32_bf16 v[12:15], v[80:83], v[116:119], v[12:15]
    ds_read_b64_tr_b16 v[100:101], v18 offset:63360
    ds_read_b64_tr_b16 v[102:103], v18 offset:63616
    s_waitcnt lgkmcnt(11)
    v_mfma_f32_16x16x32_bf16 v[12:15], v[84:87], v[120:123], v[12:15]
    buffer_load_dwordx4 v16, s[36:39], s93 offen offset:1024 sc1 lds
    s_waitcnt lgkmcnt(8)
    v_mfma_f32_16x16x32_bf16 v[12:15], v[88:91], v[124:127], v[12:15]
    buffer_load_dword v29, v22, s[36:39], s82 offen offset:256 sc1
    s_waitcnt lgkmcnt(5)
    v_mfma_f32_16x16x32_bf16 v[12:15], v[92:95], v[32:35], v[12:15]
    buffer_load_dwordx4 v16, s[36:39], s93 offen offset:2048 sc1 lds
    s_waitcnt lgkmcnt(2)
    v_mfma_f32_16x16x32_bf16 v[12:15], v[96:99], v[104:107], v[12:15]
    s_waitcnt lgkmcnt(0)
    v_mfma_f32_16x16x32_bf16 v[12:15], v[100:103], v[108:111], v[12:15]
    s_barrier
    ds_read_b128 v[112:115], v16 offset:32768
    ds_read_b128 v[116:119], v16 offset:33792
    ds_read_b128 v[120:123], v16 offset:34816
    ds_read_b128 v[124:127], v16 offset:35840
    ds_read_b128 v[32:35], v16 offset:36864
    ds_read_b128 v[104:107], v16 offset:37888
    ds_read_b128 v[108:111], v16 offset:38912
    buffer_load_dwordx4 v16, s[36:39], s93 offen offset:3072 sc1 lds
    s_waitcnt lgkmcnt(6)
    v_mfma_f32_16x16x32_bf16 v[8:11], v[40:43], v[112:115], v[8:11]
    ds_read_b128 v[112:115], v16 offset:39936
    s_waitcnt lgkmcnt(6)
    v_mfma_f32_16x16x32_bf16 v[8:11], v[44:47], v[116:119], v[8:11]
    ds_read_b128 v[116:119], v16 offset:40960
    s_waitcnt lgkmcnt(6)
    v_mfma_f32_16x16x32_bf16 v[8:11], v[48:51], v[120:123], v[8:11]
    ds_read_b128 v[120:123], v16 offset:41984
    s_waitcnt lgkmcnt(6)
    v_mfma_f32_16x16x32_bf16 v[8:11], v[52:55], v[124:127], v[8:11]
    ds_read_b128 v[124:127], v16 offset:43008
    s_waitcnt lgkmcnt(6)
    v_mfma_f32_16x16x32_bf16 v[8:11], v[56:59], v[32:35], v[8:11]
    ds_read_b128 v[32:35], v16 offset:44032
    s_waitcnt vmcnt(2)
    v_cmp_gt_u32 vcc, s72, v29
    s_add_u32 m0, s80, 0
    s_waitcnt lgkmcnt(6)
    v_mfma_f32_16x16x32_bf16 v[8:11], v[60:63], v[104:107], v[8:11]
    ds_read_b128 v[104:107], v16 offset:45056
    s_waitcnt lgkmcnt(6)
    v_mfma_f32_16x16x32_bf16 v[8:11], v[64:67], v[108:111], v[8:11]
    ds_read_b128 v[108:111], v16 offset:46080
    s_cbranch_vccnz L_slow_60
L_back_61:
    buffer_load_dwordx4 v16, s[36:39], s92 offen offset:0 sc1 lds
    s_waitcnt lgkmcnt(6)
    v_mfma_f32_16x16x32_bf16 v[8:11], v[68:71], v[112:115], v[8:11]
    ds_read_b128 v[112:115], v16 offset:47104
    s_waitcnt lgkmcnt(6)
    v_mfma_f32_16x16x32_bf16 v[8:11], v[72:75], v[116:119], v[8:11]
    ds_read_b128 v[116:119], v16 offset:48128
    buffer_load_dwordx4 v16, s[36:39], s92 offen offset:1024 sc1 lds
    s_waitcnt lgkmcnt(6)
    v_mfma_f32_16x16x32_bf16 v[8:11], v[76:79], v[120:123], v[8:11]
    s_waitcnt lgkmcnt(5)
    v_mfma_f32_16x16x32_bf16 v[8:11], v[80:83], v[124:127], v[8:11]
    buffer_load_dwordx4 v16, s[36:39], s92 offen offset:2048 sc1 lds
    s_waitcnt lgkmcnt(4)
    v_mfma_f32_16x16x32_bf16 v[8:11], v[84:87], v[32:35], v[8:11]
    v_bfe_u32 v30, v16, 4, 5
    s_waitcnt lgkmcnt(3)
    v_mfma_f32_16x16x32_bf16 v[8:11], v[88:91], v[104:107], v[8:11]
    buffer_load_dwordx4 v16, s[36:39], s92 offen offset:3072 sc1 lds
    v_lshrrev_b32 v31, 9, v16
    s_lshl_b32 s74, s69, 2
    s_add_u32 s74, s74, s68
    s_waitcnt lgkmcnt(2)
    v_mfma_f32_16x16x32_bf16 v[8:11], v[92:95], v[108:111], v[8:11]
    s_lshl_b32 s74, s74, 5
    v_lshl_add_u32 v30, v30, 11, s74
    v_lshl_add_u32 v20, v31, 4, v30
    s_add_u32 s75, s71, 0x10000
    s_waitcnt lgkmcnt(1)
    v_mfma_f32_16x16x32_bf16 v[8:11], v[96:99], v[112:115], v[8:11]
    s_waitcnt lgkmcnt(0)
    v_mfma_f32_16x16x32_bf16 v[8:11], v[100:103], v[116:119], v[8:11]
    v_cvt_pk_bf16_f32 v38, v12, v13
    v_cvt_pk_bf16_f32 v39, v14, v15
    s_nop 5
    v_cvt_pk_bf16_f32 v36, v8, v9
    v_cvt_pk_bf16_f32 v37, v10, v11
    s_nop 0
    v_permlane16_swap_b32 v36, v38
    v_permlane16_swap_b32 v37, v39
    buffer_store_dwordx4 v[36:39], v20, s[28:31], s75 offen
    s_waitcnt vmcnt(5)
    s_barrier
    ds_read_b128 v[120:123], v16 offset:16384
    ds_read_b128 v[124:127], v16 offset:17408
    ds_read_b128 v[32:35], v16 offset:18432
    ds_read_b128 v[104:107], v16 offset:19456
    ds_read_b128 v[108:111], v16 offset:20480
    ds_read_b128 v[112:115], v16 offset:21504
    ds_read_b128 v[116:119], v16 offset:22528
    s_waitcnt lgkmcnt(6)
    v_mfma_f32_16x16x32_bf16 v[4:7], v[40:43], v[120:123], v[4:7]
    ds_read_b128 v[120:123], v16 offset:23552
    s_waitcnt lgkmcnt(6)
    v_mfma_f32_16x16x32_bf16 v[4:7], v[44:47], v[124:127], v[4:7]
    ds_read_b128 v[124:127], v16 offset:24576
    s_waitcnt lgkmcnt(6)
    v_mfma_f32_16x16x32_bf16 v[4:7], v[48:51], v[32:35], v[4:7]
    ds_read_b128 v[32:35], v16 offset:25600
    s_waitcnt lgkmcnt(6)
    v_mfma_f32_16x16x32_bf16 v[4:7], v[52:55], v[104:107], v[4:7]
    ds_read_b128 v[104:107], v16 offset:26624
    s_waitcnt lgkmcnt(6)
    v_mfma_f32_16x16x32_bf16 v[4:7], v[56:59], v[108:111], v[4:7]
    ds_read_b128 v[108:111], v16 offset:27648
    s_waitcnt lgkmcnt(6)
    v_mfma_f32_16x16x32_bf16 v[4:7], v[60:63], v[112:115], v[4:7]
    ds_read_b128 v[112:115], v16 offset:28672
    s_waitcnt lgkmcnt(6)
    v_mfma_f32_16x16x32_bf16 v[4:7], v[64:67], v[116:119], v[4:7]
    ds_read_b128 v[116:119], v16 offset:29696
    s_waitcnt lgkmcnt(6)
    v_mfma_f32_16x16x32_bf16 v[4:7], v[68:71], v[120:123], v[4:7]
    ds_read_b128 v[120:123], v16 offset:30720
    s_waitcnt lgkmcnt(6)
    v_mfma_f32_16x16x32_bf16 v[4:7], v[72:75], v[124:127], v[4:7]
    ds_read_b128 v[124:127], v16 offset:31744
    s_waitcnt lgkmcnt(6)
    v_mfma_f32_16x16x32_bf16 v[4:7], v[76:79], v[32:35], v[4:7]
    s_waitcnt vmcnt(1)
    s_barrier
    ds_read_b128 v[32:35], v16 offset:0
    s_waitcnt lgkmcnt(6)
    v_mfma_f32_16x16x32_bf16 v[4:7], v[80:83], v[104:107], v[4:7]
    ds_read_b128 v[104:107], v16 offset:1024
    s_waitcnt lgkmcnt(6)
    v_mfma_f32_16x16x32_bf16 v[4:7], v[84:87], v[108:111], v[4:7]
    ds_read_b128 v[108:111], v16 offset:2048
    s_waitcnt lgkmcnt(6)
    v_mfma_f32_16x16x32_bf16 v[4:7], v[88:91], v[112:115], v[4:7]
    ds_read_b128 v[112:115], v16 offset:3072
    s_waitcnt lgkmcnt(6)
    v_mfma_f32_16x16x32_bf16 v[4:7], v[92:95], v[116:119], v[4:7]
    ds_read_b128 v[116:119], v16 offset:4096
    s_waitcnt lgkmcnt(6)
    v_mfma_f32_16x16x32_bf16 v[4:7], v[96:99], v[120:123], v[4:7]
    ds_read_b128 v[120:123], v16 offset:5120
    s_waitcnt lgkmcnt(6)
    v_mfma_f32_16x16x32_bf16 v[4:7], v[100:103], v[124:127], v[4:7]
    ds_read_b128 v[124:127], v16 offset:6144
    s_waitcnt lgkmcnt(6)
    v_mfma_f32_16x16x32_bf16 v[0:3], v[40:43], v[32:35], v[0:3]
    ds_read_b128 v[32:35], v16 offset:7168
    s_waitcnt lgkmcnt(6)
    v_mfma_f32_16x16x32_bf16 v[0:3], v[44:47], v[104:107], v[0:3]
    ds_read_b128 v[104:107], v16 offset:8192
    s_waitcnt lgkmcnt(6)
    v_mfma_f32_16x16x32_bf16 v[0:3], v[48:51], v[108:111], v[0:3]
    ds_read_b128 v[108:111], v16 offset:9216
    v_cvt_pk_bf16_f32 v38, v4, v5
    v_cvt_pk_bf16_f32 v39, v6, v7
    s_waitcnt lgkmcnt(6)
    v_mfma_f32_16x16x32_bf16 v[0:3], v[52:55], v[112:115], v[0:3]
    ds_read_b128 v[112:115], v16 offset:10240
    s_waitcnt lgkmcnt(6)
    v_mfma_f32_16x16x32_bf16 v[0:3], v[56:59], v[116:119], v[0:3]
    ds_read_b128 v[116:119], v16 offset:11264
    s_waitcnt lgkmcnt(6)
    v_mfma_f32_16x16x32_bf16 v[0:3], v[60:63], v[120:123], v[0:3]
    ds_read_b128 v[120:123], v16 offset:12288
    s_waitcnt lgkmcnt(6)
    v_mfma_f32_16x16x32_bf16 v[0:3], v[64:67], v[124:127], v[0:3]
    ds_read_b128 v[124:127], v16 offset:13312
    s_waitcnt lgkmcnt(6)
    v_mfma_f32_16x16x32_bf16 v[0:3], v[68:71], v[32:35], v[0:3]
    ds_read_b128 v[32:35], v16 offset:14336
    s_waitcnt lgkmcnt(6)
    v_mfma_f32_16x16x32_bf16 v[0:3], v[72:75], v[104:107], v[0:3]
    ds_read_b128 v[104:107], v16 offset:15360
    s_waitcnt lgkmcnt(6)
    v_mfma_f32_16x16x32_bf16 v[0:3], v[76:79], v[108:111], v[0:3]
    s_waitcnt lgkmcnt(5)
    v_mfma_f32_16x16x32_bf16 v[0:3], v[80:83], v[112:115], v[0:3]
    s_waitcnt lgkmcnt(4)
    v_mfma_f32_16x16x32_bf16 v[0:3], v[84:87], v[116:119], v[0:3]
    s_waitcnt lgkmcnt(3)
    v_mfma_f32_16x16x32_bf16 v[0:3], v[88:91], v[120:123], v[0:3]
    s_waitcnt lgkmcnt(2)
    v_mfma_f32_16x16x32_bf16 v[0:3], v[92:95], v[124:127], v[0:3]
    s_waitcnt lgkmcnt(1)
    v_mfma_f32_16x16x32_bf16 v[0:3], v[96:99], v[32:35], v[0:3]
    s_waitcnt lgkmcnt(0)
    v_mfma_f32_16x16x32_bf16 v[0:3], v[100:103], v[104:107], v[0:3]
    s_nop 7
    v_cvt_pk_bf16_f32 v36, v0, v1
    v_cvt_pk_bf16_f32 v37, v2, v3
    s_nop 0
    v_permlane16_swap_b32 v36, v38
    v_permlane16_swap_b32 v37, v39
    buffer_store_dwordx4 v[36:39], v20, s[28:31], s71 offen
    s_endpgm
L_slow_3:
    s_mov_b32 s73, 0
L_spin_5:
    buffer_load_dword v29, off, s[36:39], s58 offset:1024 sc1
    s_waitcnt vmcnt(0)
    v_cmp_ne_u32 vcc, 1, v29
    s_cbranch_vccz L_back_4
    s_add_u32 s73, s73, 1
    s_cmp_lt_u32 s73, 262144
    s_cbranch_scc1 L_spin_5
    s_endpgm
L_slow_6:
    s_mov_b32 s73, 0
L_spin_8:
    buffer_load_dword v29, v20, s[32:35], 0 offen sc1
    s_waitcnt vmcnt(0)
    v_and_b32 v117, 15, v29
    v_cmp_ne_u32 vcc, 8, v117
    s_cbranch_vccz L_back_7
    s_add_u32 s73, s73, 1
    s_cmp_lt_u32 s73, 262144
    s_cbranch_scc1 L_spin_8
    s_endpgm
L_slow_9:
    s_mov_b32 s73, 0
L_spin_11:
    buffer_load_dwordx4 v[90:93], v16, s[36:39], s85 offen sc1
    s_waitcnt vmcnt(0)
    v_cmp_eq_u32 vcc, -1, v93
    s_cbranch_vccz L_back_10
    s_add_u32 s73, s73, 1
    s_cmp_lt_u32 s73, 262144
    s_cbranch_scc1 L_spin_11
    s_endpgm
L_slow_12:
    s_mov_b32 s73, 0
L_spin_14:
    buffer_load_dword v29, v22, s[36:39], s82 offen offset:0 sc1
    s_waitcnt vmcnt(0)
    v_cmp_gt_u32 vcc, s72, v29
    s_cbranch_vccz L_back_13
    s_add_u32 s73, s73, 1
    s_cmp_lt_u32 s73, 262144
    s_cbranch_scc1 L_spin_14
    s_endpgm
L_slow_15:
    s_mov_b32 s73, 0
L_spin_17:
    buffer_load_dword v29, v22, s[36:39], s82 offen offset:256 sc1
    s_waitcnt vmcnt(0)
    v_cmp_gt_u32 vcc, s72, v29
    s_cbranch_vccz L_back_16
    s_add_u32 s73, s73, 1
    s_cmp_lt_u32 s73, 262144
    s_cbranch_scc1 L_spin_17
    s_endpgm
L_slow_18:
    s_mov_b32 s73, 0
L_spin_20:
    buffer_load_dword v29, v22, s[36:39], s82 offen offset:384 sc1
    s_waitcnt vmcnt(0)
    v_cmp_gt_u32 vcc, s72, v29
    s_cbranch_vccz L_back_19
    s_add_u32 s73, s73, 1
    s_cmp_lt_u32 s73, 262144
    s_cbranch_scc1 L_spin_20
    s_endpgm
L_slow_21:
    s_mov_b32 s73, 0
L_spin_23:
    buffer_load_dword v29, v22, s[36:39], s82 offen offset:896 sc1
    s_waitcnt vmcnt(0)
    v_cmp_gt_u32 vcc, s72, v29
    s_cbranch_vccz L_back_22
    s_add_u32 s73, s73, 1
    s_cmp_lt_u32 s73, 262144
    s_cbranch_scc1 L_spin_23
    s_endpgm
L_slow_24:
    s_mov_b32 s73, 0
L_spin_26:
    buffer_load_dword v29, v22, s[36:39], s82 offen offset:512 sc1
    s_waitcnt vmcnt(0)
    v_cmp_gt_u32 vcc, s72, v29
    s_cbranch_vccz L_back_25
    s_add_u32 s73, s73, 1
    s_cmp_lt_u32 s73, 262144
    s_cbranch_scc1 L_spin_26
    s_endpgm
L_slow_27:
    s_mov_b32 s73, 0
L_spin_29:
    buffer_load_dword v29, v22, s[36:39], s82 offen offset:640 sc1
    s_waitcnt vmcnt(0)
    v_cmp_gt_u32 vcc, s72, v29
    s_cbranch_vccz L_back_28
    s_add_u32 s73, s73, 1
    s_cmp_lt_u32 s73, 262144
    s_cbranch_scc1 L_spin_29
    s_endpgm
L_slow_30:
    s_mov_b32 s73, 0
L_spin_32:
    buffer_load_dword v29, v22, s[36:39], s82 offen offset:768 sc1
    s_waitcnt vmcnt(0)
    v_cmp_gt_u32 vcc, s72, v29
    s_cbranch_vccz L_back_31
    s_add_u32 s73, s73, 1
    s_cmp_lt_u32 s73, 262144
    s_cbranch_scc1 L_spin_32
    s_endpgm
L_slow_33:
    s_mov_b32 s73, 0
L_spin_35:
    buffer_load_dword v29, v22, s[36:39], s82 offen offset:0 sc1
    s_waitcnt vmcnt(0)
    v_cmp_gt_u32 vcc, s72, v29
    s_cbranch_vccz L_back_34
    s_add_u32 s73, s73, 1
    s_cmp_lt_u32 s73, 262144
    s_cbranch_scc1 L_spin_35
    s_endpgm
L_slow_36:
    s_mov_b32 s73, 0
L_spin_38:
    buffer_load_dwordx4 v[90:93], v16, s[36:39], s85 offen sc1
    s_waitcnt vmcnt(0)
    v_cmp_eq_u32 vcc, -1, v93
    s_cbranch_vccz L_back_37
    s_add_u32 s73, s73, 1
    s_cmp_lt_u32 s73, 262144
    s_cbranch_scc1 L_spin_38
    s_endpgm
L_slow_39:
    s_mov_b32 s73, 0
L_spin_41:
    buffer_load_dword v29, v22, s[36:39], s82 offen offset:128 sc1
    s_waitcnt vmcnt(0)
    v_cmp_gt_u32 vcc, s72, v29
    s_cbranch_vccz L_back_40
    s_add_u32 s73, s73, 1
    s_cmp_lt_u32 s73, 262144
    s_cbranch_scc1 L_spin_41
    s_endpgm
L_slow_42:
    s_mov_b32 s73, 0
L_spin_44:
    buffer_load_dword v29, v22, s[36:39], s82 offen offset:512 sc1
    s_waitcnt vmcnt(0)
    v_cmp_gt_u32 vcc, s72, v29
    s_cbranch_vccz L_back_43
    s_add_u32 s73, s73, 1
    s_cmp_lt_u32 s73, 262144
    s_cbranch_scc1 L_spin_44
    s_endpgm
L_slow_45:
    s_mov_b32 s73, 0
L_spin_47:
    buffer_load_dword v29, v22, s[36:39], s82 offen offset:640 sc1
    s_waitcnt vmcnt(0)
    v_cmp_gt_u32 vcc, s72, v29
    s_cbranch_vccz L_back_46
    s_add_u32 s73, s73, 1
    s_cmp_lt_u32 s73, 262144
    s_cbranch_scc1 L_spin_47
    s_endpgm
L_slow_48:
    s_mov_b32 s73, 0
L_spin_50:
    buffer_load_dword v29, v22, s[36:39], s82 offen offset:768 sc1
    s_waitcnt vmcnt(0)
    v_cmp_gt_u32 vcc, s72, v29
    s_cbranch_vccz L_back_49
    s_add_u32 s73, s73, 1
    s_cmp_lt_u32 s73, 262144
    s_cbranch_scc1 L_spin_50
    s_endpgm
L_slow_51:
    s_mov_b32 s73, 0
L_spin_53:
    buffer_load_dword v29, v22, s[36:39], s82 offen offset:0 sc1
    s_waitcnt vmcnt(0)
    v_cmp_gt_u32 vcc, s72, v29
    s_cbranch_vccz L_back_52
    s_add_u32 s73, s73, 1
    s_cmp_lt_u32 s73, 262144
    s_cbranch_scc1 L_spin_53
    s_endpgm
L_slow_54:
    s_mov_b32 s73, 0
L_spin_56:
    buffer_load_dwordx4 v[90:93], v16, s[36:39], s85 offen sc1
    s_waitcnt vmcnt(0)
    v_cmp_eq_u32 vcc, -1, v93
    s_cbranch_vccz L_back_55
    s_add_u32 s73, s73, 1
    s_cmp_lt_u32 s73, 262144
    s_cbranch_scc1 L_spin_56
    s_endpgm
L_slow_57:
    s_mov_b32 s73, 0
L_spin_59:
    buffer_load_dword v29, v22, s[36:39], s82 offen offset:128 sc1
    s_waitcnt vmcnt(0)
    v_cmp_gt_u32 vcc, s72, v29
    s_cbranch_vccz L_back_58
    s_add_u32 s73, s73, 1
    s_cmp_lt_u32 s73, 262144
    s_cbranch_scc1 L_spin_59
    s_endpgm
L_slow_60:
    s_mov_b32 s73, 0
L_spin_62:
    buffer_load_dword v29, v22, s[36:39], s82 offen offset:256 sc1
    s_waitcnt vmcnt(0)
    v_cmp_gt_u32 vcc, s72, v29
    s_cbranch_vccz L_back_61
    s_add_u32 s73, s73, 1
    s_cmp_lt_u32 s73, 262144
    s_cbranch_scc1 L_spin_62
    s_endpgm
L_slow_63:
    s_mov_b32 s73, 0
L_spin_65:
    buffer_load_dword v29, v22, s[36:39], s82 offen offset:896 sc1
    s_waitcnt vmcnt(0)
    v_cmp_gt_u32 vcc, s72, v29
    s_cbranch_vccz L_back_64
    s_add_u32 s73, s73, 1
    s_cmp_lt_u32 s73, 262144
    s_cbranch_scc1 L_spin_65
    s_endpgm
L_q0S:
    v_mfma_f32_16x16x32_bf16 v[60:63], v[68:71], a[68:71], v[60:63]
    s_waitcnt lgkmcnt(2)
    ds_read2_b32 v[114:115], v23 offset0:32 offset1:96
    ds_read_b128 v[106:109], v24 offset:128
    ds_read_b128 v[110:113], v24 offset:384
    v_mfma_f32_16x16x32_bf16 v[52:55], a[72:75], v[72:75], v[52:55]
    ds_read_b128 v[68:71], v119 offset:40960
    v_mfma_f32_16x16x32_bf16 v[56:59], a[76:79], v[72:75], v[56:59]
    v_mfma_f32_16x16x32_bf16 v[60:63], v[72:75], a[80:83], v[60:63]
    s_waitcnt lgkmcnt(5)
    v_mfma_f32_16x16x32_bf16 v[52:55], a[84:87], v[76:79], v[52:55]
    ds_read_b128 v[72:75], v118 offset:43008
    v_mfma_f32_16x16x32_bf16 v[56:59], a[88:91], v[76:79], v[56:59]
    v_mfma_f32_16x16x32_bf16 v[60:63], v[76:79], a[92:95], v[60:63]
    s_waitcnt lgkmcnt(5)
    v_mfma_f32_16x16x32_bf16 v[52:55], a[96:99], v[64:67], v[52:55]
    ds_read_b128 v[76:79], v119 offset:43008
    v_mfma_f32_16x16x32_bf16 v[56:59], a[100:103], v[64:67], v[56:59]
    v_mfma_f32_16x16x32_bf16 v[60:63], v[64:67], a[104:107], v[60:63]
    s_waitcnt lgkmcnt(2)
    v_mfma_f32_16x16x32_bf16 v[52:55], a[108:111], v[68:71], v[52:55]
    ds_read_b128 v[64:67], v118 offset:45056
    v_mfma_f32_16x16x32_bf16 v[56:59], a[112:115], v[68:71], v[56:59]
    v_mfma_f32_16x16x32_bf16 v[60:63], v[68:71], a[116:119], v[60:63]
    s_waitcnt lgkmcnt(2)
    buffer_load_dword v29, off, s[36:39], s58 offset:1024 sc1
    v_mfma_f32_16x16x32_bf16 v[52:55], a[120:123], v[72:75], v[52:55]
    s_add_u32 s3, s19, 393216
    s_and_b32 s3, s3, 0x7ffff
    s_add_u32 m0, s81, 116224
    ds_read_b128 v[68:71], v119 offset:45056
    v_mfma_f32_16x16x32_bf16 v[56:59], a[124:127], v[72:75], v[56:59]
    buffer_load_dwordx4 v17, s[40:43], s3 offen offset:0 lds
    v_mfma_f32_16x16x32_bf16 v[60:63], v[72:75], a[128:131], v[60:63]
    s_waitcnt lgkmcnt(2)
    v_mfma_f32_16x16x32_bf16 v[52:55], a[132:135], v[76:79], v[52:55]
    s_add_u32 m0, s81, 116256
    ds_read_b128 v[72:75], v118 offset:47104
    v_mfma_f32_16x16x32_bf16 v[56:59], a[136:139], v[76:79], v[56:59]
    buffer_load_dwordx4 v17, s[40:43], s3 offen offset:1024 lds
    v_mfma_f32_16x16x32_bf16 v[60:63], v[76:79], a[140:143], v[60:63]
    s_waitcnt lgkmcnt(2)
    v_mfma_f32_16x16x32_bf16 v[52:55], a[144:147], v[64:67], v[52:55]
    s_add_u32 m0, s81, 116288
    ds_read_b128 v[76:79], v119 offset:47104
    v_mfma_f32_16x16x32_bf16 v[56:59], a[148:151], v[64:67], v[56:59]
    buffer_load_dwordx4 v17, s[40:43], s3 offen offset:2048 lds
    v_mfma_f32_16x16x32_bf16 v[60:63], v[64:67], a[152:155], v[60:63]
    s_waitcnt lgkmcnt(2)
    v_mfma_f32_16x16x32_bf16 v[52:55], a[156:159], v[68:71], v[52:55]
    s_add_u32 m0, s81, 116320
    ds_read_b128 v[64:67], v118 offset:16384
    v_mfma_f32_16x16x32_bf16 v[56:59], a[160:163], v[68:71], v[56:59]
    buffer_load_dwordx4 v17, s[40:43], s3 offen offset:3072 lds
    v_mfma_f32_16x16x32_bf16 v[60:63], v[68:71], a[164:167], v[60:63]
    s_waitcnt vmcnt(17)
    s_waitcnt lgkmcnt(2)
    v_mov_b32 v126, v125
    v_mov_b32 v127, 0
    v_mfma_f32_16x16x32_bf16 v[52:55], a[168:171], v[72:75], v[52:55]
    ds_read_b128 v[68:71], v119 offset:16384
    v_mfma_f32_16x16x32_bf16 v[56:59], a[172:175], v[72:75], v[56:59]
    buffer_load_dword v124, v124, s[36:39], s88 offen sc1
    v_mfma_f32_16x16x32_bf16 v[60:63], v[72:75], a[176:179], v[60:63]
    s_waitcnt lgkmcnt(2)
    v_lshl_add_u64 v[126:127], v[126:127], 0, s[52:53]
    v_mfma_f32_16x16x32_bf16 v[52:55], a[180:183], v[76:79], v[52:55]
    ds_read_b128 v[72:75], v118 offset:18432
    v_mfma_f32_16x16x32_bf16 v[56:59], a[184:187], v[76:79], v[56:59]
    global_load_dword v126, v[126:127], off
    v_mfma_f32_16x16x32_bf16 v[60:63], v[76:79], a[188:191], v[60:63]
    s_waitcnt lgkmcnt(2)
    v_mfma_f32_16x16x32_bf16 v[40:43], a[0:3], v[64:67], 0
    ds_read_b128 v[76:79], v119 offset:18432
    v_mfma_f32_16x16x32_bf16 v[44:47], a[4:7], v[64:67], 0
    v_mfma_f32_16x16x32_bf16 v[48:51], v[64:67], a[8:11], 0
    s_waitcnt lgkmcnt(2)
    v_fma_f32 v56, v115, v84, v56
    v_fma_f32 v57, v115, v85, v57
    v_fma_f32 v58, v115, v86, v58
    v_mfma_f32_16x16x32_bf16 v[40:43], a[12:15], v[68:71], v[40:43]
    ds_read_b128 v[64:67], v118 offset:20480
    v_fma_f32 v59, v115, v87, v59
    v_mul_f32 v56, v114, v56
    v_mfma_f32_16x16x32_bf16 v[44:47], a[16:19], v[68:71], v[44:47]
    v_mul_f32 v57, v114, v57
    v_mul_f32 v58, v114, v58
    v_mfma_f32_16x16x32_bf16 v[48:51], v[68:71], a[20:23], v[48:51]
    s_waitcnt lgkmcnt(2)
    v_mul_f32 v59, v114, v59
    v_cvt_pk_bf16_f32 v98, v56, v57
    v_cvt_pk_bf16_f32 v99, v58, v59
    v_mfma_f32_16x16x32_bf16 v[40:43], a[24:27], v[72:75], v[40:43]
    ds_read_b128 v[68:71], v119 offset:20480
    v_fma_f32 v52, v115, v80, v52
    v_mfma_f32_16x16x32_bf16 v[44:47], a[28:31], v[72:75], v[44:47]
    v_fma_f32 v53, v115, v81, v53
    v_fma_f32 v54, v115, v82, v54
    v_min_u32 v93, -2, v93
    v_mfma_f32_16x16x32_bf16 v[48:51], v[72:75], a[32:35], v[48:51]
    s_waitcnt lgkmcnt(2)
    buffer_store_dwordx4 v[90:93], v16, s[36:39], s84 offen sc1
    v_mov_b32 v117, -1
    v_mfma_f32_16x16x32_bf16 v[40:43], a[36:39], v[76:79], v[40:43]
    ds_read_b128 v[72:75], v118 offset:22528
    v_fma_f32 v55, v115, v83, v55
    v_cvt_pk_bf16_f32 v104, v52, v53
    v_mfma_f32_16x16x32_bf16 v[44:47], a[40:43], v[76:79], v[44:47]
    s_add_u32 s75, s84, 0x10000
    buffer_store_dwordx4 v[114:117], v16, s[36:39], s75 offen sc1
    s_add_u32 s84, s84, 0x8000
    v_mfma_f32_16x16x32_bf16 v[48:51], v[76:79], a[44:47], v[48:51]
    s_waitcnt lgkmcnt(2)
    v_cvt_pk_bf16_f32 v105, v54, v55
    v_mul_f32 v116, 0x3eb8aa3b, v114
    v_mfma_f32_16x16x16_bf16 v[52:55], v[90:91], v[102:103], v[30:33]
    v_mfma_f32_16x16x16_bf16 v[56:59], v[98:99], v[102:103], v[30:33]
    v_fma_f32 v60, v110, v88, v60
    v_fma_f32 v61, v111, v88, v61
    v_fma_f32 v62, v112, v88, v62
    v_mfma_f32_16x16x32_bf16 v[40:43], a[48:51], v[64:67], v[40:43]
    ds_read_b128 v[76:79], v119 offset:22528
    v_fma_f32 v63, v113, v88, v63
    v_mul_f32 v60, v106, v60
    v_mfma_f32_16x16x32_bf16 v[44:47], a[52:55], v[64:67], v[44:47]
    v_cndmask_b32 v52, v56, v52, s[60:61]
    v_cndmask_b32 v53, v57, v53, s[62:63]
    v_mfma_f32_16x16x32_bf16 v[48:51], v[64:67], a[56:59], v[48:51]
    s_waitcnt lgkmcnt(2)
    v_cndmask_b32 v54, v58, v54, s[64:65]
    v_cndmask_b32 v55, v59, v55, s[66:67]
    v_max3_f32 v56, v52, v53, v54
    v_mfma_f32_16x16x32_bf16 v[40:43], a[60:63], v[68:71], v[40:43]
    ds_read_b128 v[64:67], v118 offset:24576
    v_max_f32 v56, v56, v55
    v_mfma_f32_16x16x32_bf16 v[44:47], a[64:67], v[68:71], v[44:47]
    v_mov_b32 v57, v56
    v_mul_f32 v61, v107, v61
    v_mul_f32 v62, v108, v62
    v_mfma_f32_16x16x32_bf16 v[48:51], v[68:71], a[68:71], v[48:51]
    s_waitcnt lgkmcnt(2)
    v_permlane32_swap_b32 v57, v56
    v_mfma_f32_16x16x32_bf16 v[40:43], a[72:75], v[72:75], v[40:43]
    ds_read_b128 v[68:71], v119 offset:24576
    v_max_f32 v56, v56, v57
    v_mov_b32 v57, v56
    v_mfma_f32_16x16x32_bf16 v[44:47], a[76:79], v[72:75], v[44:47]
    v_mul_f32 v63, v109, v63
    v_permlane16_swap_b32 v57, v56
    v_mfma_f32_16x16x32_bf16 v[48:51], v[72:75], a[80:83], v[48:51]
    s_waitcnt lgkmcnt(2)
    v_max_f32 v56, v56, v57
    v_mul_f32 v56, v56, v89
    v_mfma_f32_16x16x32_bf16 v[40:43], a[84:87], v[76:79], v[40:43]
    ds_read_b128 v[72:75], v118 offset:26624
    v_fma_f32 v52, v52, v89, -v56
    v_mfma_f32_16x16x32_bf16 v[44:47], a[88:91], v[76:79], v[44:47]
    v_fma_f32 v53, v53, v89, -v56
    v_fma_f32 v54, v54, v89, -v56
    v_fma_f32 v55, v55, v89, -v56
    v_mfma_f32_16x16x32_bf16 v[48:51], v[76:79], a[92:95], v[48:51]
    s_waitcnt lgkmcnt(2)
    v_exp_f32 v52, v52
    v_mfma_f32_16x16x32_bf16 v[40:43], a[96:99], v[64:67], v[40:43]
    v_exp_f32 v53, v53
    s_waitcnt vmcnt(9)
    s_barrier
    ds_read_b128 v[76:79], v119 offset:26624
    v_mfma_f32_16x16x32_bf16 v[44:47], a[100:103], v[64:67], v[44:47]
    ds_read_b64_tr_b16 a[192:193], v122 offset:24576
    v_mfma_f32_16x16x32_bf16 v[48:51], v[64:67], a[104:107], v[48:51]
    s_waitcnt lgkmcnt(3)
    ds_read_b64_tr_b16 a[194:195], v122 offset:25088
    ds_read_b64_tr_b16 a[196:197], v122 offset:25600
    ds_read_b64_tr_b16 a[198:199], v122 offset:26112
    v_mfma_f32_16x16x32_bf16 v[40:43], a[108:111], v[68:71], v[40:43]
    ds_read_b128 v[64:67], v118 offset:28672
    ds_read_b64_tr_b16 a[200:201], v122 offset:26624
    v_mfma_f32_16x16x32_bf16 v[44:47], a[112:115], v[68:71], v[44:47]
    ds_read_b64_tr_b16 a[202:203], v122 offset:27136
    ds_read_b64_tr_b16 a[204:205], v122 offset:36864
    ds_read_b64_tr_b16 a[206:207], v122 offset:37376
    v_mfma_f32_16x16x32_bf16 v[48:51], v[68:71], a[116:119], v[48:51]
    s_waitcnt lgkmcnt(10)
    ds_read_b64_tr_b16 a[208:209], v122 offset:37888
    ds_read_b64_tr_b16 a[210:211], v122 offset:38400
    v_mfma_f32_16x16x32_bf16 v[40:43], a[120:123], v[72:75], v[40:43]
    ds_read_b128 v[68:71], v119 offset:28672
    ds_read_b64_tr_b16 a[212:213], v122 offset:38912
    ds_read_b64_tr_b16 a[214:215], v122 offset:39424
    v_mfma_f32_16x16x32_bf16 v[44:47], a[124:127], v[72:75], v[44:47]
    ds_read_b64_tr_b16 a[216:217], v123 offset:0
    ds_read_b64_tr_b16 a[218:219], v123 offset:512
    v_mfma_f32_16x16x32_bf16 v[48:51], v[72:75], a[128:131], v[48:51]
    s_waitcnt lgkmcnt(14)
    ds_read_b64_tr_b16 a[220:221], v123 offset:1024
    ds_read_b64_tr_b16 a[222:223], v123 offset:1536
    ds_read_b64_tr_b16 a[224:225], v123 offset:2048
    v_mfma_f32_16x16x32_bf16 v[40:43], a[132:135], v[76:79], v[40:43]
    s_lshl_b32 s76, s2, 7
    s_lshl_b32 s77, s68, 12
    ds_read_b128 v[72:75], v118 offset:30720
    v_mfma_f32_16x16x32_bf16 v[44:47], a[136:139], v[76:79], v[44:47]
    ds_read_b64_tr_b16 a[226:227], v123 offset:2560
    ds_read_b64_tr_b16 a[228:229], v123 offset:12288
    ds_read_b64_tr_b16 a[230:231], v123 offset:12800
    v_mfma_f32_16x16x32_bf16 v[48:51], v[76:79], a[140:143], v[48:51]
    s_add_u32 s76, s76, s77
    s_waitcnt lgkmcnt(14)
    ds_read_b64_tr_b16 a[232:233], v123 offset:13312
    ds_read_b64_tr_b16 a[234:235], v123 offset:13824
    v_lshlrev_b32 v125, 5, v22
    v_mfma_f32_16x16x32_bf16 v[40:43], a[144:147], v[64:67], v[40:43]
    s_mov_b64 s[40:41], s[24:25]
    ds_read_b128 v[76:79], v119 offset:30720
    ds_read_b64_tr_b16 a[236:237], v123 offset:14336
    v_mfma_f32_16x16x32_bf16 v[44:47], a[148:151], v[64:67], v[44:47]
    ds_read_b64_tr_b16 a[238:239], v123 offset:14848
    v_exp_f32 v54, v54
    v_exp_f32 v55, v55
    v_mfma_f32_16x16x32_bf16 v[48:51], v[64:67], a[152:155], v[48:51]
    s_mov_b64 s[40:41], s[16:17]
    s_waitcnt lgkmcnt(14)
    v_cvt_pk_bf16_f32 v58, v52, v53
    v_mfma_f32_16x16x32_bf16 v[40:43], a[156:159], v[68:71], v[40:43]
    ds_read_b128 v[64:67], v118 offset:0
    v_cvt_pk_bf16_f32 v59, v54, v55
    v_cvt_pk_bf16_f32 v94, v60, v61
    v_cvt_pk_bf16_f32 v95, v62, v63
    v_mfma_f32_16x16x32_bf16 v[44:47], a[160:163], v[68:71], v[44:47]
    ds_read2_b32 v[114:115], v23 offset0:16 offset1:80
    ds_read_b128 v[106:109], v24 offset:64
    ds_read_b128 v[110:113], v24 offset:320
    v_mfma_f32_16x16x32_bf16 v[48:51], v[68:71], a[164:167], v[48:51]
    v_and_b32 v60, v38, v58
    v_and_b32 v61, v39, v59
    v_xor_b32 v62, v60, v58
    v_xor_b32 v63, v61, v59
    s_nop 1
    v_mfma_f32_16x16x32_bf16 v[56:59], v[34:37], v[60:63], 0
    v_mfma_f32_16x16x32_bf16 v[52:55], v[92:95], v[60:63], 0
    s_nop 6
    v_rcp_f32 v56, v56
    s_nop 0
    v_mul_f32 v52, v56, v52
    v_mul_f32 v53, v56, v53
    v_mul_f32 v54, v56, v54
    v_mul_f32 v55, v56, v55
    v_cvt_pk_bf16_f32 v60, v52, v53
    v_cvt_pk_bf16_f32 v61, v54, v55
    buffer_store_dwordx2 v[60:61], v19, s[36:39], s91 offen offset:0 sc1
    s_waitcnt lgkmcnt(12)
    v_mfma_f32_16x16x32_bf16 v[40:43], a[168:171], v[72:75], v[40:43]
    ds_read_b128 v[68:71], v119 offset:0
    v_mfma_f32_16x16x32_bf16 v[44:47], a[172:175], v[72:75], v[44:47]
    v_mfma_f32_16x16x32_bf16 v[48:51], v[72:75], a[176:179], v[48:51]
    s_waitcnt lgkmcnt(7)
    v_mfma_f32_16x16x32_bf16 v[40:43], a[180:183], v[76:79], v[40:43]
    ds_read_b128 v[72:75], v118 offset:2048
    v_mfma_f32_16x16x32_bf16 v[44:47], a[184:187], v[76:79], v[44:47]
    v_mfma_f32_16x16x32_bf16 v[48:51], v[76:79], a[188:191], v[48:51]
    s_waitcnt lgkmcnt(5)
    v_mfma_f32_16x16x32_bf16 v[52:55], a[0:3], v[64:67], 0
    ds_read_b128 v[76:79], v119 offset:2048
    v_mfma_f32_16x16x32_bf16 v[56:59], a[4:7], v[64:67], 0
    v_mfma_f32_16x16x32_bf16 v[60:63], v[64:67], a[8:11], 0
    s_waitcnt lgkmcnt(2)
    v_mfma_f32_16x16x32_bf16 v[52:55], a[12:15], v[68:71], v[52:55]
    ds_read_b128 v[64:67], v118 offset:4096
    v_fma_f32 v44, v115, v84, v44
    v_fma_f32 v45, v115, v85, v45
    v_mfma_f32_16x16x32_bf16 v[56:59], a[16:19], v[68:71], v[56:59]
    v_fma_f32 v46, v115, v86, v46
    v_fma_f32 v47, v115, v87, v47
    v_mul_f32 v44, v114, v44
    v_mfma_f32_16x16x32_bf16 v[60:63], v[68:71], a[20:23], v[60:63]
    s_waitcnt lgkmcnt(2)
    v_mul_f32 v45, v114, v45
    v_mul_f32 v46, v114, v46
    v_mfma_f32_16x16x32_bf16 v[52:55], a[24:27], v[72:75], v[52:55]
    ds_read_b128 v[68:71], v119 offset:4096
    v_mul_f32 v47, v114, v47
    v_cvt_pk_bf16_f32 v100, v44, v45
    v_mfma_f32_16x16x32_bf16 v[56:59], a[28:31], v[72:75], v[56:59]
    v_cvt_pk_bf16_f32 v101, v46, v47
    v_fma_f32 v40, v115, v80, v40
    v_mfma_f32_16x16x32_bf16 v[60:63], v[72:75], a[32:35], v[60:63]
    s_waitcnt lgkmcnt(2)
    v_fma_f32 v41, v115, v81, v41
    v_fma_f32 v42, v115, v82, v42
    v_fma_f32 v43, v115, v83, v43
    v_mfma_f32_16x16x32_bf16 v[52:55], a[36:39], v[76:79], v[52:55]
    ds_read_b128 v[72:75], v118 offset:6144
    v_cvt_pk_bf16_f32 v102, v40, v41
    v_mfma_f32_16x16x32_bf16 v[56:59], a[40:43], v[76:79], v[56:59]
    v_cvt_pk_bf16_f32 v103, v42, v43
    v_mul_f32 v89, 0x3eb8aa3b, v114
    v_mfma_f32_16x16x16_bf16 v[40:43], v[98:99], v[104:105], v[30:33]
    v_mfma_f32_16x16x16_bf16 v[44:47], v[100:101], v[104:105], v[30:33]
    v_fma_f32 v48, v110, v88, v48
    v_fma_f32 v49, v111, v88, v49
    v_fma_f32 v50, v112, v88, v50
    v_mfma_f32_16x16x32_bf16 v[60:63], v[76:79], a[44:47], v[60:63]
    s_waitcnt lgkmcnt(2)
    v_fma_f32 v51, v113, v88, v51
    v_mul_f32 v48, v106, v48
    v_mul_f32 v49, v107, v49
    v_mfma_f32_16x16x32_bf16 v[52:55], a[48:51], v[64:67], v[52:55]
    s_barrier
    ds_read_b128 v[76:79], v119 offset:6144
    v_mfma_f32_16x16x32_bf16 v[56:59], a[52:55], v[64:67], v[56:59]
    v_cndmask_b32 v40, v44, v40, s[60:61]
    v_cndmask_b32 v41, v45, v41, s[62:63]
    v_cndmask_b32 v42, v46, v42, s[64:65]
    v_mfma_f32_16x16x32_bf16 v[60:63], v[64:67], a[56:59], v[60:63]
    s_waitcnt lgkmcnt(2)
    v_cndmask_b32 v43, v47, v43, s[66:67]
    v_max3_f32 v44, v40, v41, v42
    v_mfma_f32_16x16x32_bf16 v[52:55], a[60:63], v[68:71], v[52:55]
    ds_read_b128 v[64:67], v118 offset:8192
    v_max_f32 v44, v44, v43
    v_mov_b32 v45, v44
    v_mfma_f32_16x16x32_bf16 v[56:59], a[64:67], v[68:71], v[56:59]
    v_mul_f32 v50, v108, v50
    v_permlane32_swap_b32 v45, v44
    v_mfma_f32_16x16x32_bf16 v[60:63], v[68:71], a[68:71], v[60:63]
    s_waitcnt lgkmcnt(2)
    v_max_f32 v44, v44, v45
    v_mov_b32 v45, v44
    v_mfma_f32_16x16x32_bf16 v[52:55], a[72:75], v[72:75], v[52:55]
    s_add_u32 s49, s101, 2
    s_and_b32 s49, s49, 7
    s_mul_i32 s49, s49, 196608
    s_add_u32 m0, s48, 65536
    ds_read_b128 v[68:71], v119 offset:8192
    v_mfma_f32_16x16x32_bf16 v[56:59], a[76:79], v[72:75], v[56:59]
    buffer_load_dwordx4 v120, s[20:23], s49 offen offset:0 lds
    v_permlane16_swap_b32 v45, v44
    v_mfma_f32_16x16x32_bf16 v[60:63], v[72:75], a[80:83], v[60:63]
    s_waitcnt lgkmcnt(2)
    buffer_load_dwordx4 v120, s[20:23], s49 offen offset:1024 lds
    v_max_f32 v44, v44, v45
    v_mfma_f32_16x16x32_bf16 v[52:55], a[84:87], v[76:79], v[52:55]
    ds_read_b128 v[72:75], v118 offset:10240
    v_mul_f32 v44, v44, v116
    v_fma_f32 v40, v40, v116, -v44
    v_mfma_f32_16x16x32_bf16 v[56:59], a[88:91], v[76:79], v[56:59]
    buffer_load_dwordx4 v120, s[20:23], s49 offen offset:2048 lds
    v_fma_f32 v41, v41, v116, -v44
    s_add_u32 m0, s48, 68608
    v_mfma_f32_16x16x32_bf16 v[60:63], v[76:79], a[92:95], v[60:63]
    s_waitcnt lgkmcnt(2)
    buffer_load_dwordx4 v121, s[20:23], s49 offen offset:0 lds
    v_fma_f32 v42, v42, v116, -v44
    v_mfma_f32_16x16x32_bf16 v[52:55], a[96:99], v[64:67], v[52:55]
    ds_read_b128 v[76:79], v119 offset:10240
    v_fma_f32 v43, v43, v116, -v44
    v_exp_f32 v40, v40
    v_mfma_f32_16x16x32_bf16 v[56:59], a[100:103], v[64:67], v[56:59]
    buffer_load_dwordx4 v121, s[20:23], s49 offen offset:1024 lds
    v_mfma_f32_16x16x32_bf16 v[60:63], v[64:67], a[104:107], v[60:63]
    s_waitcnt lgkmcnt(2)
    buffer_load_dwordx4 v121, s[20:23], s49 offen offset:2048 lds
    v_exp_f32 v41, v41
    v_mfma_f32_16x16x32_bf16 v[52:55], a[108:111], v[68:71], v[52:55]
    s_add_u32 s49, s101, 3
    s_and_b32 s49, s49, 7
    s_mul_i32 s49, s49, 196608
    s_add_u32 m0, s48, 90112
    ds_read_b128 v[64:67], v118 offset:12288
    v_mfma_f32_16x16x32_bf16 v[56:59], a[112:115], v[68:71], v[56:59]
    buffer_load_dwordx4 v120, s[20:23], s49 offen offset:0 lds
    v_exp_f32 v42, v42
    v_mfma_f32_16x16x32_bf16 v[60:63], v[68:71], a[116:119], v[60:63]
    s_waitcnt lgkmcnt(2)
    buffer_load_dwordx4 v120, s[20:23], s49 offen offset:1024 lds
    v_exp_f32 v43, v43
    v_mfma_f32_16x16x32_bf16 v[52:55], a[120:123], v[72:75], v[52:55]
    ds_read_b128 v[68:71], v119 offset:12288
    v_mfma_f32_16x16x32_bf16 v[56:59], a[124:127], v[72:75], v[56:59]
    buffer_load_dwordx4 v120, s[20:23], s49 offen offset:2048 lds
    v_cvt_pk_bf16_f32 v46, v40, v41
    s_add_u32 m0, s48, 93184
    v_mfma_f32_16x16x32_bf16 v[60:63], v[72:75], a[128:131], v[60:63]
    s_waitcnt lgkmcnt(2)
    buffer_load_dwordx4 v121, s[20:23], s49 offen offset:0 lds
    v_cvt_pk_bf16_f32 v47, v42, v43
    v_mul_f32 v51, v109, v51
    v_mfma_f32_16x16x32_bf16 v[52:55], a[132:135], v[76:79], v[52:55]
    ds_read_b128 v[72:75], v118 offset:14336
    v_cvt_pk_bf16_f32 v96, v48, v49
    v_mfma_f32_16x16x32_bf16 v[56:59], a[136:139], v[76:79], v[56:59]
    buffer_load_dwordx4 v121, s[20:23], s49 offen offset:1024 lds
    v_cvt_pk_bf16_f32 v97, v50, v51
    v_and_b32 v48, v38, v46
    v_mfma_f32_16x16x32_bf16 v[60:63], v[76:79], a[140:143], v[60:63]
    s_waitcnt lgkmcnt(2)
    buffer_load_dwordx4 v121, s[20:23], s49 offen offset:2048 lds
    ds_read2_b32 v[114:115], v23 offset0:0 offset1:64
    v_mfma_f32_16x16x32_bf16 v[52:55], a[144:147], v[64:67], v[52:55]
    s_add_u32 s49, s101, 4
    s_and_b32 s49, s49, 7
    s_mul_i32 s49, s49, 196608
    s_add_u32 m0, s48, 133120
    ds_read_b128 v[76:79], v119 offset:14336
    v_mfma_f32_16x16x32_bf16 v[56:59], a[148:151], v[64:67], v[56:59]
    buffer_load_dwordx4 v120, s[20:23], s49 offen offset:0 lds
    ds_read_b128 v[106:109], v24 offset:0
    ds_read_b128 v[110:113], v24 offset:256
    v_mfma_f32_16x16x32_bf16 v[60:63], v[64:67], a[152:155], v[60:63]
    s_waitcnt lgkmcnt(5)
    buffer_load_dwordx4 v120, s[20:23], s49 offen offset:1024 lds
    v_and_b32 v49, v39, v47
    v_mfma_f32_16x16x32_bf16 v[52:55], a[156:159], v[68:71], v[52:55]
    v_xor_b32 v50, v48, v46
    v_xor_b32 v51, v49, v47
    v_mfma_f32_16x16x32_bf16 v[56:59], a[160:163], v[68:71], v[56:59]
    buffer_load_dwordx4 v120, s[20:23], s49 offen offset:2048 lds
    v_mfma_f32_16x16x32_bf16 v[44:47], v[34:37], v[48:51], 0
    v_mfma_f32_16x16x32_bf16 v[40:43], v[94:97], v[48:51], 0
    s_add_u32 m0, s48, 136192
    v_mfma_f32_16x16x32_bf16 v[60:63], v[68:71], a[164:167], v[60:63]
    buffer_load_dwordx4 v121, s[20:23], s49 offen offset:0 lds
    s_nop 3
    v_rcp_f32 v44, v44
    s_nop 0
    v_mul_f32 v40, v44, v40
    v_mul_f32 v41, v44, v41
    v_mul_f32 v42, v44, v42
    v_mul_f32 v43, v44, v43
    v_cvt_pk_bf16_f32 v48, v40, v41
    v_cvt_pk_bf16_f32 v49, v42, v43
    buffer_store_dwordx2 v[48:49], v19, s[36:39], s90 offen offset:0 sc1
    s_waitcnt lgkmcnt(4)
    v_mfma_f32_16x16x32_bf16 v[52:55], a[168:171], v[72:75], v[52:55]
    v_mfma_f32_16x16x32_bf16 v[56:59], a[172:175], v[72:75], v[56:59]
    buffer_load_dwordx4 v121, s[20:23], s49 offen offset:1024 lds
    v_mfma_f32_16x16x32_bf16 v[60:63], v[72:75], a[176:179], v[60:63]
    s_waitcnt lgkmcnt(2)
    buffer_load_dwordx4 v121, s[20:23], s49 offen offset:2048 lds
    v_mfma_f32_16x16x32_bf16 v[52:55], a[180:183], v[76:79], v[52:55]
    v_mfma_f32_16x16x32_bf16 v[56:59], a[184:187], v[76:79], v[56:59]
    v_mfma_f32_16x16x32_bf16 v[60:63], v[76:79], a[188:191], v[60:63]
    v_min_f32 v64, s100, v30
    s_waitcnt vmcnt(28)
    v_cmp_ne_u32 vcc, 1, v29
    v_min_f32 v65, s100, v31
    s_cbranch_vccnz L_slow_66
L_back_67:
    v_min_f32 v66, s100, v32
    v_fma_f32 v52, v115, v80, v52
    v_fma_f32 v56, v115, v84, v56
    v_fma_f32 v57, v115, v85, v57
    v_fma_f32 v58, v115, v86, v58
    v_fma_f32 v59, v115, v87, v59
    v_mul_f32 v56, v114, v56
    v_mul_f32 v57, v114, v57
    v_mul_f32 v58, v114, v58
    v_mul_f32 v59, v114, v59
    v_cvt_pk_bf16_f32 v98, v56, v57
    v_cvt_pk_bf16_f32 v99, v58, v59
    v_mfma_f32_16x16x16_bf16 v[40:43], v[100:101], v[102:103], v[30:33]
    s_waitcnt lgkmcnt(0)
    v_fma_f32 v60, v110, v88, v60
    v_mfma_f32_16x16x16_bf16 v[44:47], v[98:99], v[102:103], v[30:33]
    v_fma_f32 v61, v111, v88, v61
    v_fma_f32 v62, v112, v88, v62
    v_fma_f32 v63, v113, v88, v63
    v_fma_f32 v53, v115, v81, v53
    v_mul_f32 v60, v106, v60
    v_fma_f32 v54, v115, v82, v54
    v_mul_f32 v61, v107, v61
    v_fma_f32 v55, v115, v83, v55
    v_cndmask_b32 v40, v44, v40, s[60:61]
    v_cndmask_b32 v41, v45, v41, s[62:63]
    v_cndmask_b32 v42, v46, v42, s[64:65]
    v_cndmask_b32 v43, v47, v43, s[66:67]
    v_max3_f32 v44, v40, v41, v42
    v_max_f32 v44, v44, v43
    v_mov_b32 v45, v44
    v_mul_f32 v62, v108, v62
    v_cvt_pk_bf16_f32 v104, v52, v53
    v_permlane32_swap_b32 v45, v44
    v_max_f32 v44, v44, v45
    v_mov_b32 v45, v44
    v_mul_f32 v63, v109, v63
    v_cvt_pk_bf16_f32 v105, v54, v55
    v_permlane16_swap_b32 v45, v44
    v_max_f32 v44, v44, v45
    v_mul_f32 v44, v44, v89
    v_fma_f32 v40, v40, v89, -v44
    v_fma_f32 v41, v41, v89, -v44
    v_fma_f32 v42, v42, v89, -v44
    v_fma_f32 v43, v43, v89, -v44
    v_exp_f32 v40, v40
    v_exp_f32 v41, v41
    v_exp_f32 v42, v42
    v_exp_f32 v43, v43
    v_cvt_pk_bf16_f32 v46, v40, v41
    v_cvt_pk_bf16_f32 v47, v42, v43
    v_cvt_pk_bf16_f32 v94, v60, v61
    buffer_load_dwordx4 v[90:93], v16, s[36:39], s85 offen sc1
    v_mul_f32 v116, 0x3eb8aa3b, v114
    v_cvt_pk_bf16_f32 v95, v62, v63
    v_and_b32 v50, v38, v46
    v_and_b32 v51, v39, v47
    v_xor_b32 v48, v50, v46
    v_xor_b32 v49, v51, v47
    v_min_f32 v67, s100, v33
    s_nop 0
    v_mfma_f32_16x16x32_bf16 v[44:47], v[34:37], v[48:51], 0
    v_mfma_f32_16x16x32_bf16 v[40:43], v[94:97], v[48:51], 0
    s_nop 6
    v_rcp_f32 v44, v44
    s_nop 0
    v_mul_f32 v40, v44, v40
    v_mul_f32 v41, v44, v41
    v_mul_f32 v42, v44, v42
    v_mul_f32 v43, v44, v43
    v_cvt_pk_bf16_f32 v48, v40, v41
    v_cvt_pk_bf16_f32 v49, v42, v43
    buffer_store_dwordx2 v[48:49], v19, s[36:39], s89 offen offset:0 sc1
    v_mfma_f32_16x16x32_bf16 v[68:71], a[192:195], v[34:37], 0
    v_mfma_f32_16x16x32_bf16 v[72:75], a[196:199], v[34:37], 0
    v_mfma_f32_16x16x32_bf16 v[76:79], v[34:37], a[200:203], 0
    v_mfma_f32_16x16x32_bf16 v[68:71], a[204:207], v[34:37], v[68:71]
    v_mfma_f32_16x16x32_bf16 v[72:75], a[208:211], v[34:37], v[72:75]
    v_mfma_f32_16x16x32_bf16 v[76:79], v[34:37], a[212:215], v[76:79]
    s_waitcnt vmcnt(15)
    s_barrier
    s_waitcnt vmcnt(0)
    buffer_store_dword v25, off, s[36:39], s83 offset:0 sc1
    buffer_store_dword v25, off, s[36:39], s83 offset:896 sc1
    ds_read_b64_tr_b16 a[240:241], v122 offset:0
    ds_read_b64_tr_b16 a[242:243], v122 offset:512
    ds_read_b64_tr_b16 a[244:245], v122 offset:1024
    ds_read_b64_tr_b16 a[246:247], v122 offset:1536
    ds_read_b64_tr_b16 a[248:249], v122 offset:2048
    ds_read_b64_tr_b16 a[250:251], v122 offset:2560
    ds_read_b64_tr_b16 a[252:253], v122 offset:12288
    ds_read_b64_tr_b16 a[254:255], v122 offset:12800
    ds_read_b64_tr_b16 v[128:129], v122 offset:13312
    ds_read_b64_tr_b16 v[130:131], v122 offset:13824
    ds_read_b64_tr_b16 v[132:133], v122 offset:14336
    ds_read_b64_tr_b16 v[134:135], v122 offset:14848
    v_mfma_f32_16x16x32_bf16 v[68:71], a[216:219], v[34:37], v[68:71]
    v_mfma_f32_16x16x32_bf16 v[72:75], a[220:223], v[34:37], v[72:75]
    v_mfma_f32_16x16x32_bf16 v[76:79], v[34:37], a[224:227], v[76:79]
    v_mfma_f32_16x16x32_bf16 v[68:71], a[228:231], v[34:37], v[68:71]
    v_mfma_f32_16x16x32_bf16 v[72:75], a[232:235], v[34:37], v[72:75]
    v_mfma_f32_16x16x32_bf16 v[76:79], v[34:37], a[236:239], v[76:79]
    s_waitcnt lgkmcnt(0)
    s_barrier
    s_add_u32 s49, s101, 5
    s_and_b32 s49, s49, 7
    s_mul_i32 s49, s49, 196608
    s_add_u32 m0, s48, 65536
    s_nop 0
    buffer_load_dwordx4 v120, s[20:23], s49 offen offset:0 lds
    ds_read_b64_tr_b16 v[136:137], v122 offset:24576
    ds_read_b64_tr_b16 v[138:139], v122 offset:25088
    ds_read_b64_tr_b16 v[140:141], v122 offset:25600
    v_mfma_f32_16x16x32_bf16 v[68:71], a[240:243], v[34:37], v[68:71]
    buffer_load_dwordx4 v120, s[20:23], s49 offen offset:1024 lds
    ds_read_b64_tr_b16 v[142:143], v122 offset:26112
    ds_read_b64_tr_b16 v[144:145], v122 offset:26624
    ds_read_b64_tr_b16 v[146:147], v122 offset:27136
    v_mfma_f32_16x16x32_bf16 v[72:75], a[244:247], v[34:37], v[72:75]
    buffer_load_dwordx4 v120, s[20:23], s49 offen offset:2048 lds
    ds_read_b64_tr_b16 v[148:149], v122 offset:36864
    ds_read_b64_tr_b16 v[150:151], v122 offset:37376
    ds_read_b64_tr_b16 v[152:153], v122 offset:37888
    v_mfma_f32_16x16x32_bf16 v[76:79], v[34:37], a[248:251], v[76:79]
    s_add_u32 m0, s48, 68608
    s_nop 0
    buffer_load_dwordx4 v121, s[20:23], s49 offen offset:0 lds
    ds_read_b64_tr_b16 v[154:155], v122 offset:38400
    ds_read_b64_tr_b16 v[156:157], v122 offset:38912
    ds_read_b64_tr_b16 v[158:159], v122 offset:39424
    v_mfma_f32_16x16x32_bf16 v[68:71], a[252:255], v[34:37], v[68:71]
    buffer_load_dwordx4 v121, s[20:23], s49 offen offset:1024 lds
    v_mfma_f32_16x16x32_bf16 v[72:75], v[128:131], v[34:37], v[72:75]
    buffer_load_dwordx4 v121, s[20:23], s49 offen offset:2048 lds
    v_mfma_f32_16x16x32_bf16 v[76:79], v[34:37], v[132:135], v[76:79]
    s_waitcnt lgkmcnt(0)
    s_barrier
    ds_read_b64_tr_b16 v[160:161], v123 offset:0
    ds_read_b64_tr_b16 v[162:163], v123 offset:512
    ds_read_b64_tr_b16 v[164:165], v123 offset:1024
    ds_read_b64_tr_b16 v[166:167], v123 offset:1536
    ds_read_b64_tr_b16 v[168:169], v123 offset:2048
    ds_read_b64_tr_b16 v[170:171], v123 offset:2560
    ds_read_b64_tr_b16 v[172:173], v123 offset:12288
    ds_read_b64_tr_b16 v[174:175], v123 offset:12800
    ds_read_b64_tr_b16 v[176:177], v123 offset:13312
    ds_read_b64_tr_b16 v[178:179], v123 offset:13824
    ds_read_b64_tr_b16 v[180:181], v123 offset:14336
    ds_read_b64_tr_b16 v[182:183], v123 offset:14848
    s_add_u32 s49, s101, 6
    s_and_b32 s49, s49, 7
    s_mul_i32 s49, s49, 196608
    s_add_u32 m0, s48, 90112
    v_cmp_eq_u32 vcc, -1, v93
    v_mfma_f32_16x16x32_bf16 v[68:71], v[136:139], v[34:37], v[68:71]
    v_mfma_f32_16x16x32_bf16 v[72:75], v[140:143], v[34:37], v[72:75]
    v_mfma_f32_16x16x32_bf16 v[76:79], v[34:37], v[144:147], v[76:79]
    s_cbranch_vccnz L_slow_69
L_back_70:
    s_add_u32 s85, s85, 0x8000
    v_mfma_f32_16x16x16_bf16 v[52:55], v[98:99], v[104:105], v[30:33]
    v_mfma_f32_16x16x16_bf16 v[56:59], v[90:91], v[104:105], v[64:67]
    v_mfma_f32_16x16x32_bf16 v[68:71], v[148:151], v[34:37], v[68:71]
    v_mfma_f32_16x16x32_bf16 v[72:75], v[152:155], v[34:37], v[72:75]
    v_mfma_f32_16x16x32_bf16 v[76:79], v[34:37], v[156:159], v[76:79]
    buffer_load_dwordx4 v120, s[20:23], s49 offen offset:0 lds
    buffer_load_dwordx4 v120, s[20:23], s49 offen offset:1024 lds
    buffer_load_dwordx4 v120, s[20:23], s49 offen offset:2048 lds
    s_add_u32 m0, s48, 93184
    s_nop 0
    buffer_load_dwordx4 v121, s[20:23], s49 offen offset:0 lds
    v_cndmask_b32 v52, v56, v52, s[60:61]
    v_cndmask_b32 v53, v57, v53, s[62:63]
    v_cndmask_b32 v54, v58, v54, s[64:65]
    v_cndmask_b32 v55, v59, v55, s[66:67]
    v_max3_f32 v56, v52, v53, v54
    v_max_f32 v56, v56, v55
    v_mov_b32 v57, v56
    buffer_load_dwordx4 v121, s[20:23], s49 offen offset:1024 lds
    buffer_load_dwordx4 v121, s[20:23], s49 offen offset:2048 lds
    v_permlane32_swap_b32 v57, v56
    v_max_f32 v56, v56, v57
    v_mov_b32 v57, v56
    s_nop 1
    v_permlane16_swap_b32 v57, v56
    v_max_f32 v56, v56, v57
    v_mul_f32 v56, v56, v116
    v_fma_f32 v52, v52, v116, -v56
    v_fma_f32 v53, v53, v116, -v56
    v_fma_f32 v54, v54, v116, -v56
    v_fma_f32 v55, v55, v116, -v56
    v_exp_f32 v52, v52
    v_exp_f32 v53, v53
    v_exp_f32 v54, v54
    v_exp_f32 v55, v55
    v_cvt_pk_bf16_f32 v58, v52, v53
    v_cvt_pk_bf16_f32 v59, v54, v55
    v_and_b32 v62, v38, v58
    v_and_b32 v63, v39, v59
    v_xor_b32 v60, v62, v58
    v_xor_b32 v61, v63, v59
    s_nop 1
    v_mfma_f32_16x16x32_bf16 v[56:59], v[34:37], v[60:63], 0
    v_mfma_f32_16x16x32_bf16 v[52:55], v[92:95], v[60:63], 0
    s_nop 6
    v_rcp_f32 v56, v56
    s_nop 0
    v_mul_f32 v52, v56, v52
    v_mul_f32 v53, v56, v53
    v_mul_f32 v54, v56, v54
    v_mul_f32 v55, v56, v55
    v_cvt_pk_bf16_f32 v60, v52, v53
    v_cvt_pk_bf16_f32 v61, v54, v55
    buffer_store_dwordx2 v[60:61], v19, s[36:39], s88 offen offset:0 sc1
    s_waitcnt vmcnt(7) lgkmcnt(0)
    s_barrier
    buffer_load_dword v29, v22, s[36:39], s82 offen offset:0 sc1
    s_add_u32 s49, s101, 7
    s_and_b32 s49, s49, 7
    s_mul_i32 s49, s49, 196608
    s_add_u32 m0, s48, 133120
    s_nop 0
    buffer_load_dwordx4 v120, s[20:23], s49 offen offset:0 lds
    ds_read_b64_tr_b16 v[184:185], v122 offset:0
    ds_read_b64_tr_b16 v[186:187], v122 offset:512
    ds_read_b64_tr_b16 v[188:189], v122 offset:1024
    v_mfma_f32_16x16x32_bf16 v[68:71], v[160:163], v[34:37], v[68:71]
    buffer_load_dwordx4 v120, s[20:23], s49 offen offset:1024 lds
    ds_read_b64_tr_b16 v[190:191], v122 offset:1536
    ds_read_b64_tr_b16 v[192:193], v122 offset:2048
    ds_read_b64_tr_b16 v[194:195], v122 offset:2560
    v_mfma_f32_16x16x32_bf16 v[72:75], v[164:167], v[34:37], v[72:75]
    buffer_load_dwordx4 v120, s[20:23], s49 offen offset:2048 lds
    ds_read_b64_tr_b16 v[196:197], v122 offset:12288
    ds_read_b64_tr_b16 v[198:199], v122 offset:12800
    ds_read_b64_tr_b16 v[200:201], v122 offset:13312
    v_mfma_f32_16x16x32_bf16 v[76:79], v[34:37], v[168:171], v[76:79]
    s_add_u32 m0, s48, 136192
    s_nop 0
    buffer_load_dwordx4 v121, s[20:23], s49 offen offset:0 lds
    ds_read_b64_tr_b16 v[202:203], v122 offset:13824
    ds_read_b64_tr_b16 v[204:205], v122 offset:14336
    ds_read_b64_tr_b16 v[206:207], v122 offset:14848
    v_mfma_f32_16x16x32_bf16 v[68:71], v[172:175], v[34:37], v[68:71]
    buffer_load_dwordx4 v121, s[20:23], s49 offen offset:1024 lds
    v_mfma_f32_16x16x32_bf16 v[72:75], v[176:179], v[34:37], v[72:75]
    buffer_load_dwordx4 v121, s[20:23], s49 offen offset:2048 lds
    v_mfma_f32_16x16x32_bf16 v[76:79], v[34:37], v[180:183], v[76:79]
    s_waitcnt vmcnt(8) lgkmcnt(0)
    s_barrier
    s_waitcnt vmcnt(7)
    buffer_store_dword v25, off, s[36:39], s83 offset:256 sc1
    s_add_u32 s3, s19, 0
    s_and_b32 s3, s3, 0x7ffff
    s_add_u32 m0, s81, 65536
    s_nop 0
    buffer_load_dwordx4 v17, s[40:43], s3 offen offset:0 lds
    ds_read_b64_tr_b16 v[208:209], v122 offset:24576
    ds_read_b64_tr_b16 v[210:211], v122 offset:25088
    ds_read_b64_tr_b16 v[212:213], v122 offset:25600
    ds_read_b64_tr_b16 v[214:215], v122 offset:26112
    ds_read_b64_tr_b16 v[216:217], v122 offset:26624
    ds_read_b64_tr_b16 v[218:219], v122 offset:27136
    v_mfma_f32_16x16x32_bf16 v[68:71], v[184:187], v[34:37], v[68:71]
    s_add_u32 m0, s81, 65568
    s_nop 0
    buffer_load_dwordx4 v17, s[40:43], s3 offen offset:1024 lds
    ds_read_b64_tr_b16 v[220:221], v122 offset:36864
    ds_read_b64_tr_b16 v[222:223], v122 offset:37376
    ds_read_b64_tr_b16 v[224:225], v122 offset:37888
    ds_read_b64_tr_b16 v[226:227], v122 offset:38400
    ds_read_b64_tr_b16 v[228:229], v122 offset:38912
    ds_read_b64_tr_b16 v[230:231], v122 offset:39424
    v_mfma_f32_16x16x32_bf16 v[72:75], v[188:191], v[34:37], v[72:75]
    v_mfma_f32_16x16x32_bf16 v[76:79], v[34:37], v[192:195], v[76:79]
    s_add_u32 m0, s81, 65600
    s_nop 0
    buffer_load_dwordx4 v17, s[40:43], s3 offen offset:2048 lds
    v_mfma_f32_16x16x32_bf16 v[68:71], v[196:199], v[34:37], v[68:71]
    s_add_u32 m0, s81, 65632
    s_nop 0
    buffer_load_dwordx4 v17, s[40:43], s3 offen offset:3072 lds
    v_mfma_f32_16x16x32_bf16 v[72:75], v[200:203], v[34:37], v[72:75]
    v_mfma_f32_16x16x32_bf16 v[76:79], v[34:37], v[204:207], v[76:79]
    s_waitcnt vmcnt(5) lgkmcnt(0)
    s_barrier
    s_add_u32 s3, s19, 131072
    s_and_b32 s3, s3, 0x7ffff
    s_add_u32 m0, s81, 82432
    s_nop 0
    buffer_load_dwordx4 v17, s[40:43], s3 offen offset:0 lds
    ds_read_b64_tr_b16 v[232:233], v123 offset:0
    ds_read_b64_tr_b16 v[234:235], v123 offset:512
    s_add_u32 m0, s81, 82464
    s_nop 0
    buffer_load_dwordx4 v17, s[40:43], s3 offen offset:1024 lds
    ds_read_b64_tr_b16 v[236:237], v123 offset:1024
    ds_read_b64_tr_b16 v[238:239], v123 offset:1536
    v_mfma_f32_16x16x32_bf16 v[68:71], v[208:211], v[34:37], v[68:71]
    s_add_u32 m0, s81, 82496
    s_nop 0
    buffer_load_dwordx4 v17, s[40:43], s3 offen offset:2048 lds
    ds_read_b64_tr_b16 v[240:241], v123 offset:2048
    ds_read_b64_tr_b16 v[242:243], v123 offset:2560
    v_mfma_f32_16x16x32_bf16 v[72:75], v[212:215], v[34:37], v[72:75]
    s_add_u32 m0, s81, 82528
    s_nop 0
    buffer_load_dwordx4 v17, s[40:43], s3 offen offset:3072 lds
    ds_read_b64_tr_b16 v[244:245], v123 offset:12288
    ds_read_b64_tr_b16 v[246:247], v123 offset:12800
    v_mfma_f32_16x16x32_bf16 v[76:79], v[34:37], v[216:219], v[76:79]
    s_add_u32 s3, s19, 262144
    s_and_b32 s3, s3, 0x7ffff
    s_add_u32 m0, s81, 99328
    s_nop 0
    buffer_load_dwordx4 v17, s[40:43], s3 offen offset:0 lds
    ds_read_b64_tr_b16 v[248:249], v123 offset:13312
    ds_read_b64_tr_b16 v[250:251], v123 offset:13824
    s_add_u32 m0, s81, 99360
    s_nop 0
    buffer_load_dwordx4 v17, s[40:43], s3 offen offset:1024 lds
    ds_read_b64_tr_b16 v[252:253], v123 offset:14336
    ds_read_b64_tr_b16 v[254:255], v123 offset:14848
    v_mfma_f32_16x16x32_bf16 v[68:71], v[220:223], v[34:37], v[68:71]
    s_add_u32 m0, s81, 99392
    s_nop 0
    buffer_load_dwordx4 v17, s[40:43], s3 offen offset:2048 lds
    v_mfma_f32_16x16x32_bf16 v[72:75], v[224:227], v[34:37], v[72:75]
    s_add_u32 m0, s81, 99424
    s_nop 0
    buffer_load_dwordx4 v17, s[40:43], s3 offen offset:3072 lds
    v_mfma_f32_16x16x32_bf16 v[76:79], v[34:37], v[228:231], v[76:79]
    v_cmp_gt_u32 vcc, s72, v29
    s_cbranch_vccnz L_slow_72
L_back_73:
    s_add_u32 m0, s80, 49152
    s_nop 0
    buffer_load_dwordx4 v16, s[36:39], s95 offen offset:0 sc1 lds
    buffer_load_dwordx4 v16, s[36:39], s95 offen offset:1024 sc1 lds
    buffer_load_dwordx4 v16, s[36:39], s95 offen offset:2048 sc1 lds
    buffer_load_dwordx4 v16, s[36:39], s95 offen offset:3072 sc1 lds
    s_add_u32 m0, s80, 32768
    s_nop 0
    buffer_load_dwordx4 v16, s[36:39], s94 offen offset:0 sc1 lds
    buffer_load_dwordx4 v16, s[36:39], s94 offen offset:1024 sc1 lds
    buffer_load_dwordx4 v16, s[36:39], s94 offen offset:2048 sc1 lds
    buffer_load_dwordx4 v16, s[36:39], s94 offen offset:3072 sc1 lds
    s_mov_b64 s[40:41], s[24:25]
    buffer_load_dword v30, v125, s[40:43], s76 offen
    s_waitcnt lgkmcnt(10)
    v_mfma_f32_16x16x32_bf16 v[68:71], v[232:235], v[34:37], v[68:71]
    s_waitcnt lgkmcnt(8)
    v_mfma_f32_16x16x32_bf16 v[72:75], v[236:239], v[34:37], v[72:75]
    s_waitcnt lgkmcnt(6)
    v_mfma_f32_16x16x32_bf16 v[76:79], v[34:37], v[240:243], v[76:79]
    s_waitcnt lgkmcnt(4)
    v_mfma_f32_16x16x32_bf16 v[68:71], v[244:247], v[34:37], v[68:71]
    s_waitcnt lgkmcnt(2)
    v_mfma_f32_16x16x32_bf16 v[72:75], v[248:251], v[34:37], v[72:75]
    s_waitcnt lgkmcnt(0)
    v_mfma_f32_16x16x32_bf16 v[76:79], v[34:37], v[252:255], v[76:79]
    s_lshl_b32 s74, s68, 8
    v_add_u32 v116, s74, v24
    v_add_u32 v117, s74, v23
    s_nop 0
    ds_write_b128 v116, v[68:71] offset:3072
    s_nop 0
    ds_write_b128 v116, v[72:75] offset:3136
    s_nop 0
    ds_write_b32 v117, v76 offset:3200
    s_waitcnt vmcnt(1) lgkmcnt(0)
L_wS:
    s_barrier
    ds_read_b64_tr_b16 v[40:41], v18 offset:0
    ds_read_b64_tr_b16 v[42:43], v18 offset:256
    ds_read_b128 v[104:107], v16 offset:49152
    ds_read_b64_tr_b16 v[44:45], v18 offset:4224
    ds_read_b64_tr_b16 v[46:47], v18 offset:4480
    ds_read_b128 v[108:111], v16 offset:50176
    ds_read_b64_tr_b16 v[48:49], v18 offset:8448
    ds_read_b64_tr_b16 v[50:51], v18 offset:8704
    ds_read_b128 v[112:115], v16 offset:51200
    ds_read_b64_tr_b16 v[52:53], v18 offset:12672
    ds_read_b64_tr_b16 v[54:55], v18 offset:12928
    ds_read_b128 v[116:119], v16 offset:52224
    ds_read_b128 v[120:123], v16 offset:53248
    ds_read_b128 v[124:127], v16 offset:54272
    ds_read_b64_tr_b16 v[56:57], v18 offset:16896
    ds_read_b64_tr_b16 v[58:59], v18 offset:17152
    ds_read_b128 v[32:35], v16 offset:55296
    s_waitcnt lgkmcnt(14)
    v_mfma_f32_16x16x32_bf16 v[12:15], v[40:43], v[104:107], v[12:15]
    ds_read_b64_tr_b16 v[60:61], v18 offset:21120
    ds_read_b64_tr_b16 v[62:63], v18 offset:21376
    ds_read_b128 v[104:107], v16 offset:56320
    s_waitcnt lgkmcnt(14)
    v_mfma_f32_16x16x32_bf16 v[12:15], v[44:47], v[108:111], v[12:15]
    ds_read_b64_tr_b16 v[64:65], v18 offset:25344
    ds_read_b64_tr_b16 v[66:67], v18 offset:25600
    ds_read_b128 v[108:111], v16 offset:57344
    s_waitcnt vmcnt(4)
    buffer_store_dword v25, off, s[36:39], s83 offset:256 sc1
    buffer_load_dword v29, v22, s[36:39], s82 offen offset:896 sc1
    s_waitcnt lgkmcnt(14)
    v_mfma_f32_16x16x32_bf16 v[12:15], v[48:51], v[112:115], v[12:15]
    ds_read_b64_tr_b16 v[68:69], v18 offset:29568
    ds_read_b64_tr_b16 v[70:71], v18 offset:29824
    ds_read_b128 v[112:115], v16 offset:58368
    s_waitcnt lgkmcnt(14)
    v_mfma_f32_16x16x32_bf16 v[12:15], v[52:55], v[116:119], v[12:15]
    ds_read_b64_tr_b16 v[72:73], v18 offset:33792
    ds_read_b64_tr_b16 v[74:75], v18 offset:34048
    ds_read_b128 v[116:119], v16 offset:59392
    s_waitcnt lgkmcnt(13)
    v_mfma_f32_16x16x32_bf16 v[12:15], v[56:59], v[120:123], v[12:15]
    ds_read_b64_tr_b16 v[76:77], v18 offset:38016
    ds_read_b64_tr_b16 v[78:79], v18 offset:38272
    ds_read_b128 v[120:123], v16 offset:60416
    s_waitcnt lgkmcnt(13)
    v_mfma_f32_16x16x32_bf16 v[12:15], v[60:63], v[124:127], v[12:15]
    ds_read_b64_tr_b16 v[80:81], v18 offset:42240
    ds_read_b64_tr_b16 v[82:83], v18 offset:42496
    ds_read_b128 v[124:127], v16 offset:61440
    s_waitcnt lgkmcnt(13)
    v_mfma_f32_16x16x32_bf16 v[12:15], v[64:67], v[32:35], v[12:15]
    ds_read_b64_tr_b16 v[84:85], v18 offset:46464
    ds_read_b64_tr_b16 v[86:87], v18 offset:46720
    ds_read_b128 v[32:35], v16 offset:62464
    s_waitcnt lgkmcnt(13)
    v_mfma_f32_16x16x32_bf16 v[12:15], v[68:71], v[104:107], v[12:15]
    ds_read_b64_tr_b16 v[88:89], v18 offset:50688
    ds_read_b64_tr_b16 v[90:91], v18 offset:50944
    ds_read_b128 v[104:107], v16 offset:63488
    s_waitcnt vmcnt(0)
    v_cmp_gt_u32 vcc, s72, v29
    s_add_u32 m0, s80, 16384
    s_bitcmp1_b32 s72, 0
    s_cselect_b64 s[40:41], s[24:25], s[16:17]
    s_waitcnt lgkmcnt(13)
    v_mfma_f32_16x16x32_bf16 v[12:15], v[72:75], v[108:111], v[12:15]
    ds_read_b64_tr_b16 v[92:93], v18 offset:54912
    ds_read_b64_tr_b16 v[94:95], v18 offset:55168
    ds_read_b128 v[108:111], v16 offset:64512
    s_waitcnt lgkmcnt(13)
    v_mfma_f32_16x16x32_bf16 v[12:15], v[76:79], v[112:115], v[12:15]
    ds_read_b64_tr_b16 v[96:97], v18 offset:59136
    ds_read_b64_tr_b16 v[98:99], v18 offset:59392
    s_cbranch_vccnz L_slow_81
L_back_82:
    buffer_load_dwordx4 v16, s[36:39], s93 offen offset:0 sc1 lds
    s_waitcnt lgkmcnt(12)
    v_mfma_f32_16x16x32_bf16 v[12:15], v[80:83], v[116:119], v[12:15]
    ds_read_b64_tr_b16 v[100:101], v18 offset:63360
    ds_read_b64_tr_b16 v[102:103], v18 offset:63616
    s_waitcnt lgkmcnt(11)
    v_mfma_f32_16x16x32_bf16 v[12:15], v[84:87], v[120:123], v[12:15]
    buffer_load_dwordx4 v16, s[36:39], s93 offen offset:1024 sc1 lds
    s_waitcnt lgkmcnt(8)
    v_mfma_f32_16x16x32_bf16 v[12:15], v[88:91], v[124:127], v[12:15]
    buffer_load_dword v29, v22, s[36:39], s82 offen offset:256 sc1
    s_waitcnt lgkmcnt(5)
    v_mfma_f32_16x16x32_bf16 v[12:15], v[92:95], v[32:35], v[12:15]
    buffer_load_dwordx4 v16, s[36:39], s93 offen offset:2048 sc1 lds
    s_waitcnt lgkmcnt(2)
    v_mfma_f32_16x16x32_bf16 v[12:15], v[96:99], v[104:107], v[12:15]
    s_waitcnt lgkmcnt(0)
    v_mfma_f32_16x16x32_bf16 v[12:15], v[100:103], v[108:111], v[12:15]
    s_barrier
    ds_read_b128 v[112:115], v16 offset:32768
    ds_read_b128 v[116:119], v16 offset:33792
    ds_read_b128 v[120:123], v16 offset:34816
    ds_read_b128 v[124:127], v16 offset:35840
    ds_read_b128 v[32:35], v16 offset:36864
    ds_read_b128 v[104:107], v16 offset:37888
    s_nop 0
    v_cvt_pk_bf16_f32 v36, v12, v13
    v_cvt_pk_bf16_f32 v37, v14, v15
    buffer_store_dwordx2 v[36:37], v19, s[36:39], s99 offen offset:0 sc1
    ds_read_b128 v[108:111], v16 offset:38912
    buffer_load_dwordx4 v16, s[36:39], s93 offen offset:3072 sc1 lds
    s_waitcnt lgkmcnt(6)
    v_mfma_f32_16x16x32_bf16 v[8:11], v[40:43], v[112:115], v[8:11]
    ds_read_b128 v[112:115], v16 offset:39936
    s_waitcnt lgkmcnt(6)
    v_mfma_f32_16x16x32_bf16 v[8:11], v[44:47], v[116:119], v[8:11]
    ds_read_b128 v[116:119], v16 offset:40960
    s_waitcnt lgkmcnt(6)
    v_mfma_f32_16x16x32_bf16 v[8:11], v[48:51], v[120:123], v[8:11]
    ds_read_b128 v[120:123], v16 offset:41984
    s_waitcnt lgkmcnt(6)
    v_mfma_f32_16x16x32_bf16 v[8:11], v[52:55], v[124:127], v[8:11]
    ds_read_b128 v[124:127], v16 offset:43008
    v_mul_f32 v39, v12, v12
    v_add_f32 v38, v12, v13
    v_fmac_f32 v39, v13, v13
    s_waitcnt lgkmcnt(6)
    v_mfma_f32_16x16x32_bf16 v[8:11], v[56:59], v[32:35], v[8:11]
    ds_read_b128 v[32:35], v16 offset:44032
    v_add_f32 v38, v38, v14
    s_waitcnt vmcnt(3)
    v_cmp_gt_u32 vcc, s72, v29
    s_add_u32 m0, s80, 0
    s_waitcnt lgkmcnt(6)
    v_mfma_f32_16x16x32_bf16 v[8:11], v[60:63], v[104:107], v[8:11]
    ds_read_b128 v[104:107], v16 offset:45056
    v_fmac_f32 v39, v14, v14
    v_add_f32 v38, v38, v15
    v_fmac_f32 v39, v15, v15
    s_waitcnt lgkmcnt(6)
    v_mfma_f32_16x16x32_bf16 v[8:11], v[64:67], v[108:111], v[8:11]
    ds_read_b128 v[108:111], v16 offset:46080
    v_permlane32_swap_b32 v38, v39
    s_cbranch_vccnz L_slow_75
L_back_76:
    buffer_load_dwordx4 v16, s[36:39], s92 offen offset:0 sc1 lds
    s_waitcnt lgkmcnt(6)
    v_mfma_f32_16x16x32_bf16 v[8:11], v[68:71], v[112:115], v[8:11]
    ds_read_b128 v[112:115], v16 offset:47104
    v_add_f32 v38, v38, v39
    v_mov_b32 v39, v38
    s_waitcnt lgkmcnt(6)
    v_mfma_f32_16x16x32_bf16 v[8:11], v[72:75], v[116:119], v[8:11]
    ds_read_b128 v[116:119], v16 offset:48128
    buffer_load_dwordx4 v16, s[36:39], s92 offen offset:1024 sc1 lds
    v_permlane16_swap_b32 v39, v38
    v_add_f32 v38, v38, v39
    s_waitcnt lgkmcnt(6)
    v_mfma_f32_16x16x32_bf16 v[8:11], v[76:79], v[120:123], v[8:11]
    ds_write_b32 v26, v38 offset:512
    s_waitcnt lgkmcnt(6)
    v_mfma_f32_16x16x32_bf16 v[8:11], v[80:83], v[124:127], v[8:11]
    buffer_load_dwordx4 v16, s[36:39], s92 offen offset:2048 sc1 lds
    s_waitcnt lgkmcnt(5)
    v_mfma_f32_16x16x32_bf16 v[8:11], v[84:87], v[32:35], v[8:11]
    s_waitcnt lgkmcnt(4)
    v_mfma_f32_16x16x32_bf16 v[8:11], v[88:91], v[104:107], v[8:11]
    buffer_load_dwordx4 v16, s[36:39], s92 offen offset:3072 sc1 lds
    s_waitcnt lgkmcnt(3)
    v_mfma_f32_16x16x32_bf16 v[8:11], v[92:95], v[108:111], v[8:11]
    s_waitcnt vmcnt(5)
    buffer_store_dword v25, off, s[36:39], s83 offset:384 sc1
    s_waitcnt lgkmcnt(2)
    v_mfma_f32_16x16x32_bf16 v[8:11], v[96:99], v[112:115], v[8:11]
    s_waitcnt lgkmcnt(1)
    v_mfma_f32_16x16x32_bf16 v[8:11], v[100:103], v[116:119], v[8:11]
    s_nop 7
    v_cvt_pk_bf16_f32 v36, v8, v9
    v_cvt_pk_bf16_f32 v37, v10, v11
    buffer_store_dwordx2 v[36:37], v19, s[36:39], s98 offen offset:0 sc1
    v_mul_f32 v39, v8, v8
    v_add_f32 v38, v8, v9
    v_fmac_f32 v39, v9, v9
    v_add_f32 v38, v38, v10
    v_fmac_f32 v39, v10, v10
    v_add_f32 v38, v38, v11
    v_fmac_f32 v39, v11, v11
    s_nop 1
    v_permlane32_swap_b32 v38, v39
    v_add_f32 v38, v38, v39
    v_mov_b32 v39, v38
    s_nop 1
    v_permlane16_swap_b32 v39, v38
    v_add_f32 v38, v38, v39
    ds_write_b32 v26, v38 offset:0
    s_waitcnt lgkmcnt(0)
    s_barrier
    ds_read_b128 v[36:39], v28 offset:0
    s_waitcnt lgkmcnt(0)
    v_add_f32 v36, v36, v37
    v_add_f32 v38, v38, v39
    v_add_f32 v36, v36, v38
    buffer_store_dword v36, v21, s[36:39], s87 offen offset:2048 sc1
    buffer_load_dword v29, v22, s[36:39], s82 offen offset:384 sc1
    s_waitcnt vmcnt(8)
    s_barrier
    ds_read_b128 v[120:123], v16 offset:16384
    ds_read_b128 v[124:127], v16 offset:17408
    ds_read_b128 v[32:35], v16 offset:18432
    ds_read_b128 v[104:107], v16 offset:19456
    ds_read_b128 v[108:111], v16 offset:20480
    ds_read_b128 v[112:115], v16 offset:21504
    ds_read_b128 v[116:119], v16 offset:22528
    s_waitcnt lgkmcnt(6)
    v_mfma_f32_16x16x32_bf16 v[4:7], v[40:43], v[120:123], v[4:7]
    ds_read_b128 v[120:123], v16 offset:23552
    s_waitcnt lgkmcnt(6)
    v_mfma_f32_16x16x32_bf16 v[4:7], v[44:47], v[124:127], v[4:7]
    ds_read_b128 v[124:127], v16 offset:24576
    s_waitcnt lgkmcnt(6)
    v_mfma_f32_16x16x32_bf16 v[4:7], v[48:51], v[32:35], v[4:7]
    ds_read_b128 v[32:35], v16 offset:25600
    s_waitcnt lgkmcnt(6)
    v_mfma_f32_16x16x32_bf16 v[4:7], v[52:55], v[104:107], v[4:7]
    ds_read_b128 v[104:107], v16 offset:26624
    s_waitcnt lgkmcnt(6)
    v_mfma_f32_16x16x32_bf16 v[4:7], v[56:59], v[108:111], v[4:7]
    ds_read_b128 v[108:111], v16 offset:27648
    s_waitcnt lgkmcnt(6)
    v_mfma_f32_16x16x32_bf16 v[4:7], v[60:63], v[112:115], v[4:7]
    ds_read_b128 v[112:115], v16 offset:28672
    s_waitcnt lgkmcnt(6)
    v_mfma_f32_16x16x32_bf16 v[4:7], v[64:67], v[116:119], v[4:7]
    ds_read_b128 v[116:119], v16 offset:29696
    s_waitcnt vmcnt(0)
    v_cmp_gt_u32 vcc, s72, v29
    s_add_u32 m0, s80, 49152
    buffer_store_dword v25, off, s[36:39], s83 offset:512 sc1
    s_waitcnt lgkmcnt(6)
    v_mfma_f32_16x16x32_bf16 v[4:7], v[68:71], v[120:123], v[4:7]
    ds_read_b128 v[120:123], v16 offset:30720
    s_waitcnt lgkmcnt(6)
    v_mfma_f32_16x16x32_bf16 v[4:7], v[72:75], v[124:127], v[4:7]
    ds_read_b128 v[124:127], v16 offset:31744
    s_cbranch_vccnz L_slow_78
L_back_79:
    buffer_load_dwordx4 v16, s[36:39], s7 offen offset:0 sc1 lds
    s_waitcnt lgkmcnt(6)
    v_mfma_f32_16x16x32_bf16 v[4:7], v[76:79], v[32:35], v[4:7]
    s_barrier
    ds_read_b128 v[32:35], v16 offset:0
    s_waitcnt lgkmcnt(6)
    v_mfma_f32_16x16x32_bf16 v[4:7], v[80:83], v[104:107], v[4:7]
    ds_read_b128 v[104:107], v16 offset:1024
    buffer_load_dwordx4 v16, s[36:39], s7 offen offset:1024 sc1 lds
    s_waitcnt lgkmcnt(6)
    v_mfma_f32_16x16x32_bf16 v[4:7], v[84:87], v[108:111], v[4:7]
    ds_read_b128 v[108:111], v16 offset:2048
    s_waitcnt lgkmcnt(6)
    v_mfma_f32_16x16x32_bf16 v[4:7], v[88:91], v[112:115], v[4:7]
    ds_read_b128 v[112:115], v16 offset:3072
    buffer_load_dwordx4 v16, s[36:39], s7 offen offset:2048 sc1 lds
    s_waitcnt lgkmcnt(6)
    v_mfma_f32_16x16x32_bf16 v[4:7], v[92:95], v[116:119], v[4:7]
    ds_read_b128 v[116:119], v16 offset:4096
    s_waitcnt lgkmcnt(6)
    v_mfma_f32_16x16x32_bf16 v[4:7], v[96:99], v[120:123], v[4:7]
    ds_read_b128 v[120:123], v16 offset:5120
    buffer_load_dwordx4 v16, s[36:39], s7 offen offset:3072 sc1 lds
    s_waitcnt lgkmcnt(6)
    v_mfma_f32_16x16x32_bf16 v[4:7], v[100:103], v[124:127], v[4:7]
    ds_read_b128 v[124:127], v16 offset:6144
    s_waitcnt lgkmcnt(6)
    v_mfma_f32_16x16x32_bf16 v[0:3], v[40:43], v[32:35], v[0:3]
    ds_read_b128 v[32:35], v16 offset:7168
    s_waitcnt lgkmcnt(6)
    v_mfma_f32_16x16x32_bf16 v[0:3], v[44:47], v[104:107], v[0:3]
    ds_read_b128 v[104:107], v16 offset:8192
    s_waitcnt lgkmcnt(6)
    v_mfma_f32_16x16x32_bf16 v[0:3], v[48:51], v[108:111], v[0:3]
    ds_read_b128 v[108:111], v16 offset:9216
    v_cvt_pk_bf16_f32 v36, v4, v5
    v_cvt_pk_bf16_f32 v37, v6, v7
    s_waitcnt lgkmcnt(6)
    v_mfma_f32_16x16x32_bf16 v[0:3], v[52:55], v[112:115], v[0:3]
    ds_read_b128 v[112:115], v16 offset:10240
    buffer_store_dwordx2 v[36:37], v19, s[36:39], s97 offen offset:0 sc1
    s_waitcnt lgkmcnt(6)
    v_mfma_f32_16x16x32_bf16 v[0:3], v[56:59], v[116:119], v[0:3]
    ds_read_b128 v[116:119], v16 offset:11264
    v_mul_f32 v39, v4, v4
    s_waitcnt lgkmcnt(6)
    v_mfma_f32_16x16x32_bf16 v[0:3], v[60:63], v[120:123], v[0:3]
    ds_read_b128 v[120:123], v16 offset:12288
    v_add_f32 v38, v4, v5
    s_waitcnt lgkmcnt(6)
    v_mfma_f32_16x16x32_bf16 v[0:3], v[64:67], v[124:127], v[0:3]
    ds_read_b128 v[124:127], v16 offset:13312
    v_fmac_f32 v39, v5, v5
    s_waitcnt lgkmcnt(6)
    v_mfma_f32_16x16x32_bf16 v[0:3], v[68:71], v[32:35], v[0:3]
    ds_read_b128 v[32:35], v16 offset:14336
    v_add_f32 v38, v38, v6
    s_waitcnt lgkmcnt(6)
    v_mfma_f32_16x16x32_bf16 v[0:3], v[72:75], v[104:107], v[0:3]
    ds_read_b128 v[104:107], v16 offset:15360
    v_fmac_f32 v39, v6, v6
    s_waitcnt lgkmcnt(6)
    v_mfma_f32_16x16x32_bf16 v[0:3], v[76:79], v[108:111], v[0:3]
    v_add_f32 v38, v38, v7
    v_fmac_f32 v39, v7, v7
    s_waitcnt lgkmcnt(5)
    v_mfma_f32_16x16x32_bf16 v[0:3], v[80:83], v[112:115], v[0:3]
    buffer_load_dword v29, v22, s[36:39], s82 offen offset:512 sc1
    v_permlane32_swap_b32 v38, v39
    s_waitcnt lgkmcnt(4)
    v_mfma_f32_16x16x32_bf16 v[0:3], v[84:87], v[116:119], v[0:3]
    v_add_f32 v38, v38, v39
    v_mov_b32 v39, v38
    s_waitcnt lgkmcnt(3)
    v_mfma_f32_16x16x32_bf16 v[0:3], v[88:91], v[120:123], v[0:3]
    s_waitcnt vmcnt(2)
    s_barrier
    ds_read_b128 v[64:67], v16 offset:49152
    s_waitcnt lgkmcnt(3)
    v_mfma_f32_16x16x32_bf16 v[0:3], v[92:95], v[124:127], v[0:3]
    ds_read_b128 v[68:71], v16 offset:50176
    v_permlane16_swap_b32 v39, v38
    s_waitcnt lgkmcnt(3)
    v_mfma_f32_16x16x32_bf16 v[0:3], v[96:99], v[32:35], v[0:3]
    ds_read_b128 v[72:75], v16 offset:51200
    s_waitcnt lgkmcnt(3)
    v_mfma_f32_16x16x32_bf16 v[0:3], v[100:103], v[104:107], v[0:3]
    v_add_f32 v38, v38, v39
    ds_write_b32 v26, v38 offset:1024
    s_bitcmp1_b32 s72, 0
    s_cbranch_scc1 L_qkvBS
L_qkvAS:
    s_waitcnt lgkmcnt(3)
    v_mfma_f32_16x16x32_bf16 v[40:43], a[0:3], v[64:67], 0
    ds_read_b128 v[76:79], v16 offset:52224
    v_mfma_f32_16x16x32_bf16 v[44:47], a[4:7], v[64:67], 0
    s_waitcnt vmcnt(1)
    buffer_store_dword v25, off, s[36:39], s83 offset:640 sc1
    v_cvt_pk_bf16_f32 v36, v0, v1
    v_cvt_pk_bf16_f32 v37, v2, v3
    v_mfma_f32_16x16x32_bf16 v[48:51], v[64:67], a[8:11], 0
    s_waitcnt lgkmcnt(3)
    buffer_store_dwordx2 v[36:37], v19, s[36:39], s96 offen offset:0 sc1
    v_mul_f32 v39, v0, v0
    v_mfma_f32_16x16x32_bf16 v[40:43], a[12:15], v[68:71], v[40:43]
    ds_read_b128 v[64:67], v16 offset:53248
    v_add_f32 v38, v0, v1
    v_fmac_f32 v39, v1, v1
    v_mfma_f32_16x16x32_bf16 v[44:47], a[16:19], v[68:71], v[44:47]
    v_add_f32 v38, v38, v2
    v_fmac_f32 v39, v2, v2
    v_mfma_f32_16x16x32_bf16 v[48:51], v[68:71], a[20:23], v[48:51]
    s_waitcnt lgkmcnt(3)
    v_add_f32 v38, v38, v3
    v_fmac_f32 v39, v3, v3
    v_mfma_f32_16x16x32_bf16 v[40:43], a[24:27], v[72:75], v[40:43]
    ds_read_b128 v[68:71], v16 offset:54272
    v_permlane32_swap_b32 v38, v39
    v_mfma_f32_16x16x32_bf16 v[44:47], a[28:31], v[72:75], v[44:47]
    s_waitcnt vmcnt(2)
    v_add_f32 v38, v38, v39
    v_mov_b32 v39, v38
    v_cmp_gt_u32 vcc, s72, v29
    v_mfma_f32_16x16x32_bf16 v[48:51], v[72:75], a[32:35], v[48:51]
    s_waitcnt lgkmcnt(2)
    v_permlane16_swap_b32 v39, v38
    v_mfma_f32_16x16x32_bf16 v[40:43], a[36:39], v[76:79], v[40:43]
    s_cbranch_vccnz L_slow_84
L_back_85:
    v_add_f32 v38, v38, v39
    ds_write_b32 v26, v38 offset:512
    ds_read_b128 v[72:75], v16 offset:55296
    v_mfma_f32_16x16x32_bf16 v[44:47], a[40:43], v[76:79], v[44:47]
    s_lshl_b32 s74, s68, 8
    buffer_load_dwordx4 v[118:121], v16, s[36:39], s86 offen offset:2048 sc1
    v_add_u32 v84, s74, v24
    v_add_u32 v88, s74, v23
    v_mfma_f32_16x16x32_bf16 v[48:51], v[76:79], a[44:47], v[48:51]
    s_waitcnt lgkmcnt(3)
    buffer_load_dwordx4 v[122:125], v16, s[36:39], s86 offen offset:3072 sc1
    ds_read_b128 v[80:83], v84 offset:2048
    v_mfma_f32_16x16x32_bf16 v[40:43], a[48:51], v[64:67], v[40:43]
    ds_read_b128 v[76:79], v16 offset:56320
    ds_read_b128 v[84:87], v84 offset:2112
    ds_read_b32 v88, v88 offset:2176
    v_mfma_f32_16x16x32_bf16 v[44:47], a[52:55], v[64:67], v[44:47]
    s_add_u32 m0, s80, 32768
    ds_read_b128 v[30:33], v28 offset:3584
    ds_read_b64 v[38:39], v28 offset:4608
    v_mfma_f32_16x16x32_bf16 v[48:51], v[64:67], a[56:59], v[48:51]
    s_waitcnt lgkmcnt(8)
    buffer_load_dwordx4 v16, s[36:39], s6 offen offset:0 sc1 lds
    v_mov_b32 v34, 0x3f803f80
    v_mov_b32 v35, 0x3f803f80
    v_mfma_f32_16x16x32_bf16 v[40:43], a[60:63], v[68:71], v[40:43]
    s_waitcnt lgkmcnt(7)
    s_barrier
    ds_read_b128 v[64:67], v16 offset:57344
    v_mfma_f32_16x16x32_bf16 v[44:47], a[64:67], v[68:71], v[44:47]
    ds_read_b128 v[106:109], v28 offset:512
    v_mov_b32 v36, 0x3f803f80
    v_mov_b32 v37, 0x3f803f80
    v_mfma_f32_16x16x32_bf16 v[48:51], v[68:71], a[68:71], v[48:51]
    s_waitcnt lgkmcnt(8)
    buffer_load_dwordx4 v16, s[36:39], s6 offen offset:1024 sc1 lds
    v_mfma_f32_16x16x32_bf16 v[40:43], a[72:75], v[72:75], v[40:43]
    ds_read_b128 v[68:71], v16 offset:58368
    v_mfma_f32_16x16x32_bf16 v[44:47], a[76:79], v[72:75], v[44:47]
    v_mfma_f32_16x16x32_bf16 v[48:51], v[72:75], a[80:83], v[48:51]
    s_waitcnt lgkmcnt(7)
    buffer_load_dwordx4 v16, s[36:39], s6 offen offset:2048 sc1 lds
    v_mfma_f32_16x16x32_bf16 v[40:43], a[84:87], v[76:79], v[40:43]
    s_waitcnt lgkmcnt(1)
    ds_read_b128 v[72:75], v16 offset:59392
    v_add_f32 v106, v106, v107
    v_add_f32 v108, v108, v109
    v_mfma_f32_16x16x32_bf16 v[44:47], a[88:91], v[76:79], v[44:47]
    v_add_f32 v106, v106, v108
    v_mfma_f32_16x16x32_bf16 v[48:51], v[76:79], a[92:95], v[48:51]
    buffer_load_dwordx4 v16, s[36:39], s6 offen offset:3072 sc1 lds
    buffer_store_dword v106, v21, s[36:39], s87 offen offset:0 sc1
    v_mfma_f32_16x16x32_bf16 v[40:43], a[96:99], v[64:67], v[40:43]
    ds_read_b128 v[76:79], v16 offset:60416
    v_mfma_f32_16x16x32_bf16 v[44:47], a[100:103], v[64:67], v[44:47]
    v_mfma_f32_16x16x32_bf16 v[48:51], v[64:67], a[104:107], v[48:51]
    s_waitcnt lgkmcnt(2)
    s_waitcnt vmcnt(5)
    v_add_f32 v118, v118, v122
    v_add_f32 v120, v120, v124
    v_mfma_f32_16x16x32_bf16 v[40:43], a[108:111], v[68:71], v[40:43]
    ds_read_b128 v[64:67], v16 offset:61440
    v_add_f32 v119, v119, v123
    v_add_f32 v121, v121, v125
    v_mfma_f32_16x16x32_bf16 v[44:47], a[112:115], v[68:71], v[44:47]
    buffer_load_dword v29, v22, s[36:39], s82 offen offset:640 sc1
    v_permlane32_swap_b32 v118, v120
    v_mfma_f32_16x16x32_bf16 v[48:51], v[68:71], a[116:119], v[48:51]
    s_waitcnt lgkmcnt(2)
    v_permlane32_swap_b32 v119, v121
    v_mfma_f32_16x16x32_bf16 v[40:43], a[120:123], v[72:75], v[40:43]
    s_add_u32 s3, s19, 0
    s_and_b32 s3, s3, 0x7ffff
    ds_read_b128 v[68:71], v16 offset:62464
    v_mfma_f32_16x16x32_bf16 v[44:47], a[124:127], v[72:75], v[44:47]
    s_add_u32 m0, s81, 65536
    v_add_f32 v118, v118, v120
    v_add_f32 v119, v119, v121
    v_mfma_f32_16x16x32_bf16 v[48:51], v[72:75], a[128:131], v[48:51]
    s_waitcnt lgkmcnt(2)
    buffer_load_dwordx4 v17, s[40:43], s3 offen offset:0 lds
    v_permlane16_swap_b32 v118, v119
    v_mfma_f32_16x16x32_bf16 v[40:43], a[132:135], v[76:79], v[40:43]
    ds_read_b128 v[72:75], v16 offset:63488
    v_add_f32 v118, v118, v119
    v_mfma_f32_16x16x32_bf16 v[44:47], a[136:139], v[76:79], v[44:47]
    v_mul_f32 v119, 0x3b000000, v118
    v_mul_f32 v118, 0x3b000000, v118
    v_mfma_f32_16x16x32_bf16 v[48:51], v[76:79], a[140:143], v[48:51]
    s_waitcnt lgkmcnt(2)
    v_permlane16_swap_b32 v118, v119
    v_fma_f32 v119, -v118, v118, v119
    v_mfma_f32_16x16x32_bf16 v[40:43], a[144:147], v[64:67], v[40:43]
    ds_read_b128 v[76:79], v16 offset:64512
    v_max_f32 v119, 0, v119
    v_cvt_pk_bf16_f32 v119, v118, v119
    v_mfma_f32_16x16x32_bf16 v[44:47], a[148:151], v[64:67], v[44:47]
    v_lshlrev_b32 v118, 16, v119
    v_and_b32 v119, 0xffff0000, v119
    v_mfma_f32_16x16x32_bf16 v[48:51], v[64:67], a[152:155], v[48:51]
    s_waitcnt lgkmcnt(2)
    v_add_f32 v119, 0x3727c5ac, v119
    v_cvt_pk_bf16_f32 v119, v119, v119
    v_and_b32 v119, 0xffff0000, v119
    v_mfma_f32_16x16x32_bf16 v[40:43], a[156:159], v[68:71], v[40:43]
    s_waitcnt vmcnt(3)
    s_barrier
    ds_read_b128 v[64:67], v16 offset:32768
    v_mfma_f32_16x16x32_bf16 v[44:47], a[160:163], v[68:71], v[44:47]
    s_waitcnt vmcnt(1)
    v_cmp_gt_u32 vcc, s72, v29
    buffer_store_dword v25, off, s[36:39], s83 offset:768 sc1
    v_add_u32 v25, 1, v25
    v_mfma_f32_16x16x32_bf16 v[48:51], v[68:71], a[164:167], v[48:51]
    s_waitcnt lgkmcnt(2)
    v_sqrt_f32 v119, v119
    v_mfma_f32_16x16x32_bf16 v[40:43], a[168:171], v[72:75], v[40:43]
    ds_read_b128 v[68:71], v16 offset:33792
    v_xor_b32 v118, 0x80000000, v118
    v_mfma_f32_16x16x32_bf16 v[44:47], a[172:175], v[72:75], v[44:47]
    s_cbranch_vccnz L_slow_87
L_back_88:
    s_add_u32 m0, s80, 16384
    v_cvt_pk_bf16_f32 v119, v119, v119
    v_and_b32 v119, 0xffff0000, v119
    v_mfma_f32_16x16x32_bf16 v[48:51], v[72:75], a[176:179], v[48:51]
    s_waitcnt lgkmcnt(2)
    buffer_load_dwordx4 v16, s[36:39], s5 offen offset:0 sc1 lds
    v_rcp_f32 v119, v119
    v_mfma_f32_16x16x32_bf16 v[40:43], a[180:183], v[76:79], v[40:43]
    ds_read_b128 v[72:75], v16 offset:34816
    ds_write2_b32 v27, v119, v118 offset0:32 offset1:96
    v_mfma_f32_16x16x32_bf16 v[44:47], a[184:187], v[76:79], v[44:47]
    ds_read2_b32 v[114:115], v23 offset0:48 offset1:112
    ds_read_b128 v[106:109], v24 offset:192
    ds_read_b128 v[110:113], v24 offset:448
    v_mfma_f32_16x16x32_bf16 v[48:51], v[76:79], a[188:191], v[48:51]
    s_waitcnt lgkmcnt(6)
    buffer_load_dwordx4 v16, s[36:39], s5 offen offset:1024 sc1 lds
    v_mfma_f32_16x16x32_bf16 v[52:55], a[0:3], v[64:67], 0
    ds_read_b128 v[76:79], v16 offset:35840
    v_mfma_f32_16x16x32_bf16 v[56:59], a[4:7], v[64:67], 0
    v_mfma_f32_16x16x32_bf16 v[60:63], v[64:67], a[8:11], 0
    s_waitcnt lgkmcnt(6)
    buffer_load_dwordx4 v16, s[36:39], s5 offen offset:2048 sc1 lds
    s_waitcnt lgkmcnt(3)
    v_fma_f32 v44, v115, v84, v44
    v_mfma_f32_16x16x32_bf16 v[52:55], a[12:15], v[68:71], v[52:55]
    ds_read_b128 v[64:67], v16 offset:36864
    v_fma_f32 v45, v115, v85, v45
    v_fma_f32 v46, v115, v86, v46
    v_mfma_f32_16x16x32_bf16 v[56:59], a[16:19], v[68:71], v[56:59]
    v_fma_f32 v47, v115, v87, v47
    v_mul_f32 v44, v114, v44
    v_mfma_f32_16x16x32_bf16 v[60:63], v[68:71], a[20:23], v[60:63]
    buffer_load_dwordx4 v16, s[36:39], s5 offen offset:3072 sc1 lds
    v_mul_f32 v45, v114, v45
    v_mul_f32 v46, v114, v46
    v_mfma_f32_16x16x32_bf16 v[52:55], a[24:27], v[72:75], v[52:55]
    ds_read_b128 v[68:71], v16 offset:37888
    v_mul_f32 v47, v114, v47
    v_mfma_f32_16x16x32_bf16 v[56:59], a[28:31], v[72:75], v[56:59]
    v_cvt_pk_bf16_f32 v90, v44, v45
    v_cvt_pk_bf16_f32 v91, v46, v47
    s_waitcnt lgkmcnt(3)
    v_fma_f32 v48, v110, v88, v48
    v_mfma_f32_16x16x32_bf16 v[60:63], v[72:75], a[32:35], v[60:63]
    s_waitcnt lgkmcnt(2)
    v_fma_f32 v49, v111, v88, v49
    v_mfma_f32_16x16x32_bf16 v[52:55], a[36:39], v[76:79], v[52:55]
    ds_read_b128 v[72:75], v16 offset:38912
    v_fma_f32 v50, v112, v88, v50
    v_fma_f32 v51, v113, v88, v51
    v_mfma_f32_16x16x32_bf16 v[56:59], a[40:43], v[76:79], v[56:59]
    s_add_u32 m0, s81, 65568
    v_mul_f32 v48, v106, v48
    v_mul_f32 v49, v107, v49
    v_mfma_f32_16x16x32_bf16 v[60:63], v[76:79], a[44:47], v[60:63]
    s_waitcnt lgkmcnt(2)
    buffer_load_dwordx4 v17, s[40:43], s3 offen offset:1024 lds
    v_mul_f32 v50, v108, v50
    v_mfma_f32_16x16x32_bf16 v[52:55], a[48:51], v[64:67], v[52:55]
    ds_read_b128 v[76:79], v16 offset:39936
    v_mul_f32 v51, v109, v51
    v_cvt_pk_bf16_f32 v92, v48, v49
    v_mfma_f32_16x16x32_bf16 v[56:59], a[52:55], v[64:67], v[56:59]
    buffer_load_dword v29, v22, s[36:39], s82 offen offset:768 sc1
    v_cvt_pk_bf16_f32 v93, v50, v51
    v_mfma_f32_16x16x32_bf16 v[60:63], v[64:67], a[56:59], v[60:63]
    s_waitcnt lgkmcnt(2)
    v_fma_f32 v40, v115, v80, v40
    v_fma_f32 v41, v115, v81, v41
    v_fma_f32 v42, v115, v82, v42
    v_mfma_f32_16x16x32_bf16 v[52:55], a[60:63], v[68:71], v[52:55]
    ds_read_b128 v[64:67], v16 offset:40960
    v_fma_f32 v43, v115, v83, v43
    v_mfma_f32_16x16x32_bf16 v[56:59], a[64:67], v[68:71], v[56:59]
    v_cvt_pk_bf16_f32 v102, v40, v41
    v_cvt_pk_bf16_f32 v103, v42, v43
    v_mul_f32 v89, 0x3eb8aa3b, v114
    v_mfma_f32_16x16x32_bf16 v[60:63], v[68:71], a[68:71], v[60:63]
    s_waitcnt lgkmcnt(2)
    ds_read2_b32 v[114:115], v23 offset0:32 offset1:96
    ds_read_b128 v[106:109], v24 offset:128
    v_mfma_f32_16x16x32_bf16 v[52:55], a[72:75], v[72:75], v[52:55]
    ds_read_b128 v[68:71], v16 offset:41984
    ds_read_b128 v[110:113], v24 offset:384
    v_mfma_f32_16x16x32_bf16 v[56:59], a[76:79], v[72:75], v[56:59]
    s_add_u32 m0, s81, 65600
    v_mfma_f32_16x16x32_bf16 v[60:63], v[72:75], a[80:83], v[60:63]
    s_waitcnt lgkmcnt(5)
    buffer_load_dwordx4 v17, s[40:43], s3 offen offset:2048 lds
    v_mfma_f32_16x16x32_bf16 v[52:55], a[84:87], v[76:79], v[52:55]
    ds_read_b128 v[72:75], v16 offset:43008
    v_mfma_f32_16x16x32_bf16 v[56:59], a[88:91], v[76:79], v[56:59]
    v_mfma_f32_16x16x32_bf16 v[60:63], v[76:79], a[92:95], v[60:63]
    s_waitcnt lgkmcnt(5)
    v_mfma_f32_16x16x32_bf16 v[52:55], a[96:99], v[64:67], v[52:55]
    ds_read_b128 v[76:79], v16 offset:44032
    v_mfma_f32_16x16x32_bf16 v[56:59], a[100:103], v[64:67], v[56:59]
    s_waitcnt vmcnt(1)
    v_cmp_gt_u32 vcc, s72, v29
    v_mfma_f32_16x16x32_bf16 v[60:63], v[64:67], a[104:107], v[60:63]
    s_waitcnt lgkmcnt(3)
    v_mfma_f32_16x16x32_bf16 v[52:55], a[108:111], v[68:71], v[52:55]
    s_cbranch_vccnz L_slow_90
L_back_91:
    s_add_u32 s72, s72, 1
    ds_read_b128 v[64:67], v16 offset:45056
    v_mfma_f32_16x16x32_bf16 v[56:59], a[112:115], v[68:71], v[56:59]
    buffer_load_dwordx4 v[118:121], v16, s[36:39], s86 offen offset:0 sc1
    v_mfma_f32_16x16x32_bf16 v[60:63], v[68:71], a[116:119], v[60:63]
    s_waitcnt lgkmcnt(2)
    buffer_load_dwordx4 v[122:125], v16, s[36:39], s86 offen offset:1024 sc1
    v_mfma_f32_16x16x32_bf16 v[52:55], a[120:123], v[72:75], v[52:55]
    ds_read_b128 v[68:71], v16 offset:46080
    v_mfma_f32_16x16x32_bf16 v[56:59], a[124:127], v[72:75], v[56:59]
    s_add_u32 m0, s80, 0
    v_mfma_f32_16x16x32_bf16 v[60:63], v[72:75], a[128:131], v[60:63]
    s_waitcnt lgkmcnt(2)
    buffer_load_dwordx4 v16, s[36:39], s4 offen offset:0 sc1 lds
    v_mfma_f32_16x16x32_bf16 v[52:55], a[132:135], v[76:79], v[52:55]
    ds_read_b128 v[72:75], v16 offset:47104
    v_mfma_f32_16x16x32_bf16 v[56:59], a[136:139], v[76:79], v[56:59]
    v_mfma_f32_16x16x32_bf16 v[60:63], v[76:79], a[140:143], v[60:63]
    s_waitcnt lgkmcnt(2)
    buffer_load_dwordx4 v16, s[36:39], s4 offen offset:1024 sc1 lds
    v_mfma_f32_16x16x32_bf16 v[52:55], a[144:147], v[64:67], v[52:55]
    ds_read_b128 v[76:79], v16 offset:48128
    v_mfma_f32_16x16x32_bf16 v[56:59], a[148:151], v[64:67], v[56:59]
    v_mfma_f32_16x16x32_bf16 v[60:63], v[64:67], a[152:155], v[60:63]
    s_waitcnt lgkmcnt(2)
    buffer_load_dwordx4 v16, s[36:39], s4 offen offset:2048 sc1 lds
    v_mfma_f32_16x16x32_bf16 v[52:55], a[156:159], v[68:71], v[52:55]
    s_barrier
    ds_read_b128 v[64:67], v16 offset:16384
    v_mfma_f32_16x16x32_bf16 v[56:59], a[160:163], v[68:71], v[56:59]
    v_mfma_f32_16x16x32_bf16 v[60:63], v[68:71], a[164:167], v[60:63]
    s_waitcnt lgkmcnt(2)
    buffer_load_dwordx4 v16, s[36:39], s4 offen offset:3072 sc1 lds
    v_mfma_f32_16x16x32_bf16 v[52:55], a[168:171], v[72:75], v[52:55]
    ds_read_b128 v[68:71], v16 offset:17408
    v_mfma_f32_16x16x32_bf16 v[56:59], a[172:175], v[72:75], v[56:59]
    v_min_u32 v93, -2, v93
    v_mfma_f32_16x16x32_bf16 v[60:63], v[72:75], a[176:179], v[60:63]
    s_waitcnt lgkmcnt(2)
    buffer_store_dwordx4 v[90:93], v16, s[36:39], s84 offen sc1
    v_mfma_f32_16x16x32_bf16 v[52:55], a[180:183], v[76:79], v[52:55]
    ds_read_b128 v[72:75], v16 offset:18432
    s_waitcnt vmcnt(5)
    v_add_f32 v118, v118, v122
    v_mfma_f32_16x16x32_bf16 v[56:59], a[184:187], v[76:79], v[56:59]
    s_add_u32 s84, s84, 0x8000
    v_add_f32 v120, v120, v124
    v_add_f32 v119, v119, v123
    v_mfma_f32_16x16x32_bf16 v[60:63], v[76:79], a[188:191], v[60:63]
    v_add_f32 v121, v121, v125
    v_permlane32_swap_b32 v118, v120
    s_waitcnt lgkmcnt(2)
    v_mfma_f32_16x16x32_bf16 v[40:43], a[0:3], v[64:67], 0
    ds_read_b128 v[76:79], v16 offset:19456
    v_permlane32_swap_b32 v119, v121
    v_mfma_f32_16x16x32_bf16 v[44:47], a[4:7], v[64:67], 0
    s_add_u32 m0, s81, 65632
    v_add_f32 v118, v118, v120
    v_add_f32 v119, v119, v121
    v_mfma_f32_16x16x32_bf16 v[48:51], v[64:67], a[8:11], 0
    s_waitcnt lgkmcnt(2)
    buffer_load_dwordx4 v17, s[40:43], s3 offen offset:3072 lds
    v_permlane16_swap_b32 v118, v119
    v_mfma_f32_16x16x32_bf16 v[40:43], a[12:15], v[68:71], v[40:43]
    ds_read_b128 v[64:67], v16 offset:20480
    v_add_f32 v118, v118, v119
    v_mfma_f32_16x16x32_bf16 v[44:47], a[16:19], v[68:71], v[44:47]
    v_mul_f32 v119, 0x3b000000, v118
    v_mul_f32 v118, 0x3b000000, v118
    v_fma_f32 v56, v115, v84, v56
    v_mfma_f32_16x16x32_bf16 v[48:51], v[68:71], a[20:23], v[48:51]
    s_waitcnt lgkmcnt(2)
    v_permlane16_swap_b32 v118, v119
    v_fma_f32 v119, -v118, v118, v119
    v_mfma_f32_16x16x32_bf16 v[40:43], a[24:27], v[72:75], v[40:43]
    s_add_u32 s3, s19, 131072
    s_and_b32 s3, s3, 0x7ffff
    ds_read_b128 v[68:71], v16 offset:21504
    v_mfma_f32_16x16x32_bf16 v[44:47], a[28:31], v[72:75], v[44:47]
    s_add_u32 m0, s81, 82432
    v_max_f32 v119, 0, v119
    v_cvt_pk_bf16_f32 v119, v118, v119
    v_lshlrev_b32 v118, 16, v119
    v_mfma_f32_16x16x32_bf16 v[48:51], v[72:75], a[32:35], v[48:51]
    s_waitcnt lgkmcnt(2)
    buffer_load_dwordx4 v17, s[40:43], s3 offen offset:0 lds
    v_and_b32 v119, 0xffff0000, v119
    v_mfma_f32_16x16x32_bf16 v[40:43], a[36:39], v[76:79], v[40:43]
    ds_read_b128 v[72:75], v16 offset:22528
    v_add_f32 v119, 0x3727c5ac, v119
    v_cvt_pk_bf16_f32 v119, v119, v119
    v_mfma_f32_16x16x32_bf16 v[44:47], a[40:43], v[76:79], v[44:47]
    v_and_b32 v119, 0xffff0000, v119
    v_sqrt_f32 v119, v119
    v_mfma_f32_16x16x32_bf16 v[48:51], v[76:79], a[44:47], v[48:51]
    s_waitcnt lgkmcnt(2)
    v_xor_b32 v118, 0x80000000, v118
    v_cvt_pk_bf16_f32 v119, v119, v119
    v_mfma_f32_16x16x32_bf16 v[40:43], a[48:51], v[64:67], v[40:43]
    ds_read_b128 v[76:79], v16 offset:23552
    v_and_b32 v119, 0xffff0000, v119
    v_rcp_f32 v119, v119
    v_mfma_f32_16x16x32_bf16 v[44:47], a[52:55], v[64:67], v[44:47]
    s_add_u32 m0, s81, 82464
    ds_write2_b32 v27, v119, v118 offset0:0 offset1:64
    v_mfma_f32_16x16x32_bf16 v[48:51], v[64:67], a[56:59], v[48:51]
    s_waitcnt lgkmcnt(3)
    buffer_load_dwordx4 v17, s[40:43], s3 offen offset:1024 lds
    v_fma_f32 v57, v115, v85, v57
    v_fma_f32 v58, v115, v86, v58
    v_mfma_f32_16x16x32_bf16 v[40:43], a[60:63], v[68:71], v[40:43]
    ds_read_b128 v[64:67], v16 offset:24576
    v_fma_f32 v59, v115, v87, v59
    v_mul_f32 v56, v114, v56
    v_mfma_f32_16x16x32_bf16 v[44:47], a[64:67], v[68:71], v[44:47]
    v_mul_f32 v57, v114, v57
    v_mul_f32 v58, v114, v58
    v_mul_f32 v59, v114, v59
    v_mfma_f32_16x16x32_bf16 v[48:51], v[68:71], a[68:71], v[48:51]
    s_waitcnt lgkmcnt(3)
    v_cvt_pk_bf16_f32 v98, v56, v57
    v_cvt_pk_bf16_f32 v99, v58, v59
    v_fma_f32 v52, v115, v80, v52
    v_mfma_f32_16x16x32_bf16 v[40:43], a[72:75], v[72:75], v[40:43]
    ds_read_b128 v[68:71], v16 offset:25600
    v_fma_f32 v53, v115, v81, v53
    v_mfma_f32_16x16x32_bf16 v[44:47], a[76:79], v[72:75], v[44:47]
    s_add_u32 m0, s81, 82496
    v_fma_f32 v54, v115, v82, v54
    v_fma_f32 v55, v115, v83, v55
    v_cvt_pk_bf16_f32 v104, v52, v53
    v_mfma_f32_16x16x32_bf16 v[48:51], v[72:75], a[80:83], v[48:51]
    s_waitcnt lgkmcnt(3)
    buffer_load_dwordx4 v17, s[40:43], s3 offen offset:2048 lds
    v_cvt_pk_bf16_f32 v105, v54, v55
    v_mfma_f32_16x16x32_bf16 v[40:43], a[84:87], v[76:79], v[40:43]
    ds_read_b128 v[72:75], v16 offset:26624
    v_mul_f32 v116, 0x3eb8aa3b, v114
    v_mfma_f32_16x16x16_bf16 v[52:55], v[90:91], v[102:103], v[30:33]
    v_mfma_f32_16x16x16_bf16 v[56:59], v[98:99], v[102:103], v[30:33]
    v_fma_f32 v60, v110, v88, v60
    v_fma_f32 v61, v111, v88, v61
    v_fma_f32 v62, v112, v88, v62
    v_mfma_f32_16x16x32_bf16 v[44:47], a[88:91], v[76:79], v[44:47]
    v_fma_f32 v63, v113, v88, v63
    v_mul_f32 v60, v106, v60
    v_mul_f32 v61, v107, v61
    v_mfma_f32_16x16x32_bf16 v[48:51], v[76:79], a[92:95], v[48:51]
    s_waitcnt lgkmcnt(2)
    v_cndmask_b32 v52, v56, v52, s[60:61]
    v_cndmask_b32 v53, v57, v53, s[62:63]
    v_cndmask_b32 v54, v58, v54, s[64:65]
    v_mfma_f32_16x16x32_bf16 v[40:43], a[96:99], v[64:67], v[40:43]
    ds_read_b128 v[76:79], v16 offset:27648
    v_cndmask_b32 v55, v59, v55, s[66:67]
    v_max3_f32 v56, v52, v53, v54
    v_mfma_f32_16x16x32_bf16 v[44:47], a[100:103], v[64:67], v[44:47]
    s_add_u32 m0, s81, 82528
    v_max_f32 v56, v56, v55
    v_mov_b32 v57, v56
    v_mfma_f32_16x16x32_bf16 v[48:51], v[64:67], a[104:107], v[48:51]
    s_waitcnt lgkmcnt(2)
    buffer_load_dwordx4 v17, s[40:43], s3 offen offset:3072 lds
    v_permlane32_swap_b32 v57, v56
    v_mfma_f32_16x16x32_bf16 v[40:43], a[108:111], v[68:71], v[40:43]
    ds_read_b128 v[64:67], v16 offset:28672
    v_max_f32 v56, v56, v57
    v_mov_b32 v57, v56
    v_mfma_f32_16x16x32_bf16 v[44:47], a[112:115], v[68:71], v[44:47]
    v_mul_f32 v62, v108, v62
    v_permlane16_swap_b32 v57, v56
    v_mfma_f32_16x16x32_bf16 v[48:51], v[68:71], a[116:119], v[48:51]
    s_waitcnt lgkmcnt(2)
    v_max_f32 v56, v56, v57
    v_mul_f32 v56, v56, v89
    v_fma_f32 v52, v52, v89, -v56
    v_mfma_f32_16x16x32_bf16 v[40:43], a[120:123], v[72:75], v[40:43]
    s_add_u32 s3, s19, 262144
    s_and_b32 s3, s3, 0x7ffff
    ds_read_b128 v[68:71], v16 offset:29696
    v_fma_f32 v53, v53, v89, -v56
    v_mfma_f32_16x16x32_bf16 v[44:47], a[124:127], v[72:75], v[44:47]
    s_add_u32 m0, s81, 99328
    v_fma_f32 v54, v54, v89, -v56
    v_fma_f32 v55, v55, v89, -v56
    v_mfma_f32_16x16x32_bf16 v[48:51], v[72:75], a[128:131], v[48:51]
    s_waitcnt lgkmcnt(2)
    buffer_load_dwordx4 v17, s[40:43], s3 offen offset:0 lds
    v_exp_f32 v52, v52
    v_mfma_f32_16x16x32_bf16 v[40:43], a[132:135], v[76:79], v[40:43]
    ds_read_b128 v[72:75], v16 offset:30720
    v_exp_f32 v53, v53
    v_mfma_f32_16x16x32_bf16 v[44:47], a[136:139], v[76:79], v[44:47]
    v_exp_f32 v54, v54
    v_mfma_f32_16x16x32_bf16 v[48:51], v[76:79], a[140:143], v[48:51]
    s_waitcnt lgkmcnt(2)
    v_exp_f32 v55, v55
    v_cvt_pk_bf16_f32 v58, v52, v53
    v_mfma_f32_16x16x32_bf16 v[40:43], a[144:147], v[64:67], v[40:43]
    ds_read_b128 v[76:79], v16 offset:31744
    v_cvt_pk_bf16_f32 v59, v54, v55
    v_mul_f32 v63, v109, v63
    v_mfma_f32_16x16x32_bf16 v[44:47], a[148:151], v[64:67], v[44:47]
    s_add_u32 m0, s81, 99360
    v_cvt_pk_bf16_f32 v94, v60, v61
    v_cvt_pk_bf16_f32 v95, v62, v63
    v_mfma_f32_16x16x32_bf16 v[48:51], v[64:67], a[152:155], v[48:51]
    s_waitcnt lgkmcnt(2)
    buffer_load_dwordx4 v17, s[40:43], s3 offen offset:1024 lds
    ds_read2_b32 v[114:115], v23 offset0:16 offset1:80
    ds_read_b128 v[106:109], v24 offset:64
    v_mfma_f32_16x16x32_bf16 v[40:43], a[156:159], v[68:71], v[40:43]
    ds_read_b128 v[110:113], v24 offset:320
    s_waitcnt vmcnt(8)
    s_barrier
    ds_read_b128 v[64:67], v16 offset:0
    v_mfma_f32_16x16x32_bf16 v[44:47], a[160:163], v[68:71], v[44:47]
    v_and_b32 v60, v38, v58
    v_and_b32 v61, v39, v59
    v_xor_b32 v62, v60, v58
    v_xor_b32 v63, v61, v59
    v_mfma_f32_16x16x32_bf16 v[48:51], v[68:71], a[164:167], v[48:51]
    s_nop 0
    v_mfma_f32_16x16x32_bf16 v[56:59], v[34:37], v[60:63], 0
    v_mfma_f32_16x16x32_bf16 v[52:55], v[92:95], v[60:63], 0
    s_nop 6
    v_rcp_f32 v56, v56
    s_nop 0
    v_mul_f32 v52, v56, v52
    v_mul_f32 v53, v56, v53
    v_mul_f32 v54, v56, v54
    v_mul_f32 v55, v56, v55
    v_cvt_pk_bf16_f32 v60, v52, v53
    v_cvt_pk_bf16_f32 v61, v54, v55
    buffer_store_dwordx2 v[60:61], v19, s[36:39], s91 offen offset:0 sc1
    s_waitcnt lgkmcnt(5)
    v_mfma_f32_16x16x32_bf16 v[40:43], a[168:171], v[72:75], v[40:43]
    ds_read_b128 v[68:71], v16 offset:1024
    v_mfma_f32_16x16x32_bf16 v[44:47], a[172:175], v[72:75], v[44:47]
    s_add_u32 m0, s81, 99392
    v_mfma_f32_16x16x32_bf16 v[48:51], v[72:75], a[176:179], v[48:51]
    s_waitcnt lgkmcnt(5)
    buffer_load_dwordx4 v17, s[40:43], s3 offen offset:2048 lds
    v_mfma_f32_16x16x32_bf16 v[40:43], a[180:183], v[76:79], v[40:43]
    ds_read_b128 v[72:75], v16 offset:2048
    v_mfma_f32_16x16x32_bf16 v[44:47], a[184:187], v[76:79], v[44:47]
    s_add_u32 m0, s81, 99424
    v_mfma_f32_16x16x32_bf16 v[48:51], v[76:79], a[188:191], v[48:51]
    buffer_load_dwordx4 v17, s[40:43], s3 offen offset:3072 lds
    s_waitcnt lgkmcnt(2)
    v_mfma_f32_16x16x32_bf16 v[56:59], a[4:7], v[64:67], 0
    ds_read_b128 v[76:79], v16 offset:3072
    v_mfma_f32_16x16x32_bf16 v[60:63], v[64:67], a[8:11], 0
    s_waitcnt lgkmcnt(2)
    v_fma_f32 v44, v115, v84, v44
    v_fma_f32 v45, v115, v85, v45
    v_fma_f32 v46, v115, v86, v46
    v_mfma_f32_16x16x32_bf16 v[56:59], a[16:19], v[68:71], v[56:59]
    ds_read_b128 v[64:67], v16 offset:4096
    v_fma_f32 v47, v115, v87, v47
    v_mul_f32 v44, v114, v44
    v_mfma_f32_16x16x32_bf16 v[60:63], v[68:71], a[20:23], v[60:63]
    s_add_u32 s3, s19, 393216
    s_and_b32 s3, s3, 0x7ffff
    s_waitcnt lgkmcnt(2)
    v_mul_f32 v45, v114, v45
    v_mul_f32 v46, v114, v46
    v_mfma_f32_16x16x32_bf16 v[56:59], a[28:31], v[72:75], v[56:59]
    s_add_u32 m0, s81, 116224
    ds_read_b128 v[68:71], v16 offset:5120
    v_mul_f32 v47, v114, v47
    v_cvt_pk_bf16_f32 v100, v44, v45
    v_mfma_f32_16x16x32_bf16 v[60:63], v[72:75], a[32:35], v[60:63]
    s_waitcnt lgkmcnt(2)
    buffer_load_dwordx4 v17, s[40:43], s3 offen offset:0 lds
    v_cvt_pk_bf16_f32 v101, v46, v47
    v_mfma_f32_16x16x32_bf16 v[56:59], a[40:43], v[76:79], v[56:59]
    ds_read_b128 v[72:75], v16 offset:6144
    v_fma_f32 v40, v115, v80, v40
    v_fma_f32 v41, v115, v81, v41
    v_mfma_f32_16x16x32_bf16 v[60:63], v[76:79], a[44:47], v[60:63]
    s_waitcnt lgkmcnt(2)
    v_fma_f32 v42, v115, v82, v42
    v_fma_f32 v43, v115, v83, v43
    v_cvt_pk_bf16_f32 v102, v40, v41
    v_mfma_f32_16x16x32_bf16 v[56:59], a[52:55], v[64:67], v[56:59]
    ds_read_b128 v[76:79], v16 offset:7168
    v_cvt_pk_bf16_f32 v103, v42, v43
    v_mul_f32 v89, 0x3eb8aa3b, v114
    v_mfma_f32_16x16x32_bf16 v[60:63], v[64:67], a[56:59], v[60:63]
    s_waitcnt lgkmcnt(2)
    v_mfma_f32_16x16x16_bf16 v[40:43], v[98:99], v[104:105], v[30:33]
    v_mfma_f32_16x16x16_bf16 v[44:47], v[100:101], v[104:105], v[30:33]
    v_fma_f32 v48, v110, v88, v48
    v_fma_f32 v49, v111, v88, v49
    v_fma_f32 v50, v112, v88, v50
    v_mfma_f32_16x16x32_bf16 v[56:59], a[64:67], v[68:71], v[56:59]
    s_waitcnt vmcnt(3)
    buffer_store_dword v25, off, s[36:39], s83 offset:0 sc1
    ds_read_b128 v[64:67], v16 offset:8192
    v_fma_f32 v51, v113, v88, v51
    v_mfma_f32_16x16x32_bf16 v[60:63], v[68:71], a[68:71], v[60:63]
    s_waitcnt lgkmcnt(2)
    buffer_load_dwordx4 v[90:93], v16, s[36:39], s85 offen sc1
    v_cndmask_b32 v40, v44, v40, s[60:61]
    v_cndmask_b32 v41, v45, v41, s[62:63]
    v_mfma_f32_16x16x32_bf16 v[56:59], a[76:79], v[72:75], v[56:59]
    ds_read_b128 v[68:71], v16 offset:9216
    v_cndmask_b32 v42, v46, v42, s[64:65]
    v_cndmask_b32 v43, v47, v43, s[66:67]
    v_mfma_f32_16x16x32_bf16 v[60:63], v[72:75], a[80:83], v[60:63]
    s_waitcnt lgkmcnt(2)
    v_max3_f32 v44, v40, v41, v42
    v_max_f32 v44, v44, v43
    v_mov_b32 v45, v44
    v_mfma_f32_16x16x32_bf16 v[56:59], a[88:91], v[76:79], v[56:59]
    s_add_u32 m0, s81, 116256
    ds_read_b128 v[72:75], v16 offset:10240
    v_permlane32_swap_b32 v45, v44
    v_mfma_f32_16x16x32_bf16 v[60:63], v[76:79], a[92:95], v[60:63]
    s_waitcnt lgkmcnt(2)
    buffer_load_dwordx4 v17, s[40:43], s3 offen offset:1024 lds
    v_max_f32 v44, v44, v45
    v_mfma_f32_16x16x32_bf16 v[56:59], a[100:103], v[64:67], v[56:59]
    ds_read_b128 v[76:79], v16 offset:11264
    v_mov_b32 v45, v44
    v_mul_f32 v48, v106, v48
    v_mfma_f32_16x16x32_bf16 v[60:63], v[64:67], a[104:107], v[60:63]
    s_waitcnt lgkmcnt(2)
    v_permlane16_swap_b32 v45, v44
    v_max_f32 v44, v44, v45
    v_mfma_f32_16x16x32_bf16 v[56:59], a[112:115], v[68:71], v[56:59]
    ds_read_b128 v[64:67], v16 offset:12288
    v_mul_f32 v44, v44, v116
    v_fma_f32 v40, v40, v116, -v44
    v_mfma_f32_16x16x32_bf16 v[60:63], v[68:71], a[116:119], v[60:63]
    s_waitcnt lgkmcnt(2)
    v_fma_f32 v41, v41, v116, -v44
    v_fma_f32 v42, v42, v116, -v44
    v_fma_f32 v43, v43, v116, -v44
    v_mfma_f32_16x16x32_bf16 v[56:59], a[124:127], v[72:75], v[56:59]
    s_add_u32 m0, s81, 116288
    ds_read_b128 v[68:71], v16 offset:13312
    v_exp_f32 v40, v40
    v_mfma_f32_16x16x32_bf16 v[60:63], v[72:75], a[128:131], v[60:63]
    s_waitcnt lgkmcnt(2)
    buffer_load_dwordx4 v17, s[40:43], s3 offen offset:2048 lds
    v_exp_f32 v41, v41
    v_mfma_f32_16x16x32_bf16 v[56:59], a[136:139], v[76:79], v[56:59]
    ds_read_b128 v[72:75], v16 offset:14336
    v_exp_f32 v42, v42
    v_mfma_f32_16x16x32_bf16 v[60:63], v[76:79], a[140:143], v[60:63]
    s_waitcnt lgkmcnt(2)
    v_exp_f32 v43, v43
    v_mfma_f32_16x16x32_bf16 v[56:59], a[148:151], v[64:67], v[56:59]
    ds_read_b128 v[76:79], v16 offset:15360
    v_cvt_pk_bf16_f32 v46, v40, v41
    v_cvt_pk_bf16_f32 v47, v42, v43
    v_mfma_f32_16x16x32_bf16 v[60:63], v[64:67], a[152:155], v[60:63]
    s_waitcnt lgkmcnt(2)
    v_mul_f32 v49, v107, v49
    v_mul_f32 v50, v108, v50
    v_mul_f32 v51, v109, v51
    v_mfma_f32_16x16x32_bf16 v[56:59], a[160:163], v[68:71], v[56:59]
    s_add_u32 m0, s81, 116320
    ds_read_b128 v[64:67], v16 offset:0
    v_cvt_pk_bf16_f32 v96, v48, v49
    v_mfma_f32_16x16x32_bf16 v[60:63], v[68:71], a[164:167], v[60:63]
    s_waitcnt lgkmcnt(2)
    buffer_load_dwordx4 v17, s[40:43], s3 offen offset:3072 lds
    v_cvt_pk_bf16_f32 v97, v50, v51
    v_and_b32 v48, v38, v46
    v_mfma_f32_16x16x32_bf16 v[56:59], a[172:175], v[72:75], v[56:59]
    ds_read_b128 v[68:71], v16 offset:1024
    ds_read2_b32 v[114:115], v23 offset0:0 offset1:64
    ds_read_b128 v[106:109], v24 offset:0
    v_mfma_f32_16x16x32_bf16 v[60:63], v[72:75], a[176:179], v[60:63]
    s_waitcnt lgkmcnt(4)
    ds_read_b128 v[110:113], v24 offset:256
    v_and_b32 v49, v39, v47
    v_xor_b32 v50, v48, v46
    v_mfma_f32_16x16x32_bf16 v[56:59], a[184:187], v[76:79], v[56:59]
    ds_read_b128 v[72:75], v16 offset:2048
    v_xor_b32 v51, v49, v47
    v_mfma_f32_16x16x32_bf16 v[60:63], v[76:79], a[188:191], v[60:63]
    s_waitcnt lgkmcnt(5)
    ds_read_b128 v[76:79], v16 offset:3072
    v_mfma_f32_16x16x32_bf16 v[44:47], v[34:37], v[48:51], 0
    v_mfma_f32_16x16x32_bf16 v[40:43], v[94:97], v[48:51], 0
    v_min_f32 v118, s100, v30
    v_min_f32 v119, s100, v31
    v_min_f32 v120, s100, v32
    v_min_f32 v121, s100, v33
    v_mfma_f32_16x16x32_bf16 v[52:55], a[0:3], v[64:67], 0
    ds_read_b128 v[64:67], v16 offset:4096
    s_nop 0
    v_rcp_f32 v44, v44
    s_nop 0
    v_mul_f32 v40, v44, v40
    v_mul_f32 v41, v44, v41
    v_mul_f32 v42, v44, v42
    v_mul_f32 v43, v44, v43
    v_cvt_pk_bf16_f32 v48, v40, v41
    v_cvt_pk_bf16_f32 v49, v42, v43
    buffer_store_dwordx2 v[48:49], v19, s[36:39], s90 offen offset:0 sc1
    s_waitcnt lgkmcnt(6)
    v_mfma_f32_16x16x32_bf16 v[52:55], a[12:15], v[68:71], v[52:55]
    s_waitcnt lgkmcnt(2)
    buffer_load_dword v29, v22, s[36:39], s82 offen offset:0 sc1
    ds_read_b128 v[68:71], v16 offset:5120
    v_fma_f32 v56, v115, v84, v56
    v_fma_f32 v57, v115, v85, v57
    v_mfma_f32_16x16x32_bf16 v[52:55], a[24:27], v[72:75], v[52:55]
    s_waitcnt lgkmcnt(2)
    ds_read_b128 v[72:75], v16 offset:6144
    v_fma_f32 v58, v115, v86, v58
    v_fma_f32 v59, v115, v87, v59
    v_mul_f32 v56, v114, v56
    v_mfma_f32_16x16x32_bf16 v[52:55], a[36:39], v[76:79], v[52:55]
    s_waitcnt lgkmcnt(2)
    ds_read_b128 v[76:79], v16 offset:7168
    v_mul_f32 v57, v114, v57
    v_mul_f32 v58, v114, v58
    v_mul_f32 v59, v114, v59
    v_mfma_f32_16x16x32_bf16 v[52:55], a[48:51], v[64:67], v[52:55]
    s_waitcnt lgkmcnt(2)
    ds_read_b128 v[64:67], v16 offset:8192
    v_cvt_pk_bf16_f32 v98, v56, v57
    v_cvt_pk_bf16_f32 v99, v58, v59
    v_mfma_f32_16x16x16_bf16 v[40:43], v[100:101], v[102:103], v[30:33]
    v_fma_f32 v60, v110, v88, v60
    v_mfma_f32_16x16x16_bf16 v[44:47], v[98:99], v[102:103], v[30:33]
    v_fma_f32 v61, v111, v88, v61
    v_fma_f32 v62, v112, v88, v62
    v_fma_f32 v63, v113, v88, v63
    v_mul_f32 v60, v106, v60
    v_mfma_f32_16x16x32_bf16 v[52:55], a[60:63], v[68:71], v[52:55]
    s_waitcnt lgkmcnt(2)
    ds_read_b128 v[68:71], v16 offset:9216
    v_mul_f32 v61, v107, v61
    v_cndmask_b32 v40, v44, v40, s[60:61]
    v_cndmask_b32 v41, v45, v41, s[62:63]
    v_cndmask_b32 v42, v46, v42, s[64:65]
    v_mfma_f32_16x16x32_bf16 v[52:55], a[72:75], v[72:75], v[52:55]
    s_waitcnt lgkmcnt(2)
    ds_read_b128 v[72:75], v16 offset:10240
    v_cndmask_b32 v43, v47, v43, s[66:67]
    v_max3_f32 v44, v40, v41, v42
    v_max_f32 v44, v44, v43
    v_mfma_f32_16x16x32_bf16 v[52:55], a[84:87], v[76:79], v[52:55]
    s_waitcnt lgkmcnt(2)
    ds_read_b128 v[76:79], v16 offset:11264
    v_mov_b32 v45, v44
    v_mul_f32 v62, v108, v62
    v_mul_f32 v63, v109, v63
    v_mfma_f32_16x16x32_bf16 v[52:55], a[96:99], v[64:67], v[52:55]
    s_waitcnt lgkmcnt(2)
    ds_read_b128 v[64:67], v16 offset:12288
    v_permlane32_swap_b32 v45, v44
    v_max_f32 v44, v44, v45
    v_mfma_f32_16x16x32_bf16 v[52:55], a[108:111], v[68:71], v[52:55]
    s_waitcnt vmcnt(1)
    s_waitcnt lgkmcnt(2)
    buffer_store_dword v25, off, s[36:39], s83 offset:128 sc1
    ds_read_b128 v[68:71], v16 offset:13312
    v_mov_b32 v45, v44
    s_waitcnt vmcnt(1)
    v_cmp_gt_u32 vcc, s72, v29
    v_mfma_f32_16x16x32_bf16 v[52:55], a[120:123], v[72:75], v[52:55]
    s_cbranch_vccnz L_slow_93
L_back_94:
    s_add_u32 m0, s80, 49152
    s_waitcnt lgkmcnt(2)
    ds_read_b128 v[72:75], v16 offset:14336
    v_permlane16_swap_b32 v45, v44
    v_mfma_f32_16x16x32_bf16 v[52:55], a[132:135], v[76:79], v[52:55]
    s_waitcnt lgkmcnt(2)
    buffer_load_dwordx4 v16, s[36:39], s95 offen offset:0 sc1 lds
    ds_read_b128 v[76:79], v16 offset:15360
    v_max_f32 v44, v44, v45
    v_mul_f32 v44, v44, v89
    v_mfma_f32_16x16x32_bf16 v[52:55], a[144:147], v[64:67], v[52:55]
    s_waitcnt lgkmcnt(2)
    buffer_load_dwordx4 v16, s[36:39], s95 offen offset:1024 sc1 lds
    v_fma_f32 v40, v40, v89, -v44
    v_fma_f32 v41, v41, v89, -v44
    v_fma_f32 v42, v42, v89, -v44
    v_mfma_f32_16x16x32_bf16 v[52:55], a[156:159], v[68:71], v[52:55]
    s_waitcnt lgkmcnt(1)
    buffer_load_dwordx4 v16, s[36:39], s95 offen offset:2048 sc1 lds
    v_fma_f32 v43, v43, v89, -v44
    v_exp_f32 v40, v40
    v_mfma_f32_16x16x32_bf16 v[52:55], a[168:171], v[72:75], v[52:55]
    s_waitcnt lgkmcnt(0)
    buffer_load_dwordx4 v16, s[36:39], s95 offen offset:3072 sc1 lds
    v_exp_f32 v41, v41
    v_exp_f32 v42, v42
    v_mfma_f32_16x16x32_bf16 v[52:55], a[180:183], v[76:79], v[52:55]
    v_exp_f32 v43, v43
    v_cvt_pk_bf16_f32 v46, v40, v41
    v_cvt_pk_bf16_f32 v47, v42, v43
    v_cvt_pk_bf16_f32 v94, v60, v61
    v_cvt_pk_bf16_f32 v95, v62, v63
    v_and_b32 v50, v38, v46
    v_and_b32 v51, v39, v47
    v_xor_b32 v48, v50, v46
    v_xor_b32 v49, v51, v47
    s_nop 1
    v_mfma_f32_16x16x32_bf16 v[44:47], v[34:37], v[48:51], 0
    v_mfma_f32_16x16x32_bf16 v[40:43], v[94:97], v[48:51], 0
    v_fma_f32 v52, v115, v80, v52
    v_fma_f32 v53, v115, v81, v53
    v_fma_f32 v54, v115, v82, v54
    v_fma_f32 v55, v115, v83, v55
    v_cvt_pk_bf16_f32 v104, v52, v53
    v_cvt_pk_bf16_f32 v105, v54, v55
    v_mul_f32 v116, 0x3eb8aa3b, v114
    v_cmp_eq_u32 vcc, -1, v93
    v_rcp_f32 v44, v44
    s_nop 0
    v_mul_f32 v40, v44, v40
    v_mul_f32 v41, v44, v41
    v_mul_f32 v42, v44, v42
    s_cbranch_vccnz L_slow_96
L_back_97:
    s_add_u32 s85, s85, 0x8000
    v_mfma_f32_16x16x16_bf16 v[52:55], v[98:99], v[104:105], v[30:33]
    v_mfma_f32_16x16x16_bf16 v[56:59], v[90:91], v[104:105], v[118:121]
    v_mul_f32 v43, v44, v43
    v_cvt_pk_bf16_f32 v48, v40, v41
    v_cvt_pk_bf16_f32 v49, v42, v43
    buffer_store_dwordx2 v[48:49], v19, s[36:39], s89 offen offset:0 sc1
    s_nop 3
    v_cndmask_b32 v52, v56, v52, s[60:61]
    v_cndmask_b32 v53, v57, v53, s[62:63]
    v_cndmask_b32 v54, v58, v54, s[64:65]
    v_cndmask_b32 v55, v59, v55, s[66:67]
    v_max3_f32 v56, v52, v53, v54
    v_max_f32 v56, v56, v55
    v_mov_b32 v57, v56
    s_nop 1
    v_permlane32_swap_b32 v57, v56
    v_max_f32 v56, v56, v57
    v_mov_b32 v57, v56
    s_nop 1
    v_permlane16_swap_b32 v57, v56
    v_max_f32 v56, v56, v57
    v_mul_f32 v56, v56, v116
    buffer_load_dword v29, v22, s[36:39], s82 offen offset:128 sc1
    v_fma_f32 v52, v52, v116, -v56
    v_fma_f32 v53, v53, v116, -v56
    v_fma_f32 v54, v54, v116, -v56
    v_fma_f32 v55, v55, v116, -v56
    v_exp_f32 v52, v52
    v_exp_f32 v53, v53
    v_exp_f32 v54, v54
    v_exp_f32 v55, v55
    v_cvt_pk_bf16_f32 v58, v52, v53
    v_cvt_pk_bf16_f32 v59, v54, v55
    v_and_b32 v62, v38, v58
    v_and_b32 v63, v39, v59
    v_xor_b32 v60, v62, v58
    v_xor_b32 v61, v63, v59
    s_nop 1
    v_mfma_f32_16x16x32_bf16 v[56:59], v[34:37], v[60:63], 0
    v_mfma_f32_16x16x32_bf16 v[52:55], v[92:95], v[60:63], 0
    s_nop 6
    v_rcp_f32 v56, v56
    s_nop 0
    v_mul_f32 v52, v56, v52
    v_mul_f32 v53, v56, v53
    v_mul_f32 v54, v56, v54
    v_mul_f32 v55, v56, v55
    v_cvt_pk_bf16_f32 v60, v52, v53
    s_waitcnt vmcnt(1)
    buffer_store_dword v25, off, s[36:39], s83 offset:896 sc1
    v_cvt_pk_bf16_f32 v61, v54, v55
    buffer_store_dwordx2 v[60:61], v19, s[36:39], s88 offen offset:0 sc1
    s_waitcnt vmcnt(2)
    v_cmp_gt_u32 vcc, s72, v29
    s_cbranch_vccnz L_slow_99
L_back_100:
    s_add_u32 m0, s80, 32768
    s_nop 0
    buffer_load_dwordx4 v16, s[36:39], s94 offen offset:0 sc1 lds
    buffer_load_dwordx4 v16, s[36:39], s94 offen offset:1024 sc1 lds
    buffer_load_dwordx4 v16, s[36:39], s94 offen offset:2048 sc1 lds
    buffer_load_dwordx4 v16, s[36:39], s94 offen offset:3072 sc1 lds
    s_branch L_wS
L_qkvBS:
    s_waitcnt lgkmcnt(3)
    v_mfma_f32_16x16x32_bf16 v[40:43], a[192:195], v[64:67], 0
    ds_read_b128 v[76:79], v16 offset:52224
    v_mfma_f32_16x16x32_bf16 v[44:47], a[196:199], v[64:67], 0
    s_waitcnt vmcnt(1)
    buffer_store_dword v25, off, s[36:39], s83 offset:640 sc1
    v_cvt_pk_bf16_f32 v36, v0, v1
    v_cvt_pk_bf16_f32 v37, v2, v3
    v_mfma_f32_16x16x32_bf16 v[48:51], v[64:67], a[200:203], 0
    s_waitcnt lgkmcnt(3)
    buffer_store_dwordx2 v[36:37], v19, s[36:39], s96 offen offset:0 sc1
    v_mul_f32 v39, v0, v0
    v_mfma_f32_16x16x32_bf16 v[40:43], a[204:207], v[68:71], v[40:43]
    ds_read_b128 v[64:67], v16 offset:53248
    v_add_f32 v38, v0, v1
    v_fmac_f32 v39, v1, v1
    v_mfma_f32_16x16x32_bf16 v[44:47], a[208:211], v[68:71], v[44:47]
    v_add_f32 v38, v38, v2
    v_fmac_f32 v39, v2, v2
    v_mfma_f32_16x16x32_bf16 v[48:51], v[68:71], a[212:215], v[48:51]
    s_waitcnt lgkmcnt(3)
    v_add_f32 v38, v38, v3
    v_fmac_f32 v39, v3, v3
    v_mfma_f32_16x16x32_bf16 v[40:43], a[216:219], v[72:75], v[40:43]
    ds_read_b128 v[68:71], v16 offset:54272
    v_permlane32_swap_b32 v38, v39
    v_mfma_f32_16x16x32_bf16 v[44:47], a[220:223], v[72:75], v[44:47]
    s_waitcnt vmcnt(2)
    v_add_f32 v38, v38, v39
    v_mov_b32 v39, v38
    v_cmp_gt_u32 vcc, s72, v29
    v_mfma_f32_16x16x32_bf16 v[48:51], v[72:75], a[224:227], v[48:51]
    s_waitcnt lgkmcnt(2)
    v_permlane16_swap_b32 v39, v38
    v_mfma_f32_16x16x32_bf16 v[40:43], a[228:231], v[76:79], v[40:43]
    s_cbranch_vccnz L_slow_102
L_back_103:
    v_add_f32 v38, v38, v39
    ds_write_b32 v26, v38 offset:512
    ds_read_b128 v[72:75], v16 offset:55296
    v_mfma_f32_16x16x32_bf16 v[44:47], a[232:235], v[76:79], v[44:47]
    s_lshl_b32 s74, s68, 8
    buffer_load_dwordx4 v[118:121], v16, s[36:39], s86 offen offset:2048 sc1
    v_add_u32 v84, s74, v24
    v_add_u32 v88, s74, v23
    v_mfma_f32_16x16x32_bf16 v[48:51], v[76:79], a[236:239], v[48:51]
    s_waitcnt lgkmcnt(3)
    buffer_load_dwordx4 v[122:125], v16, s[36:39], s86 offen offset:3072 sc1
    ds_read_b128 v[80:83], v84 offset:3072
    v_mfma_f32_16x16x32_bf16 v[40:43], a[240:243], v[64:67], v[40:43]
    ds_read_b128 v[76:79], v16 offset:56320
    ds_read_b128 v[84:87], v84 offset:3136
    ds_read_b32 v88, v88 offset:3200
    v_mfma_f32_16x16x32_bf16 v[44:47], a[244:247], v[64:67], v[44:47]
    s_add_u32 m0, s80, 32768
    ds_read_b128 v[30:33], v28 offset:3584
    ds_read_b64 v[38:39], v28 offset:4608
    v_mfma_f32_16x16x32_bf16 v[48:51], v[64:67], a[248:251], v[48:51]
    s_waitcnt lgkmcnt(8)
    buffer_load_dwordx4 v16, s[36:39], s6 offen offset:0 sc1 lds
    v_mov_b32 v34, 0x3f803f80
    v_mov_b32 v35, 0x3f803f80
    v_mfma_f32_16x16x32_bf16 v[40:43], a[252:255], v[68:71], v[40:43]
    s_waitcnt lgkmcnt(7)
    s_barrier
    ds_read_b128 v[64:67], v16 offset:57344
    v_mfma_f32_16x16x32_bf16 v[44:47], v[128:131], v[68:71], v[44:47]
    ds_read_b128 v[106:109], v28 offset:512
    v_mov_b32 v36, 0x3f803f80
    v_mov_b32 v37, 0x3f803f80
    v_mfma_f32_16x16x32_bf16 v[48:51], v[68:71], v[132:135], v[48:51]
    s_waitcnt lgkmcnt(8)
    buffer_load_dwordx4 v16, s[36:39], s6 offen offset:1024 sc1 lds
    v_mfma_f32_16x16x32_bf16 v[40:43], v[136:139], v[72:75], v[40:43]
    ds_read_b128 v[68:71], v16 offset:58368
    v_mfma_f32_16x16x32_bf16 v[44:47], v[140:143], v[72:75], v[44:47]
    v_mfma_f32_16x16x32_bf16 v[48:51], v[72:75], v[144:147], v[48:51]
    s_waitcnt lgkmcnt(7)
    buffer_load_dwordx4 v16, s[36:39], s6 offen offset:2048 sc1 lds
    v_mfma_f32_16x16x32_bf16 v[40:43], v[148:151], v[76:79], v[40:43]
    s_waitcnt lgkmcnt(1)
    ds_read_b128 v[72:75], v16 offset:59392
    v_add_f32 v106, v106, v107
    v_add_f32 v108, v108, v109
    v_mfma_f32_16x16x32_bf16 v[44:47], v[152:155], v[76:79], v[44:47]
    v_add_f32 v106, v106, v108
    v_mfma_f32_16x16x32_bf16 v[48:51], v[76:79], v[156:159], v[48:51]
    buffer_load_dwordx4 v16, s[36:39], s6 offen offset:3072 sc1 lds
    buffer_store_dword v106, v21, s[36:39], s87 offen offset:0 sc1
    v_mfma_f32_16x16x32_bf16 v[40:43], v[160:163], v[64:67], v[40:43]
    ds_read_b128 v[76:79], v16 offset:60416
    v_mfma_f32_16x16x32_bf16 v[44:47], v[164:167], v[64:67], v[44:47]
    v_mfma_f32_16x16x32_bf16 v[48:51], v[64:67], v[168:171], v[48:51]
    s_waitcnt lgkmcnt(2)
    s_waitcnt vmcnt(5)
    v_add_f32 v118, v118, v122
    v_add_f32 v120, v120, v124
    v_mfma_f32_16x16x32_bf16 v[40:43], v[172:175], v[68:71], v[40:43]
    ds_read_b128 v[64:67], v16 offset:61440
    v_add_f32 v119, v119, v123
    v_add_f32 v121, v121, v125
    v_mfma_f32_16x16x32_bf16 v[44:47], v[176:179], v[68:71], v[44:47]
    buffer_load_dword v29, v22, s[36:39], s82 offen offset:640 sc1
    v_permlane32_swap_b32 v118, v120
    v_mfma_f32_16x16x32_bf16 v[48:51], v[68:71], v[180:183], v[48:51]
    s_waitcnt lgkmcnt(2)
    v_permlane32_swap_b32 v119, v121
    v_mfma_f32_16x16x32_bf16 v[40:43], v[184:187], v[72:75], v[40:43]
    s_add_u32 s3, s19, 0
    s_and_b32 s3, s3, 0x7ffff
    ds_read_b128 v[68:71], v16 offset:62464
    v_mfma_f32_16x16x32_bf16 v[44:47], v[188:191], v[72:75], v[44:47]
    s_add_u32 m0, s81, 65536
    v_add_f32 v118, v118, v120
    v_add_f32 v119, v119, v121
    v_mfma_f32_16x16x32_bf16 v[48:51], v[72:75], v[192:195], v[48:51]
    s_waitcnt lgkmcnt(2)
    buffer_load_dwordx4 v17, s[40:43], s3 offen offset:0 lds
    v_permlane16_swap_b32 v118, v119
    v_mfma_f32_16x16x32_bf16 v[40:43], v[196:199], v[76:79], v[40:43]
    ds_read_b128 v[72:75], v16 offset:63488
    v_add_f32 v118, v118, v119
    v_mfma_f32_16x16x32_bf16 v[44:47], v[200:203], v[76:79], v[44:47]
    v_mul_f32 v119, 0x3b000000, v118
    v_mul_f32 v118, 0x3b000000, v118
    v_mfma_f32_16x16x32_bf16 v[48:51], v[76:79], v[204:207], v[48:51]
    s_waitcnt lgkmcnt(2)
    v_permlane16_swap_b32 v118, v119
    v_fma_f32 v119, -v118, v118, v119
    v_mfma_f32_16x16x32_bf16 v[40:43], v[208:211], v[64:67], v[40:43]
    ds_read_b128 v[76:79], v16 offset:64512
    v_max_f32 v119, 0, v119
    v_cvt_pk_bf16_f32 v119, v118, v119
    v_mfma_f32_16x16x32_bf16 v[44:47], v[212:215], v[64:67], v[44:47]
    v_lshlrev_b32 v118, 16, v119
    v_and_b32 v119, 0xffff0000, v119
    v_mfma_f32_16x16x32_bf16 v[48:51], v[64:67], v[216:219], v[48:51]
    s_waitcnt lgkmcnt(2)
    v_add_f32 v119, 0x3727c5ac, v119
    v_cvt_pk_bf16_f32 v119, v119, v119
    v_and_b32 v119, 0xffff0000, v119
    v_mfma_f32_16x16x32_bf16 v[40:43], v[220:223], v[68:71], v[40:43]
    s_waitcnt vmcnt(3)
    s_barrier
    ds_read_b128 v[64:67], v16 offset:32768
    v_mfma_f32_16x16x32_bf16 v[44:47], v[224:227], v[68:71], v[44:47]
    s_waitcnt vmcnt(1)
    v_cmp_gt_u32 vcc, s72, v29
    buffer_store_dword v25, off, s[36:39], s83 offset:768 sc1
    v_add_u32 v25, 1, v25
    v_mfma_f32_16x16x32_bf16 v[48:51], v[68:71], v[228:231], v[48:51]
    s_waitcnt lgkmcnt(2)
    v_sqrt_f32 v119, v119
    v_mfma_f32_16x16x32_bf16 v[40:43], v[232:235], v[72:75], v[40:43]
    ds_read_b128 v[68:71], v16 offset:33792
    v_xor_b32 v118, 0x80000000, v118
    v_mfma_f32_16x16x32_bf16 v[44:47], v[236:239], v[72:75], v[44:47]
    s_cbranch_vccnz L_slow_105
L_back_106:
    s_add_u32 m0, s80, 16384
    v_cvt_pk_bf16_f32 v119, v119, v119
    v_and_b32 v119, 0xffff0000, v119
    v_mfma_f32_16x16x32_bf16 v[48:51], v[72:75], v[240:243], v[48:51]
    s_waitcnt lgkmcnt(2)
    buffer_load_dwordx4 v16, s[36:39], s5 offen offset:0 sc1 lds
    v_rcp_f32 v119, v119
    v_mfma_f32_16x16x32_bf16 v[40:43], v[244:247], v[76:79], v[40:43]
    ds_read_b128 v[72:75], v16 offset:34816
    ds_write2_b32 v27, v119, v118 offset0:32 offset1:96
    v_mfma_f32_16x16x32_bf16 v[44:47], v[248:251], v[76:79], v[44:47]
    ds_read2_b32 v[114:115], v23 offset0:48 offset1:112
    ds_read_b128 v[106:109], v24 offset:192
    ds_read_b128 v[110:113], v24 offset:448
    v_mfma_f32_16x16x32_bf16 v[48:51], v[76:79], v[252:255], v[48:51]
    s_waitcnt lgkmcnt(6)
    buffer_load_dwordx4 v16, s[36:39], s5 offen offset:1024 sc1 lds
    v_mfma_f32_16x16x32_bf16 v[52:55], a[192:195], v[64:67], 0
    ds_read_b128 v[76:79], v16 offset:35840
    v_mfma_f32_16x16x32_bf16 v[56:59], a[196:199], v[64:67], 0
    v_mfma_f32_16x16x32_bf16 v[60:63], v[64:67], a[200:203], 0
    s_waitcnt lgkmcnt(6)
    buffer_load_dwordx4 v16, s[36:39], s5 offen offset:2048 sc1 lds
    s_waitcnt lgkmcnt(3)
    v_fma_f32 v44, v115, v84, v44
    v_mfma_f32_16x16x32_bf16 v[52:55], a[204:207], v[68:71], v[52:55]
    ds_read_b128 v[64:67], v16 offset:36864
    v_fma_f32 v45, v115, v85, v45
    v_fma_f32 v46, v115, v86, v46
    v_mfma_f32_16x16x32_bf16 v[56:59], a[208:211], v[68:71], v[56:59]
    v_fma_f32 v47, v115, v87, v47
    v_mul_f32 v44, v114, v44
    v_mfma_f32_16x16x32_bf16 v[60:63], v[68:71], a[212:215], v[60:63]
    buffer_load_dwordx4 v16, s[36:39], s5 offen offset:3072 sc1 lds
    v_mul_f32 v45, v114, v45
    v_mul_f32 v46, v114, v46
    v_mfma_f32_16x16x32_bf16 v[52:55], a[216:219], v[72:75], v[52:55]
    ds_read_b128 v[68:71], v16 offset:37888
    v_mul_f32 v47, v114, v47
    v_mfma_f32_16x16x32_bf16 v[56:59], a[220:223], v[72:75], v[56:59]
    v_cvt_pk_bf16_f32 v90, v44, v45
    v_cvt_pk_bf16_f32 v91, v46, v47
    s_waitcnt lgkmcnt(3)
    v_fma_f32 v48, v110, v88, v48
    v_mfma_f32_16x16x32_bf16 v[60:63], v[72:75], a[224:227], v[60:63]
    s_waitcnt lgkmcnt(2)
    v_fma_f32 v49, v111, v88, v49
    v_mfma_f32_16x16x32_bf16 v[52:55], a[228:231], v[76:79], v[52:55]
    ds_read_b128 v[72:75], v16 offset:38912
    v_fma_f32 v50, v112, v88, v50
    v_fma_f32 v51, v113, v88, v51
    v_mfma_f32_16x16x32_bf16 v[56:59], a[232:235], v[76:79], v[56:59]
    s_add_u32 m0, s81, 65568
    v_mul_f32 v48, v106, v48
    v_mul_f32 v49, v107, v49
    v_mfma_f32_16x16x32_bf16 v[60:63], v[76:79], a[236:239], v[60:63]
    s_waitcnt lgkmcnt(2)
    buffer_load_dwordx4 v17, s[40:43], s3 offen offset:1024 lds
    v_mul_f32 v50, v108, v50
    v_mfma_f32_16x16x32_bf16 v[52:55], a[240:243], v[64:67], v[52:55]
    ds_read_b128 v[76:79], v16 offset:39936
    v_mul_f32 v51, v109, v51
    v_cvt_pk_bf16_f32 v92, v48, v49
    v_mfma_f32_16x16x32_bf16 v[56:59], a[244:247], v[64:67], v[56:59]
    buffer_load_dword v29, v22, s[36:39], s82 offen offset:768 sc1
    v_cvt_pk_bf16_f32 v93, v50, v51
    v_mfma_f32_16x16x32_bf16 v[60:63], v[64:67], a[248:251], v[60:63]
    s_waitcnt lgkmcnt(2)
    v_fma_f32 v40, v115, v80, v40
    v_fma_f32 v41, v115, v81, v41
    v_fma_f32 v42, v115, v82, v42
    v_mfma_f32_16x16x32_bf16 v[52:55], a[252:255], v[68:71], v[52:55]
    ds_read_b128 v[64:67], v16 offset:40960
    v_fma_f32 v43, v115, v83, v43
    v_mfma_f32_16x16x32_bf16 v[56:59], v[128:131], v[68:71], v[56:59]
    v_cvt_pk_bf16_f32 v102, v40, v41
    v_cvt_pk_bf16_f32 v103, v42, v43
    v_mul_f32 v89, 0x3eb8aa3b, v114
    v_mfma_f32_16x16x32_bf16 v[60:63], v[68:71], v[132:135], v[60:63]
    s_waitcnt lgkmcnt(2)
    ds_read2_b32 v[114:115], v23 offset0:32 offset1:96
    ds_read_b128 v[106:109], v24 offset:128
    v_mfma_f32_16x16x32_bf16 v[52:55], v[136:139], v[72:75], v[52:55]
    ds_read_b128 v[68:71], v16 offset:41984
    ds_read_b128 v[110:113], v24 offset:384
    v_mfma_f32_16x16x32_bf16 v[56:59], v[140:143], v[72:75], v[56:59]
    s_add_u32 m0, s81, 65600
    v_mfma_f32_16x16x32_bf16 v[60:63], v[72:75], v[144:147], v[60:63]
    s_waitcnt lgkmcnt(5)
    buffer_load_dwordx4 v17, s[40:43], s3 offen offset:2048 lds
    v_mfma_f32_16x16x32_bf16 v[52:55], v[148:151], v[76:79], v[52:55]
    ds_read_b128 v[72:75], v16 offset:43008
    v_mfma_f32_16x16x32_bf16 v[56:59], v[152:155], v[76:79], v[56:59]
    v_mfma_f32_16x16x32_bf16 v[60:63], v[76:79], v[156:159], v[60:63]
    s_waitcnt lgkmcnt(5)
    v_mfma_f32_16x16x32_bf16 v[52:55], v[160:163], v[64:67], v[52:55]
    ds_read_b128 v[76:79], v16 offset:44032
    v_mfma_f32_16x16x32_bf16 v[56:59], v[164:167], v[64:67], v[56:59]
    s_waitcnt vmcnt(1)
    v_cmp_gt_u32 vcc, s72, v29
    v_mfma_f32_16x16x32_bf16 v[60:63], v[64:67], v[168:171], v[60:63]
    s_waitcnt lgkmcnt(3)
    v_mfma_f32_16x16x32_bf16 v[52:55], v[172:175], v[68:71], v[52:55]
    s_cbranch_vccnz L_slow_108
L_back_109:
    s_add_u32 s72, s72, 1
    ds_read_b128 v[64:67], v16 offset:45056
    v_mfma_f32_16x16x32_bf16 v[56:59], v[176:179], v[68:71], v[56:59]
    buffer_load_dwordx4 v[118:121], v16, s[36:39], s86 offen offset:0 sc1
    v_mfma_f32_16x16x32_bf16 v[60:63], v[68:71], v[180:183], v[60:63]
    s_waitcnt lgkmcnt(2)
    buffer_load_dwordx4 v[122:125], v16, s[36:39], s86 offen offset:1024 sc1
    v_mfma_f32_16x16x32_bf16 v[52:55], v[184:187], v[72:75], v[52:55]
    ds_read_b128 v[68:71], v16 offset:46080
    v_mfma_f32_16x16x32_bf16 v[56:59], v[188:191], v[72:75], v[56:59]
    s_add_u32 m0, s80, 0
    v_mfma_f32_16x16x32_bf16 v[60:63], v[72:75], v[192:195], v[60:63]
    s_waitcnt lgkmcnt(2)
    buffer_load_dwordx4 v16, s[36:39], s4 offen offset:0 sc1 lds
    v_mfma_f32_16x16x32_bf16 v[52:55], v[196:199], v[76:79], v[52:55]
    ds_read_b128 v[72:75], v16 offset:47104
    v_mfma_f32_16x16x32_bf16 v[56:59], v[200:203], v[76:79], v[56:59]
    v_mfma_f32_16x16x32_bf16 v[60:63], v[76:79], v[204:207], v[60:63]
    s_waitcnt lgkmcnt(2)
    buffer_load_dwordx4 v16, s[36:39], s4 offen offset:1024 sc1 lds
    v_mfma_f32_16x16x32_bf16 v[52:55], v[208:211], v[64:67], v[52:55]
    ds_read_b128 v[76:79], v16 offset:48128
    v_mfma_f32_16x16x32_bf16 v[56:59], v[212:215], v[64:67], v[56:59]
    v_mfma_f32_16x16x32_bf16 v[60:63], v[64:67], v[216:219], v[60:63]
    s_waitcnt lgkmcnt(2)
    buffer_load_dwordx4 v16, s[36:39], s4 offen offset:2048 sc1 lds
    v_mfma_f32_16x16x32_bf16 v[52:55], v[220:223], v[68:71], v[52:55]
    s_barrier
    ds_read_b128 v[64:67], v16 offset:16384
    v_mfma_f32_16x16x32_bf16 v[56:59], v[224:227], v[68:71], v[56:59]
    v_mfma_f32_16x16x32_bf16 v[60:63], v[68:71], v[228:231], v[60:63]
    s_waitcnt lgkmcnt(2)
    buffer_load_dwordx4 v16, s[36:39], s4 offen offset:3072 sc1 lds
    v_mfma_f32_16x16x32_bf16 v[52:55], v[232:235], v[72:75], v[52:55]
    ds_read_b128 v[68:71], v16 offset:17408
    v_mfma_f32_16x16x32_bf16 v[56:59], v[236:239], v[72:75], v[56:59]
    v_min_u32 v93, -2, v93
    v_mfma_f32_16x16x32_bf16 v[60:63], v[72:75], v[240:243], v[60:63]
    s_waitcnt lgkmcnt(2)
    buffer_store_dwordx4 v[90:93], v16, s[36:39], s84 offen sc1
    v_mov_b32 v117, -1
    v_mfma_f32_16x16x32_bf16 v[52:55], v[244:247], v[76:79], v[52:55]
    ds_read_b128 v[72:75], v16 offset:18432
    s_waitcnt vmcnt(5)
    v_add_f32 v118, v118, v122
    v_mfma_f32_16x16x32_bf16 v[56:59], v[248:251], v[76:79], v[56:59]
    s_add_u32 s75, s84, 0x10000
    buffer_store_dwordx4 v[114:117], v16, s[36:39], s75 offen sc1
    v_add_f32 v120, v120, v124
    s_add_u32 s84, s84, 0x8000
    v_mfma_f32_16x16x32_bf16 v[60:63], v[76:79], v[252:255], v[60:63]
    v_add_f32 v119, v119, v123
    v_add_f32 v121, v121, v125
    s_waitcnt lgkmcnt(2)
    v_mfma_f32_16x16x32_bf16 v[40:43], a[192:195], v[64:67], 0
    ds_read_b128 v[76:79], v16 offset:19456
    v_permlane32_swap_b32 v118, v120
    v_mfma_f32_16x16x32_bf16 v[44:47], a[196:199], v[64:67], 0
    s_add_u32 m0, s81, 65632
    v_permlane32_swap_b32 v119, v121
    v_mfma_f32_16x16x32_bf16 v[48:51], v[64:67], a[200:203], 0
    s_waitcnt lgkmcnt(2)
    buffer_load_dwordx4 v17, s[40:43], s3 offen offset:3072 lds
    v_add_f32 v118, v118, v120
    v_add_f32 v119, v119, v121
    v_mfma_f32_16x16x32_bf16 v[40:43], a[204:207], v[68:71], v[40:43]
    ds_read_b128 v[64:67], v16 offset:20480
    v_permlane16_swap_b32 v118, v119
    v_mfma_f32_16x16x32_bf16 v[44:47], a[208:211], v[68:71], v[44:47]
    v_add_f32 v118, v118, v119
    v_mul_f32 v119, 0x3b000000, v118
    v_mul_f32 v118, 0x3b000000, v118
    v_mfma_f32_16x16x32_bf16 v[48:51], v[68:71], a[212:215], v[48:51]
    s_waitcnt lgkmcnt(2)
    v_permlane16_swap_b32 v118, v119
    v_mfma_f32_16x16x32_bf16 v[40:43], a[216:219], v[72:75], v[40:43]
    s_add_u32 s3, s19, 131072
    s_and_b32 s3, s3, 0x7ffff
    ds_read_b128 v[68:71], v16 offset:21504
    v_fma_f32 v119, -v118, v118, v119
    v_mfma_f32_16x16x32_bf16 v[44:47], a[220:223], v[72:75], v[44:47]
    s_add_u32 m0, s81, 82432
    v_max_f32 v119, 0, v119
    v_cvt_pk_bf16_f32 v119, v118, v119
    v_lshlrev_b32 v118, 16, v119
    v_mfma_f32_16x16x32_bf16 v[48:51], v[72:75], a[224:227], v[48:51]
    s_waitcnt lgkmcnt(2)
    buffer_load_dwordx4 v17, s[40:43], s3 offen offset:0 lds
    v_and_b32 v119, 0xffff0000, v119
    v_mfma_f32_16x16x32_bf16 v[40:43], a[228:231], v[76:79], v[40:43]
    ds_read_b128 v[72:75], v16 offset:22528
    v_add_f32 v119, 0x3727c5ac, v119
    v_cvt_pk_bf16_f32 v119, v119, v119
    v_mfma_f32_16x16x32_bf16 v[44:47], a[232:235], v[76:79], v[44:47]
    v_and_b32 v119, 0xffff0000, v119
    v_sqrt_f32 v119, v119
    v_mfma_f32_16x16x32_bf16 v[48:51], v[76:79], a[236:239], v[48:51]
    s_waitcnt lgkmcnt(2)
    v_xor_b32 v118, 0x80000000, v118
    v_cvt_pk_bf16_f32 v119, v119, v119
    v_mfma_f32_16x16x32_bf16 v[40:43], a[240:243], v[64:67], v[40:43]
    ds_read_b128 v[76:79], v16 offset:23552
    v_and_b32 v119, 0xffff0000, v119
    v_rcp_f32 v119, v119
    v_mfma_f32_16x16x32_bf16 v[44:47], a[244:247], v[64:67], v[44:47]
    s_add_u32 m0, s81, 82464
    ds_write2_b32 v27, v119, v118 offset0:0 offset1:64
    v_mfma_f32_16x16x32_bf16 v[48:51], v[64:67], a[248:251], v[48:51]
    s_waitcnt lgkmcnt(3)
    buffer_load_dwordx4 v17, s[40:43], s3 offen offset:1024 lds
    v_fma_f32 v56, v115, v84, v56
    v_fma_f32 v57, v115, v85, v57
    v_mfma_f32_16x16x32_bf16 v[40:43], a[252:255], v[68:71], v[40:43]
    ds_read_b128 v[64:67], v16 offset:24576
    v_fma_f32 v58, v115, v86, v58
    v_fma_f32 v59, v115, v87, v59
    v_mfma_f32_16x16x32_bf16 v[44:47], v[128:131], v[68:71], v[44:47]
    v_mul_f32 v56, v114, v56
    v_mul_f32 v57, v114, v57
    v_mul_f32 v58, v114, v58
    v_mfma_f32_16x16x32_bf16 v[48:51], v[68:71], v[132:135], v[48:51]
    s_waitcnt lgkmcnt(3)
    v_mul_f32 v59, v114, v59
    v_cvt_pk_bf16_f32 v98, v56, v57
    v_cvt_pk_bf16_f32 v99, v58, v59
    v_mfma_f32_16x16x32_bf16 v[40:43], v[136:139], v[72:75], v[40:43]
    ds_read_b128 v[68:71], v16 offset:25600
    v_fma_f32 v52, v115, v80, v52
    v_mfma_f32_16x16x32_bf16 v[44:47], v[140:143], v[72:75], v[44:47]
    s_add_u32 m0, s81, 82496
    v_fma_f32 v53, v115, v81, v53
    v_fma_f32 v54, v115, v82, v54
    v_fma_f32 v55, v115, v83, v55
    v_mfma_f32_16x16x32_bf16 v[48:51], v[72:75], v[144:147], v[48:51]
    s_waitcnt lgkmcnt(3)
    buffer_load_dwordx4 v17, s[40:43], s3 offen offset:2048 lds
    v_cvt_pk_bf16_f32 v104, v52, v53
    v_cvt_pk_bf16_f32 v105, v54, v55
    v_mfma_f32_16x16x32_bf16 v[40:43], v[148:151], v[76:79], v[40:43]
    ds_read_b128 v[72:75], v16 offset:26624
    v_mul_f32 v116, 0x3eb8aa3b, v114
    v_mfma_f32_16x16x32_bf16 v[44:47], v[152:155], v[76:79], v[44:47]
    v_mfma_f32_16x16x16_bf16 v[52:55], v[90:91], v[102:103], v[30:33]
    v_mfma_f32_16x16x16_bf16 v[56:59], v[98:99], v[102:103], v[30:33]
    v_fma_f32 v60, v110, v88, v60
    v_fma_f32 v61, v111, v88, v61
    v_fma_f32 v62, v112, v88, v62
    v_mfma_f32_16x16x32_bf16 v[48:51], v[76:79], v[156:159], v[48:51]
    s_waitcnt lgkmcnt(2)
    v_fma_f32 v63, v113, v88, v63
    v_mul_f32 v60, v106, v60
    v_mul_f32 v61, v107, v61
    v_mfma_f32_16x16x32_bf16 v[40:43], v[160:163], v[64:67], v[40:43]
    ds_read_b128 v[76:79], v16 offset:27648
    v_cndmask_b32 v52, v56, v52, s[60:61]
    v_cndmask_b32 v53, v57, v53, s[62:63]
    v_mfma_f32_16x16x32_bf16 v[44:47], v[164:167], v[64:67], v[44:47]
    s_add_u32 m0, s81, 82528
    v_cndmask_b32 v54, v58, v54, s[64:65]
    v_cndmask_b32 v55, v59, v55, s[66:67]
    v_max3_f32 v56, v52, v53, v54
    v_mfma_f32_16x16x32_bf16 v[48:51], v[64:67], v[168:171], v[48:51]
    s_waitcnt lgkmcnt(2)
    buffer_load_dwordx4 v17, s[40:43], s3 offen offset:3072 lds
    v_max_f32 v56, v56, v55
    v_mov_b32 v57, v56
    v_mfma_f32_16x16x32_bf16 v[40:43], v[172:175], v[68:71], v[40:43]
    ds_read_b128 v[64:67], v16 offset:28672
    v_permlane32_swap_b32 v57, v56
    v_mfma_f32_16x16x32_bf16 v[44:47], v[176:179], v[68:71], v[44:47]
    v_max_f32 v56, v56, v57
    v_mov_b32 v57, v56
    v_mul_f32 v62, v108, v62
    v_mfma_f32_16x16x32_bf16 v[48:51], v[68:71], v[180:183], v[48:51]
    s_waitcnt lgkmcnt(2)
    v_permlane16_swap_b32 v57, v56
    v_max_f32 v56, v56, v57
    v_mfma_f32_16x16x32_bf16 v[40:43], v[184:187], v[72:75], v[40:43]
    s_add_u32 s3, s19, 262144
    s_and_b32 s3, s3, 0x7ffff
    ds_read_b128 v[68:71], v16 offset:29696
    v_mul_f32 v56, v56, v89
    v_mfma_f32_16x16x32_bf16 v[44:47], v[188:191], v[72:75], v[44:47]
    s_add_u32 m0, s81, 99328
    v_fma_f32 v52, v52, v89, -v56
    v_fma_f32 v53, v53, v89, -v56
    v_fma_f32 v54, v54, v89, -v56
    v_mfma_f32_16x16x32_bf16 v[48:51], v[72:75], v[192:195], v[48:51]
    s_waitcnt lgkmcnt(2)
    buffer_load_dwordx4 v17, s[40:43], s3 offen offset:0 lds
    v_fma_f32 v55, v55, v89, -v56
    v_mfma_f32_16x16x32_bf16 v[40:43], v[196:199], v[76:79], v[40:43]
    ds_read_b128 v[72:75], v16 offset:30720
    v_exp_f32 v52, v52
    v_mfma_f32_16x16x32_bf16 v[44:47], v[200:203], v[76:79], v[44:47]
    v_exp_f32 v53, v53
    v_exp_f32 v54, v54
    v_mfma_f32_16x16x32_bf16 v[48:51], v[76:79], v[204:207], v[48:51]
    s_waitcnt lgkmcnt(2)
    v_exp_f32 v55, v55
    v_mfma_f32_16x16x32_bf16 v[40:43], v[208:211], v[64:67], v[40:43]
    ds_read_b128 v[76:79], v16 offset:31744
    v_cvt_pk_bf16_f32 v58, v52, v53
    v_cvt_pk_bf16_f32 v59, v54, v55
    v_mfma_f32_16x16x32_bf16 v[44:47], v[212:215], v[64:67], v[44:47]
    s_add_u32 m0, s81, 99360
    v_mul_f32 v63, v109, v63
    v_cvt_pk_bf16_f32 v94, v60, v61
    v_cvt_pk_bf16_f32 v95, v62, v63
    v_mfma_f32_16x16x32_bf16 v[48:51], v[64:67], v[216:219], v[48:51]
    s_waitcnt lgkmcnt(2)
    buffer_load_dwordx4 v17, s[40:43], s3 offen offset:1024 lds
    ds_read2_b32 v[114:115], v23 offset0:16 offset1:80
    v_mfma_f32_16x16x32_bf16 v[40:43], v[220:223], v[68:71], v[40:43]
    ds_read_b128 v[106:109], v24 offset:64
    ds_read_b128 v[110:113], v24 offset:320
    s_waitcnt vmcnt(9)
    s_barrier
    ds_read_b128 v[64:67], v16 offset:0
    v_mfma_f32_16x16x32_bf16 v[44:47], v[224:227], v[68:71], v[44:47]
    v_and_b32 v60, v38, v58
    v_and_b32 v61, v39, v59
    v_xor_b32 v62, v60, v58
    v_mfma_f32_16x16x32_bf16 v[48:51], v[68:71], v[228:231], v[48:51]
    v_xor_b32 v63, v61, v59
    s_nop 1
    v_mfma_f32_16x16x32_bf16 v[56:59], v[34:37], v[60:63], 0
    v_mfma_f32_16x16x32_bf16 v[52:55], v[92:95], v[60:63], 0
    s_nop 6
    v_rcp_f32 v56, v56
    s_nop 0
    v_mul_f32 v52, v56, v52
    v_mul_f32 v53, v56, v53
    v_mul_f32 v54, v56, v54
    v_mul_f32 v55, v56, v55
    v_cvt_pk_bf16_f32 v60, v52, v53
    v_cvt_pk_bf16_f32 v61, v54, v55
    buffer_store_dwordx2 v[60:61], v19, s[36:39], s91 offen offset:0 sc1
    s_waitcnt lgkmcnt(5)
    v_mfma_f32_16x16x32_bf16 v[40:43], v[232:235], v[72:75], v[40:43]
    ds_read_b128 v[68:71], v16 offset:1024
    v_mfma_f32_16x16x32_bf16 v[44:47], v[236:239], v[72:75], v[44:47]
    s_add_u32 m0, s81, 99392
    v_mfma_f32_16x16x32_bf16 v[48:51], v[72:75], v[240:243], v[48:51]
    s_waitcnt lgkmcnt(5)
    buffer_load_dwordx4 v17, s[40:43], s3 offen offset:2048 lds
    v_mfma_f32_16x16x32_bf16 v[40:43], v[244:247], v[76:79], v[40:43]
    ds_read_b128 v[72:75], v16 offset:2048
    v_mfma_f32_16x16x32_bf16 v[44:47], v[248:251], v[76:79], v[44:47]
    s_add_u32 m0, s81, 99424
    v_mfma_f32_16x16x32_bf16 v[48:51], v[76:79], v[252:255], v[48:51]
    buffer_load_dwordx4 v17, s[40:43], s3 offen offset:3072 lds
    s_waitcnt lgkmcnt(2)
    v_mfma_f32_16x16x32_bf16 v[56:59], a[196:199], v[64:67], 0
    ds_read_b128 v[76:79], v16 offset:3072
    v_mfma_f32_16x16x32_bf16 v[60:63], v[64:67], a[200:203], 0
    s_waitcnt lgkmcnt(2)
    v_fma_f32 v44, v115, v84, v44
    v_fma_f32 v45, v115, v85, v45
    v_fma_f32 v46, v115, v86, v46
    v_mfma_f32_16x16x32_bf16 v[56:59], a[208:211], v[68:71], v[56:59]
    ds_read_b128 v[64:67], v16 offset:4096
    v_fma_f32 v47, v115, v87, v47
    v_mul_f32 v44, v114, v44
    v_mfma_f32_16x16x32_bf16 v[60:63], v[68:71], a[212:215], v[60:63]
    s_add_u32 s3, s19, 393216
    s_and_b32 s3, s3, 0x7ffff
    s_waitcnt lgkmcnt(2)
    v_mul_f32 v45, v114, v45
    v_mul_f32 v46, v114, v46
    v_mfma_f32_16x16x32_bf16 v[56:59], a[220:223], v[72:75], v[56:59]
    s_add_u32 m0, s81, 116224
    ds_read_b128 v[68:71], v16 offset:5120
    v_mul_f32 v47, v114, v47
    v_cvt_pk_bf16_f32 v100, v44, v45
    v_mfma_f32_16x16x32_bf16 v[60:63], v[72:75], a[224:227], v[60:63]
    s_waitcnt lgkmcnt(2)
    buffer_load_dwordx4 v17, s[40:43], s3 offen offset:0 lds
    v_cvt_pk_bf16_f32 v101, v46, v47
    v_mfma_f32_16x16x32_bf16 v[56:59], a[232:235], v[76:79], v[56:59]
    ds_read_b128 v[72:75], v16 offset:6144
    v_fma_f32 v40, v115, v80, v40
    v_fma_f32 v41, v115, v81, v41
    v_mfma_f32_16x16x32_bf16 v[60:63], v[76:79], a[236:239], v[60:63]
    s_waitcnt lgkmcnt(2)
    v_fma_f32 v42, v115, v82, v42
    v_fma_f32 v43, v115, v83, v43
    v_cvt_pk_bf16_f32 v102, v40, v41
    v_mfma_f32_16x16x32_bf16 v[56:59], a[244:247], v[64:67], v[56:59]
    ds_read_b128 v[76:79], v16 offset:7168
    v_cvt_pk_bf16_f32 v103, v42, v43
    v_mul_f32 v89, 0x3eb8aa3b, v114
    v_mfma_f32_16x16x32_bf16 v[60:63], v[64:67], a[248:251], v[60:63]
    s_waitcnt lgkmcnt(2)
    v_mfma_f32_16x16x16_bf16 v[40:43], v[98:99], v[104:105], v[30:33]
    v_mfma_f32_16x16x16_bf16 v[44:47], v[100:101], v[104:105], v[30:33]
    v_fma_f32 v48, v110, v88, v48
    v_fma_f32 v49, v111, v88, v49
    v_fma_f32 v50, v112, v88, v50
    v_mfma_f32_16x16x32_bf16 v[56:59], v[128:131], v[68:71], v[56:59]
    s_waitcnt vmcnt(3)
    buffer_store_dword v25, off, s[36:39], s83 offset:0 sc1
    ds_read_b128 v[64:67], v16 offset:8192
    v_fma_f32 v51, v113, v88, v51
    v_mfma_f32_16x16x32_bf16 v[60:63], v[68:71], v[132:135], v[60:63]
    s_waitcnt lgkmcnt(2)
    buffer_load_dwordx4 v[90:93], v16, s[36:39], s85 offen sc1
    v_cndmask_b32 v40, v44, v40, s[60:61]
    v_cndmask_b32 v41, v45, v41, s[62:63]
    v_mfma_f32_16x16x32_bf16 v[56:59], v[140:143], v[72:75], v[56:59]
    ds_read_b128 v[68:71], v16 offset:9216
    v_cndmask_b32 v42, v46, v42, s[64:65]
    v_cndmask_b32 v43, v47, v43, s[66:67]
    v_mfma_f32_16x16x32_bf16 v[60:63], v[72:75], v[144:147], v[60:63]
    s_waitcnt lgkmcnt(2)
    v_max3_f32 v44, v40, v41, v42
    v_max_f32 v44, v44, v43
    v_mov_b32 v45, v44
    v_mfma_f32_16x16x32_bf16 v[56:59], v[152:155], v[76:79], v[56:59]
    s_add_u32 m0, s81, 116256
    ds_read_b128 v[72:75], v16 offset:10240
    v_permlane32_swap_b32 v45, v44
    v_mfma_f32_16x16x32_bf16 v[60:63], v[76:79], v[156:159], v[60:63]
    s_waitcnt lgkmcnt(2)
    buffer_load_dwordx4 v17, s[40:43], s3 offen offset:1024 lds
    v_max_f32 v44, v44, v45
    v_mfma_f32_16x16x32_bf16 v[56:59], v[164:167], v[64:67], v[56:59]
    ds_read_b128 v[76:79], v16 offset:11264
    v_mov_b32 v45, v44
    v_mul_f32 v48, v106, v48
    v_mfma_f32_16x16x32_bf16 v[60:63], v[64:67], v[168:171], v[60:63]
    s_waitcnt lgkmcnt(2)
    v_permlane16_swap_b32 v45, v44
    v_max_f32 v44, v44, v45
    v_mfma_f32_16x16x32_bf16 v[56:59], v[176:179], v[68:71], v[56:59]
    ds_read_b128 v[64:67], v16 offset:12288
    v_mul_f32 v44, v44, v116
    v_fma_f32 v40, v40, v116, -v44
    v_mfma_f32_16x16x32_bf16 v[60:63], v[68:71], v[180:183], v[60:63]
    s_waitcnt lgkmcnt(2)
    v_fma_f32 v41, v41, v116, -v44
    v_fma_f32 v42, v42, v116, -v44
    v_fma_f32 v43, v43, v116, -v44
    v_mfma_f32_16x16x32_bf16 v[56:59], v[188:191], v[72:75], v[56:59]
    s_add_u32 m0, s81, 116288
    ds_read_b128 v[68:71], v16 offset:13312
    v_exp_f32 v40, v40
    v_mfma_f32_16x16x32_bf16 v[60:63], v[72:75], v[192:195], v[60:63]
    s_waitcnt lgkmcnt(2)
    buffer_load_dwordx4 v17, s[40:43], s3 offen offset:2048 lds
    v_exp_f32 v41, v41
    v_mfma_f32_16x16x32_bf16 v[56:59], v[200:203], v[76:79], v[56:59]
    ds_read_b128 v[72:75], v16 offset:14336
    v_exp_f32 v42, v42
    v_mfma_f32_16x16x32_bf16 v[60:63], v[76:79], v[204:207], v[60:63]
    s_waitcnt lgkmcnt(2)
    v_exp_f32 v43, v43
    v_mfma_f32_16x16x32_bf16 v[56:59], v[212:215], v[64:67], v[56:59]
    ds_read_b128 v[76:79], v16 offset:15360
    v_cvt_pk_bf16_f32 v46, v40, v41
    v_cvt_pk_bf16_f32 v47, v42, v43
    v_mfma_f32_16x16x32_bf16 v[60:63], v[64:67], v[216:219], v[60:63]
    s_waitcnt lgkmcnt(2)
    v_mul_f32 v49, v107, v49
    v_mul_f32 v50, v108, v50
    v_mul_f32 v51, v109, v51
    v_mfma_f32_16x16x32_bf16 v[56:59], v[224:227], v[68:71], v[56:59]
    s_add_u32 m0, s81, 116320
    ds_read_b128 v[64:67], v16 offset:0
    v_cvt_pk_bf16_f32 v96, v48, v49
    v_mfma_f32_16x16x32_bf16 v[60:63], v[68:71], v[228:231], v[60:63]
    s_waitcnt lgkmcnt(2)
    buffer_load_dwordx4 v17, s[40:43], s3 offen offset:3072 lds
    v_cvt_pk_bf16_f32 v97, v50, v51
    v_and_b32 v48, v38, v46
    v_mfma_f32_16x16x32_bf16 v[56:59], v[236:239], v[72:75], v[56:59]
    ds_read_b128 v[68:71], v16 offset:1024
    ds_read2_b32 v[114:115], v23 offset0:0 offset1:64
    ds_read_b128 v[106:109], v24 offset:0
    v_mfma_f32_16x16x32_bf16 v[60:63], v[72:75], v[240:243], v[60:63]
    s_waitcnt lgkmcnt(4)
    ds_read_b128 v[110:113], v24 offset:256
    v_and_b32 v49, v39, v47
    v_xor_b32 v50, v48, v46
    v_mfma_f32_16x16x32_bf16 v[56:59], v[248:251], v[76:79], v[56:59]
    ds_read_b128 v[72:75], v16 offset:2048
    v_xor_b32 v51, v49, v47
    v_mfma_f32_16x16x32_bf16 v[60:63], v[76:79], v[252:255], v[60:63]
    s_waitcnt lgkmcnt(5)
    ds_read_b128 v[76:79], v16 offset:3072
    v_mfma_f32_16x16x32_bf16 v[44:47], v[34:37], v[48:51], 0
    v_mfma_f32_16x16x32_bf16 v[40:43], v[94:97], v[48:51], 0
    v_min_f32 v118, s100, v30
    v_min_f32 v119, s100, v31
    v_min_f32 v120, s100, v32
    v_min_f32 v121, s100, v33
    v_mfma_f32_16x16x32_bf16 v[52:55], a[192:195], v[64:67], 0
    ds_read_b128 v[64:67], v16 offset:4096
    s_nop 0
    v_rcp_f32 v44, v44
    s_nop 0
    v_mul_f32 v40, v44, v40
    v_mul_f32 v41, v44, v41
    v_mul_f32 v42, v44, v42
    v_mul_f32 v43, v44, v43
    v_cvt_pk_bf16_f32 v48, v40, v41
    v_cvt_pk_bf16_f32 v49, v42, v43
    buffer_store_dwordx2 v[48:49], v19, s[36:39], s90 offen offset:0 sc1
    s_waitcnt lgkmcnt(6)
    v_mfma_f32_16x16x32_bf16 v[52:55], a[204:207], v[68:71], v[52:55]
    s_waitcnt lgkmcnt(2)
    buffer_load_dword v29, v22, s[36:39], s82 offen offset:0 sc1
    ds_read_b128 v[68:71], v16 offset:5120
    v_fma_f32 v56, v115, v84, v56
    v_fma_f32 v57, v115, v85, v57
    v_mfma_f32_16x16x32_bf16 v[52:55], a[216:219], v[72:75], v[52:55]
    s_waitcnt lgkmcnt(2)
    ds_read_b128 v[72:75], v16 offset:6144
    v_fma_f32 v58, v115, v86, v58
    v_fma_f32 v59, v115, v87, v59
    v_mul_f32 v56, v114, v56
    v_mfma_f32_16x16x32_bf16 v[52:55], a[228:231], v[76:79], v[52:55]
    s_waitcnt lgkmcnt(2)
    ds_read_b128 v[76:79], v16 offset:7168
    v_mul_f32 v57, v114, v57
    v_mul_f32 v58, v114, v58
    v_mul_f32 v59, v114, v59
    v_mfma_f32_16x16x32_bf16 v[52:55], a[240:243], v[64:67], v[52:55]
    s_waitcnt lgkmcnt(2)
    ds_read_b128 v[64:67], v16 offset:8192
    v_cvt_pk_bf16_f32 v98, v56, v57
    v_cvt_pk_bf16_f32 v99, v58, v59
    v_mfma_f32_16x16x16_bf16 v[40:43], v[100:101], v[102:103], v[30:33]
    v_fma_f32 v60, v110, v88, v60
    v_mfma_f32_16x16x16_bf16 v[44:47], v[98:99], v[102:103], v[30:33]
    v_fma_f32 v61, v111, v88, v61
    v_fma_f32 v62, v112, v88, v62
    v_fma_f32 v63, v113, v88, v63
    v_mul_f32 v60, v106, v60
    v_mfma_f32_16x16x32_bf16 v[52:55], a[252:255], v[68:71], v[52:55]
    s_waitcnt lgkmcnt(2)
    ds_read_b128 v[68:71], v16 offset:9216
    v_mul_f32 v61, v107, v61
    v_cndmask_b32 v40, v44, v40, s[60:61]
    v_cndmask_b32 v41, v45, v41, s[62:63]
    v_cndmask_b32 v42, v46, v42, s[64:65]
    v_mfma_f32_16x16x32_bf16 v[52:55], v[136:139], v[72:75], v[52:55]
    s_waitcnt lgkmcnt(2)
    ds_read_b128 v[72:75], v16 offset:10240
    v_cndmask_b32 v43, v47, v43, s[66:67]
    v_max3_f32 v44, v40, v41, v42
    v_max_f32 v44, v44, v43
    v_mfma_f32_16x16x32_bf16 v[52:55], v[148:151], v[76:79], v[52:55]
    s_waitcnt lgkmcnt(2)
    ds_read_b128 v[76:79], v16 offset:11264
    v_mov_b32 v45, v44
    v_mul_f32 v62, v108, v62
    v_mul_f32 v63, v109, v63
    v_mfma_f32_16x16x32_bf16 v[52:55], v[160:163], v[64:67], v[52:55]
    s_waitcnt lgkmcnt(2)
    ds_read_b128 v[64:67], v16 offset:12288
    v_permlane32_swap_b32 v45, v44
    v_max_f32 v44, v44, v45
    v_mfma_f32_16x16x32_bf16 v[52:55], v[172:175], v[68:71], v[52:55]
    s_waitcnt vmcnt(1)
    s_waitcnt lgkmcnt(2)
    buffer_store_dword v25, off, s[36:39], s83 offset:128 sc1
    ds_read_b128 v[68:71], v16 offset:13312
    v_mov_b32 v45, v44
    s_waitcnt vmcnt(1)
    v_cmp_gt_u32 vcc, s72, v29
    v_mfma_f32_16x16x32_bf16 v[52:55], v[184:187], v[72:75], v[52:55]
    s_cbranch_vccnz L_slow_111
L_back_112:
    s_add_u32 m0, s80, 49152
    s_waitcnt lgkmcnt(2)
    ds_read_b128 v[72:75], v16 offset:14336
    v_permlane16_swap_b32 v45, v44
    v_mfma_f32_16x16x32_bf16 v[52:55], v[196:199], v[76:79], v[52:55]
    s_waitcnt lgkmcnt(2)
    buffer_load_dwordx4 v16, s[36:39], s95 offen offset:0 sc1 lds
    ds_read_b128 v[76:79], v16 offset:15360
    v_max_f32 v44, v44, v45
    v_mul_f32 v44, v44, v89
    v_mfma_f32_16x16x32_bf16 v[52:55], v[208:211], v[64:67], v[52:55]
    s_waitcnt lgkmcnt(2)
    buffer_load_dwordx4 v16, s[36:39], s95 offen offset:1024 sc1 lds
    v_fma_f32 v40, v40, v89, -v44
    v_fma_f32 v41, v41, v89, -v44
    v_fma_f32 v42, v42, v89, -v44
    v_mfma_f32_16x16x32_bf16 v[52:55], v[220:223], v[68:71], v[52:55]
    s_waitcnt lgkmcnt(1)
    buffer_load_dwordx4 v16, s[36:39], s95 offen offset:2048 sc1 lds
    v_fma_f32 v43, v43, v89, -v44
    v_exp_f32 v40, v40
    v_mfma_f32_16x16x32_bf16 v[52:55], v[232:235], v[72:75], v[52:55]
    s_waitcnt lgkmcnt(0)
    buffer_load_dwordx4 v16, s[36:39], s95 offen offset:3072 sc1 lds
    v_exp_f32 v41, v41
    v_exp_f32 v42, v42
    v_mfma_f32_16x16x32_bf16 v[52:55], v[244:247], v[76:79], v[52:55]
    v_exp_f32 v43, v43
    v_cvt_pk_bf16_f32 v46, v40, v41
    v_cvt_pk_bf16_f32 v47, v42, v43
    v_cvt_pk_bf16_f32 v94, v60, v61
    v_cvt_pk_bf16_f32 v95, v62, v63
    v_and_b32 v50, v38, v46
    v_and_b32 v51, v39, v47
    v_xor_b32 v48, v50, v46
    v_xor_b32 v49, v51, v47
    s_nop 1
    v_mfma_f32_16x16x32_bf16 v[44:47], v[34:37], v[48:51], 0
    v_mfma_f32_16x16x32_bf16 v[40:43], v[94:97], v[48:51], 0
    v_fma_f32 v52, v115, v80, v52
    v_fma_f32 v53, v115, v81, v53
    v_fma_f32 v54, v115, v82, v54
    v_fma_f32 v55, v115, v83, v55
    v_cvt_pk_bf16_f32 v104, v52, v53
    v_cvt_pk_bf16_f32 v105, v54, v55
    v_mul_f32 v116, 0x3eb8aa3b, v114
    v_cmp_eq_u32 vcc, -1, v93
    v_rcp_f32 v44, v44
    s_nop 0
    v_mul_f32 v40, v44, v40
    v_mul_f32 v41, v44, v41
    v_mul_f32 v42, v44, v42
    s_cbranch_vccnz L_slow_114
L_back_115:
    s_add_u32 s85, s85, 0x8000
    v_mfma_f32_16x16x16_bf16 v[52:55], v[98:99], v[104:105], v[30:33]
    v_mfma_f32_16x16x16_bf16 v[56:59], v[90:91], v[104:105], v[118:121]
    v_mul_f32 v43, v44, v43
    v_cvt_pk_bf16_f32 v48, v40, v41
    v_cvt_pk_bf16_f32 v49, v42, v43
    buffer_store_dwordx2 v[48:49], v19, s[36:39], s89 offen offset:0 sc1
    s_nop 3
    v_cndmask_b32 v52, v56, v52, s[60:61]
    v_cndmask_b32 v53, v57, v53, s[62:63]
    v_cndmask_b32 v54, v58, v54, s[64:65]
    v_cndmask_b32 v55, v59, v55, s[66:67]
    v_max3_f32 v56, v52, v53, v54
    v_max_f32 v56, v56, v55
    v_mov_b32 v57, v56
    s_nop 1
    v_permlane32_swap_b32 v57, v56
    v_max_f32 v56, v56, v57
    v_mov_b32 v57, v56
    s_nop 1
    v_permlane16_swap_b32 v57, v56
    v_max_f32 v56, v56, v57
    v_mul_f32 v56, v56, v116
    buffer_load_dword v29, v22, s[36:39], s82 offen offset:128 sc1
    v_fma_f32 v52, v52, v116, -v56
    v_fma_f32 v53, v53, v116, -v56
    v_fma_f32 v54, v54, v116, -v56
    v_fma_f32 v55, v55, v116, -v56
    v_exp_f32 v52, v52
    v_exp_f32 v53, v53
    v_exp_f32 v54, v54
    v_exp_f32 v55, v55
    v_cvt_pk_bf16_f32 v58, v52, v53
    v_cvt_pk_bf16_f32 v59, v54, v55
    v_and_b32 v62, v38, v58
    v_and_b32 v63, v39, v59
    v_xor_b32 v60, v62, v58
    v_xor_b32 v61, v63, v59
    s_nop 1
    v_mfma_f32_16x16x32_bf16 v[56:59], v[34:37], v[60:63], 0
    v_mfma_f32_16x16x32_bf16 v[52:55], v[92:95], v[60:63], 0
    s_nop 6
    v_rcp_f32 v56, v56
    s_nop 0
    v_mul_f32 v52, v56, v52
    v_mul_f32 v53, v56, v53
    v_mul_f32 v54, v56, v54
    v_mul_f32 v55, v56, v55
    v_cvt_pk_bf16_f32 v60, v52, v53
    s_waitcnt vmcnt(1)
    buffer_store_dword v25, off, s[36:39], s83 offset:896 sc1
    v_cvt_pk_bf16_f32 v61, v54, v55
    buffer_store_dwordx2 v[60:61], v19, s[36:39], s88 offen offset:0 sc1
    s_waitcnt vmcnt(2)
    v_cmp_gt_u32 vcc, s72, v29
    s_cbranch_vccnz L_slow_117
L_back_118:
    s_add_u32 m0, s80, 32768
    s_nop 0
    buffer_load_dwordx4 v16, s[36:39], s94 offen offset:0 sc1 lds
    buffer_load_dwordx4 v16, s[36:39], s94 offen offset:1024 sc1 lds
    buffer_load_dwordx4 v16, s[36:39], s94 offen offset:2048 sc1 lds
    buffer_load_dwordx4 v16, s[36:39], s94 offen offset:3072 sc1 lds
    s_cmp_lt_u32 s72, 4
    s_cbranch_scc1 L_wS
    s_barrier
    ds_read_b64_tr_b16 v[40:41], v18 offset:0
    ds_read_b64_tr_b16 v[42:43], v18 offset:256
    ds_read_b128 v[104:107], v16 offset:49152
    ds_read_b64_tr_b16 v[44:45], v18 offset:4224
    ds_read_b64_tr_b16 v[46:47], v18 offset:4480
    ds_read_b128 v[108:111], v16 offset:50176
    ds_read_b64_tr_b16 v[48:49], v18 offset:8448
    ds_read_b64_tr_b16 v[50:51], v18 offset:8704
    ds_read_b128 v[112:115], v16 offset:51200
    ds_read_b64_tr_b16 v[52:53], v18 offset:12672
    ds_read_b64_tr_b16 v[54:55], v18 offset:12928
    ds_read_b128 v[116:119], v16 offset:52224
    ds_read_b128 v[120:123], v16 offset:53248
    ds_read_b128 v[124:127], v16 offset:54272
    ds_read_b64_tr_b16 v[56:57], v18 offset:16896
    ds_read_b64_tr_b16 v[58:59], v18 offset:17152
    ds_read_b128 v[32:35], v16 offset:55296
    s_waitcnt lgkmcnt(14)
    v_mfma_f32_16x16x32_bf16 v[12:15], v[40:43], v[104:107], v[12:15]
    ds_read_b64_tr_b16 v[60:61], v18 offset:21120
    ds_read_b64_tr_b16 v[62:63], v18 offset:21376
    ds_read_b128 v[104:107], v16 offset:56320
    s_waitcnt lgkmcnt(14)
    v_mfma_f32_16x16x32_bf16 v[12:15], v[44:47], v[108:111], v[12:15]
    ds_read_b64_tr_b16 v[64:65], v18 offset:25344
    ds_read_b64_tr_b16 v[66:67], v18 offset:25600
    ds_read_b128 v[108:111], v16 offset:57344
    s_waitcnt vmcnt(4)
    buffer_store_dword v25, off, s[36:39], s83 offset:256 sc1
    buffer_load_dword v29, v22, s[36:39], s82 offen offset:896 sc1
    s_waitcnt lgkmcnt(14)
    v_mfma_f32_16x16x32_bf16 v[12:15], v[48:51], v[112:115], v[12:15]
    ds_read_b64_tr_b16 v[68:69], v18 offset:29568
    ds_read_b64_tr_b16 v[70:71], v18 offset:29824
    ds_read_b128 v[112:115], v16 offset:58368
    s_waitcnt lgkmcnt(14)
    v_mfma_f32_16x16x32_bf16 v[12:15], v[52:55], v[116:119], v[12:15]
    ds_read_b64_tr_b16 v[72:73], v18 offset:33792
    ds_read_b64_tr_b16 v[74:75], v18 offset:34048
    ds_read_b128 v[116:119], v16 offset:59392
    s_waitcnt lgkmcnt(13)
    v_mfma_f32_16x16x32_bf16 v[12:15], v[56:59], v[120:123], v[12:15]
    ds_read_b64_tr_b16 v[76:77], v18 offset:38016
    ds_read_b64_tr_b16 v[78:79], v18 offset:38272
    ds_read_b128 v[120:123], v16 offset:60416
    s_waitcnt lgkmcnt(13)
    v_mfma_f32_16x16x32_bf16 v[12:15], v[60:63], v[124:127], v[12:15]
    ds_read_b64_tr_b16 v[80:81], v18 offset:42240
    ds_read_b64_tr_b16 v[82:83], v18 offset:42496
    ds_read_b128 v[124:127], v16 offset:61440
    s_waitcnt lgkmcnt(13)
    v_mfma_f32_16x16x32_bf16 v[12:15], v[64:67], v[32:35], v[12:15]
    ds_read_b64_tr_b16 v[84:85], v18 offset:46464
    ds_read_b64_tr_b16 v[86:87], v18 offset:46720
    ds_read_b128 v[32:35], v16 offset:62464
    s_waitcnt lgkmcnt(13)
    v_mfma_f32_16x16x32_bf16 v[12:15], v[68:71], v[104:107], v[12:15]
    ds_read_b64_tr_b16 v[88:89], v18 offset:50688
    ds_read_b64_tr_b16 v[90:91], v18 offset:50944
    ds_read_b128 v[104:107], v16 offset:63488
    s_waitcnt vmcnt(0)
    v_cmp_gt_u32 vcc, s72, v29
    s_add_u32 m0, s80, 16384
    s_waitcnt lgkmcnt(13)
    v_mfma_f32_16x16x32_bf16 v[12:15], v[72:75], v[108:111], v[12:15]
    ds_read_b64_tr_b16 v[92:93], v18 offset:54912
    ds_read_b64_tr_b16 v[94:95], v18 offset:55168
    ds_read_b128 v[108:111], v16 offset:64512
    s_waitcnt lgkmcnt(13)
    v_mfma_f32_16x16x32_bf16 v[12:15], v[76:79], v[112:115], v[12:15]
    ds_read_b64_tr_b16 v[96:97], v18 offset:59136
    ds_read_b64_tr_b16 v[98:99], v18 offset:59392
    s_cbranch_vccnz L_slow_123
L_back_124:
    buffer_load_dwordx4 v16, s[36:39], s93 offen offset:0 sc1 lds
    s_waitcnt lgkmcnt(12)
    v_mfma_f32_16x16x32_bf16 v[12:15], v[80:83], v[116:119], v[12:15]
    ds_read_b64_tr_b16 v[100:101], v18 offset:63360
    ds_read_b64_tr_b16 v[102:103], v18 offset:63616
    s_waitcnt lgkmcnt(11)
    v_mfma_f32_16x16x32_bf16 v[12:15], v[84:87], v[120:123], v[12:15]
    buffer_load_dwordx4 v16, s[36:39], s93 offen offset:1024 sc1 lds
    s_waitcnt lgkmcnt(8)
    v_mfma_f32_16x16x32_bf16 v[12:15], v[88:91], v[124:127], v[12:15]
    buffer_load_dword v29, v22, s[36:39], s82 offen offset:256 sc1
    s_waitcnt lgkmcnt(5)
    v_mfma_f32_16x16x32_bf16 v[12:15], v[92:95], v[32:35], v[12:15]
    buffer_load_dwordx4 v16, s[36:39], s93 offen offset:2048 sc1 lds
    s_waitcnt lgkmcnt(2)
    v_mfma_f32_16x16x32_bf16 v[12:15], v[96:99], v[104:107], v[12:15]
    s_waitcnt lgkmcnt(0)
    v_mfma_f32_16x16x32_bf16 v[12:15], v[100:103], v[108:111], v[12:15]
    s_barrier
    ds_read_b128 v[112:115], v16 offset:32768
    ds_read_b128 v[116:119], v16 offset:33792
    ds_read_b128 v[120:123], v16 offset:34816
    ds_read_b128 v[124:127], v16 offset:35840
    ds_read_b128 v[32:35], v16 offset:36864
    ds_read_b128 v[104:107], v16 offset:37888
    ds_read_b128 v[108:111], v16 offset:38912
    buffer_load_dwordx4 v16, s[36:39], s93 offen offset:3072 sc1 lds
    s_waitcnt lgkmcnt(6)
    v_mfma_f32_16x16x32_bf16 v[8:11], v[40:43], v[112:115], v[8:11]
    ds_read_b128 v[112:115], v16 offset:39936
    s_waitcnt lgkmcnt(6)
    v_mfma_f32_16x16x32_bf16 v[8:11], v[44:47], v[116:119], v[8:11]
    ds_read_b128 v[116:119], v16 offset:40960
    s_waitcnt lgkmcnt(6)
    v_mfma_f32_16x16x32_bf16 v[8:11], v[48:51], v[120:123], v[8:11]
    ds_read_b128 v[120:123], v16 offset:41984
    s_waitcnt lgkmcnt(6)
    v_mfma_f32_16x16x32_bf16 v[8:11], v[52:55], v[124:127], v[8:11]
    ds_read_b128 v[124:127], v16 offset:43008
    s_waitcnt lgkmcnt(6)
    v_mfma_f32_16x16x32_bf16 v[8:11], v[56:59], v[32:35], v[8:11]
    ds_read_b128 v[32:35], v16 offset:44032
    s_waitcnt vmcnt(2)
    v_cmp_gt_u32 vcc, s72, v29
    s_add_u32 m0, s80, 0
    s_waitcnt lgkmcnt(6)
    v_mfma_f32_16x16x32_bf16 v[8:11], v[60:63], v[104:107], v[8:11]
    ds_read_b128 v[104:107], v16 offset:45056
    s_waitcnt lgkmcnt(6)
    v_mfma_f32_16x16x32_bf16 v[8:11], v[64:67], v[108:111], v[8:11]
    ds_read_b128 v[108:111], v16 offset:46080
    s_cbranch_vccnz L_slow_120
L_back_121:
    buffer_load_dwordx4 v16, s[36:39], s92 offen offset:0 sc1 lds
    s_waitcnt lgkmcnt(6)
    v_mfma_f32_16x16x32_bf16 v[8:11], v[68:71], v[112:115], v[8:11]
    ds_read_b128 v[112:115], v16 offset:47104
    s_waitcnt lgkmcnt(6)
    v_mfma_f32_16x16x32_bf16 v[8:11], v[72:75], v[116:119], v[8:11]
    ds_read_b128 v[116:119], v16 offset:48128
    buffer_load_dwordx4 v16, s[36:39], s92 offen offset:1024 sc1 lds
    s_waitcnt lgkmcnt(6)
    v_mfma_f32_16x16x32_bf16 v[8:11], v[76:79], v[120:123], v[8:11]
    s_waitcnt lgkmcnt(5)
    v_mfma_f32_16x16x32_bf16 v[8:11], v[80:83], v[124:127], v[8:11]
    buffer_load_dwordx4 v16, s[36:39], s92 offen offset:2048 sc1 lds
    s_waitcnt lgkmcnt(4)
    v_mfma_f32_16x16x32_bf16 v[8:11], v[84:87], v[32:35], v[8:11]
    v_bfe_u32 v30, v16, 4, 5
    s_waitcnt lgkmcnt(3)
    v_mfma_f32_16x16x32_bf16 v[8:11], v[88:91], v[104:107], v[8:11]
    buffer_load_dwordx4 v16, s[36:39], s92 offen offset:3072 sc1 lds
    v_lshrrev_b32 v31, 9, v16
    s_lshl_b32 s74, s69, 2
    s_add_u32 s74, s74, s68
    s_waitcnt lgkmcnt(2)
    v_mfma_f32_16x16x32_bf16 v[8:11], v[92:95], v[108:111], v[8:11]
    s_lshl_b32 s74, s74, 5
    v_lshl_add_u32 v30, v30, 11, s74
    v_lshl_add_u32 v20, v31, 4, v30
    s_add_u32 s75, s71, 0x10000
    s_waitcnt lgkmcnt(1)
    v_mfma_f32_16x16x32_bf16 v[8:11], v[96:99], v[112:115], v[8:11]
    s_waitcnt lgkmcnt(0)
    v_mfma_f32_16x16x32_bf16 v[8:11], v[100:103], v[116:119], v[8:11]
    v_cvt_pk_bf16_f32 v38, v12, v13
    v_cvt_pk_bf16_f32 v39, v14, v15
    s_nop 5
    v_cvt_pk_bf16_f32 v36, v8, v9
    v_cvt_pk_bf16_f32 v37, v10, v11
    s_nop 0
    v_permlane16_swap_b32 v36, v38
    v_permlane16_swap_b32 v37, v39
    buffer_store_dwordx4 v[36:39], v20, s[28:31], s75 offen
    s_waitcnt vmcnt(5)
    s_barrier
    ds_read_b128 v[120:123], v16 offset:16384
    ds_read_b128 v[124:127], v16 offset:17408
    ds_read_b128 v[32:35], v16 offset:18432
    ds_read_b128 v[104:107], v16 offset:19456
    ds_read_b128 v[108:111], v16 offset:20480
    ds_read_b128 v[112:115], v16 offset:21504
    ds_read_b128 v[116:119], v16 offset:22528
    s_waitcnt lgkmcnt(6)
    v_mfma_f32_16x16x32_bf16 v[4:7], v[40:43], v[120:123], v[4:7]
    ds_read_b128 v[120:123], v16 offset:23552
    s_waitcnt lgkmcnt(6)
    v_mfma_f32_16x16x32_bf16 v[4:7], v[44:47], v[124:127], v[4:7]
    ds_read_b128 v[124:127], v16 offset:24576
    s_waitcnt lgkmcnt(6)
    v_mfma_f32_16x16x32_bf16 v[4:7], v[48:51], v[32:35], v[4:7]
    ds_read_b128 v[32:35], v16 offset:25600
    s_waitcnt lgkmcnt(6)
    v_mfma_f32_16x16x32_bf16 v[4:7], v[52:55], v[104:107], v[4:7]
    ds_read_b128 v[104:107], v16 offset:26624
    s_waitcnt lgkmcnt(6)
    v_mfma_f32_16x16x32_bf16 v[4:7], v[56:59], v[108:111], v[4:7]
    ds_read_b128 v[108:111], v16 offset:27648
    s_waitcnt lgkmcnt(6)
    v_mfma_f32_16x16x32_bf16 v[4:7], v[60:63], v[112:115], v[4:7]
    ds_read_b128 v[112:115], v16 offset:28672
    s_waitcnt lgkmcnt(6)
    v_mfma_f32_16x16x32_bf16 v[4:7], v[64:67], v[116:119], v[4:7]
    ds_read_b128 v[116:119], v16 offset:29696
    s_waitcnt lgkmcnt(6)
    v_mfma_f32_16x16x32_bf16 v[4:7], v[68:71], v[120:123], v[4:7]
    ds_read_b128 v[120:123], v16 offset:30720
    s_waitcnt lgkmcnt(6)
    v_mfma_f32_16x16x32_bf16 v[4:7], v[72:75], v[124:127], v[4:7]
    ds_read_b128 v[124:127], v16 offset:31744
    s_waitcnt lgkmcnt(6)
    v_mfma_f32_16x16x32_bf16 v[4:7], v[76:79], v[32:35], v[4:7]
    s_waitcnt vmcnt(1)
    s_barrier
    ds_read_b128 v[32:35], v16 offset:0
    s_waitcnt lgkmcnt(6)
    v_mfma_f32_16x16x32_bf16 v[4:7], v[80:83], v[104:107], v[4:7]
    ds_read_b128 v[104:107], v16 offset:1024
    s_waitcnt lgkmcnt(6)
    v_mfma_f32_16x16x32_bf16 v[4:7], v[84:87], v[108:111], v[4:7]
    ds_read_b128 v[108:111], v16 offset:2048
    s_waitcnt lgkmcnt(6)
    v_mfma_f32_16x16x32_bf16 v[4:7], v[88:91], v[112:115], v[4:7]
    ds_read_b128 v[112:115], v16 offset:3072
    s_waitcnt lgkmcnt(6)
    v_mfma_f32_16x16x32_bf16 v[4:7], v[92:95], v[116:119], v[4:7]
    ds_read_b128 v[116:119], v16 offset:4096
    s_waitcnt lgkmcnt(6)
    v_mfma_f32_16x16x32_bf16 v[4:7], v[96:99], v[120:123], v[4:7]
    ds_read_b128 v[120:123], v16 offset:5120
    s_waitcnt lgkmcnt(6)
    v_mfma_f32_16x16x32_bf16 v[4:7], v[100:103], v[124:127], v[4:7]
    ds_read_b128 v[124:127], v16 offset:6144
    s_waitcnt lgkmcnt(6)
    v_mfma_f32_16x16x32_bf16 v[0:3], v[40:43], v[32:35], v[0:3]
    ds_read_b128 v[32:35], v16 offset:7168
    s_waitcnt lgkmcnt(6)
    v_mfma_f32_16x16x32_bf16 v[0:3], v[44:47], v[104:107], v[0:3]
    ds_read_b128 v[104:107], v16 offset:8192
    s_waitcnt lgkmcnt(6)
    v_mfma_f32_16x16x32_bf16 v[0:3], v[48:51], v[108:111], v[0:3]
    ds_read_b128 v[108:111], v16 offset:9216
    v_cvt_pk_bf16_f32 v38, v4, v5
    v_cvt_pk_bf16_f32 v39, v6, v7
    s_waitcnt lgkmcnt(6)
    v_mfma_f32_16x16x32_bf16 v[0:3], v[52:55], v[112:115], v[0:3]
    ds_read_b128 v[112:115], v16 offset:10240
    s_waitcnt lgkmcnt(6)
    v_mfma_f32_16x16x32_bf16 v[0:3], v[56:59], v[116:119], v[0:3]
    ds_read_b128 v[116:119], v16 offset:11264
    s_waitcnt lgkmcnt(6)
    v_mfma_f32_16x16x32_bf16 v[0:3], v[60:63], v[120:123], v[0:3]
    ds_read_b128 v[120:123], v16 offset:12288
    s_waitcnt lgkmcnt(6)
    v_mfma_f32_16x16x32_bf16 v[0:3], v[64:67], v[124:127], v[0:3]
    ds_read_b128 v[124:127], v16 offset:13312
    s_waitcnt lgkmcnt(6)
    v_mfma_f32_16x16x32_bf16 v[0:3], v[68:71], v[32:35], v[0:3]
    ds_read_b128 v[32:35], v16 offset:14336
    s_waitcnt lgkmcnt(6)
    v_mfma_f32_16x16x32_bf16 v[0:3], v[72:75], v[104:107], v[0:3]
    ds_read_b128 v[104:107], v16 offset:15360
    s_waitcnt lgkmcnt(6)
    v_mfma_f32_16x16x32_bf16 v[0:3], v[76:79], v[108:111], v[0:3]
    s_waitcnt lgkmcnt(5)
    v_mfma_f32_16x16x32_bf16 v[0:3], v[80:83], v[112:115], v[0:3]
    s_waitcnt lgkmcnt(4)
    v_mfma_f32_16x16x32_bf16 v[0:3], v[84:87], v[116:119], v[0:3]
    s_waitcnt lgkmcnt(3)
    v_mfma_f32_16x16x32_bf16 v[0:3], v[88:91], v[120:123], v[0:3]
    s_waitcnt lgkmcnt(2)
    v_mfma_f32_16x16x32_bf16 v[0:3], v[92:95], v[124:127], v[0:3]
    s_waitcnt lgkmcnt(1)
    v_mfma_f32_16x16x32_bf16 v[0:3], v[96:99], v[32:35], v[0:3]
    s_waitcnt lgkmcnt(0)
    v_mfma_f32_16x16x32_bf16 v[0:3], v[100:103], v[104:107], v[0:3]
    s_nop 7
    v_cvt_pk_bf16_f32 v36, v0, v1
    v_cvt_pk_bf16_f32 v37, v2, v3
    s_nop 0
    v_permlane16_swap_b32 v36, v38
    v_permlane16_swap_b32 v37, v39
    buffer_store_dwordx4 v[36:39], v20, s[28:31], s71 offen
    s_endpgm
L_slow_66:
    s_mov_b32 s73, 0
L_spin_68:
    buffer_load_dword v29, off, s[36:39], s58 offset:1024 sc1
    s_waitcnt vmcnt(0)
    v_cmp_ne_u32 vcc, 1, v29
    s_cbranch_vccz L_back_67
    s_add_u32 s73, s73, 1
    s_cmp_lt_u32 s73, 262144
    s_cbranch_scc1 L_spin_68
    s_endpgm
L_slow_69:
    s_mov_b32 s73, 0
L_spin_71:
    buffer_load_dwordx4 v[90:93], v16, s[36:39], s85 offen sc1
    s_waitcnt vmcnt(0)
    v_cmp_eq_u32 vcc, -1, v93
    s_cbranch_vccz L_back_70
    s_add_u32 s73, s73, 1
    s_cmp_lt_u32 s73, 262144
    s_cbranch_scc1 L_spin_71
    s_endpgm
L_slow_72:
    s_mov_b32 s73, 0
L_spin_74:
    buffer_load_dword v29, v22, s[36:39], s82 offen offset:0 sc1
    s_waitcnt vmcnt(0)
    v_cmp_gt_u32 vcc, s72, v29
    s_cbranch_vccz L_back_73
    s_add_u32 s73, s73, 1
    s_cmp_lt_u32 s73, 262144
    s_cbranch_scc1 L_spin_74
    s_endpgm
L_slow_75:
    s_mov_b32 s73, 0
L_spin_77:
    buffer_load_dword v29, v22, s[36:39], s82 offen offset:256 sc1
    s_waitcnt vmcnt(0)
    v_cmp_gt_u32 vcc, s72, v29
    s_cbranch_vccz L_back_76
    s_add_u32 s73, s73, 1
    s_cmp_lt_u32 s73, 262144
    s_cbranch_scc1 L_spin_77
    s_endpgm
L_slow_78:
    s_mov_b32 s73, 0
L_spin_80:
    buffer_load_dword v29, v22, s[36:39], s82 offen offset:384 sc1
    s_waitcnt vmcnt(0)
    v_cmp_gt_u32 vcc, s72, v29
    s_cbranch_vccz L_back_79
    s_add_u32 s73, s73, 1
    s_cmp_lt_u32 s73, 262144
    s_cbranch_scc1 L_spin_80
    s_endpgm
L_slow_81:
    s_mov_b32 s73, 0
L_spin_83:
    buffer_load_dword v29, v22, s[36:39], s82 offen offset:896 sc1
    s_waitcnt vmcnt(0)
    v_cmp_gt_u32 vcc, s72, v29
    s_cbranch_vccz L_back_82
    s_add_u32 s73, s73, 1
    s_cmp_lt_u32 s73, 262144
    s_cbranch_scc1 L_spin_83
    s_endpgm
L_slow_84:
    s_mov_b32 s73, 0
L_spin_86:
    buffer_load_dword v29, v22, s[36:39], s82 offen offset:512 sc1
    s_waitcnt vmcnt(0)
    v_cmp_gt_u32 vcc, s72, v29
    s_cbranch_vccz L_back_85
    s_add_u32 s73, s73, 1
    s_cmp_lt_u32 s73, 262144
    s_cbranch_scc1 L_spin_86
    s_endpgm
L_slow_87:
    s_mov_b32 s73, 0
L_spin_89:
    buffer_load_dword v29, v22, s[36:39], s82 offen offset:640 sc1
    s_waitcnt vmcnt(0)
    v_cmp_gt_u32 vcc, s72, v29
    s_cbranch_vccz L_back_88
    s_add_u32 s73, s73, 1
    s_cmp_lt_u32 s73, 262144
    s_cbranch_scc1 L_spin_89
    s_endpgm
L_slow_90:
    s_mov_b32 s73, 0
L_spin_92:
    buffer_load_dword v29, v22, s[36:39], s82 offen offset:768 sc1
    s_waitcnt vmcnt(0)
    v_cmp_gt_u32 vcc, s72, v29
    s_cbranch_vccz L_back_91
    s_add_u32 s73, s73, 1
    s_cmp_lt_u32 s73, 262144
    s_cbranch_scc1 L_spin_92
    s_endpgm
L_slow_93:
    s_mov_b32 s73, 0
L_spin_95:
    buffer_load_dword v29, v22, s[36:39], s82 offen offset:0 sc1
    s_waitcnt vmcnt(0)
    v_cmp_gt_u32 vcc, s72, v29
    s_cbranch_vccz L_back_94
    s_add_u32 s73, s73, 1
    s_cmp_lt_u32 s73, 262144
    s_cbranch_scc1 L_spin_95
    s_endpgm
L_slow_96:
    s_mov_b32 s73, 0
L_spin_98:
    buffer_load_dwordx4 v[90:93], v16, s[36:39], s85 offen sc1
    s_waitcnt vmcnt(0)
    v_cmp_eq_u32 vcc, -1, v93
    s_cbranch_vccz L_back_97
    s_add_u32 s73, s73, 1
    s_cmp_lt_u32 s73, 262144
    s_cbranch_scc1 L_spin_98
    s_endpgm
L_slow_99:
    s_mov_b32 s73, 0
L_spin_101:
    buffer_load_dword v29, v22, s[36:39], s82 offen offset:128 sc1
    s_waitcnt vmcnt(0)
    v_cmp_gt_u32 vcc, s72, v29
    s_cbranch_vccz L_back_100
    s_add_u32 s73, s73, 1
    s_cmp_lt_u32 s73, 262144
    s_cbranch_scc1 L_spin_101
    s_endpgm
L_slow_102:
    s_mov_b32 s73, 0
L_spin_104:
    buffer_load_dword v29, v22, s[36:39], s82 offen offset:512 sc1
    s_waitcnt vmcnt(0)
    v_cmp_gt_u32 vcc, s72, v29
    s_cbranch_vccz L_back_103
    s_add_u32 s73, s73, 1
    s_cmp_lt_u32 s73, 262144
    s_cbranch_scc1 L_spin_104
    s_endpgm
L_slow_105:
    s_mov_b32 s73, 0
L_spin_107:
    buffer_load_dword v29, v22, s[36:39], s82 offen offset:640 sc1
    s_waitcnt vmcnt(0)
    v_cmp_gt_u32 vcc, s72, v29
    s_cbranch_vccz L_back_106
    s_add_u32 s73, s73, 1
    s_cmp_lt_u32 s73, 262144
    s_cbranch_scc1 L_spin_107
    s_endpgm
L_slow_108:
    s_mov_b32 s73, 0
L_spin_110:
    buffer_load_dword v29, v22, s[36:39], s82 offen offset:768 sc1
    s_waitcnt vmcnt(0)
    v_cmp_gt_u32 vcc, s72, v29
    s_cbranch_vccz L_back_109
    s_add_u32 s73, s73, 1
    s_cmp_lt_u32 s73, 262144
    s_cbranch_scc1 L_spin_110
    s_endpgm
L_slow_111:
    s_mov_b32 s73, 0
L_spin_113:
    buffer_load_dword v29, v22, s[36:39], s82 offen offset:0 sc1
    s_waitcnt vmcnt(0)
    v_cmp_gt_u32 vcc, s72, v29
    s_cbranch_vccz L_back_112
    s_add_u32 s73, s73, 1
    s_cmp_lt_u32 s73, 262144
    s_cbranch_scc1 L_spin_113
    s_endpgm
L_slow_114:
    s_mov_b32 s73, 0
L_spin_116:
    buffer_load_dwordx4 v[90:93], v16, s[36:39], s85 offen sc1
    s_waitcnt vmcnt(0)
    v_cmp_eq_u32 vcc, -1, v93
    s_cbranch_vccz L_back_115
    s_add_u32 s73, s73, 1
    s_cmp_lt_u32 s73, 262144
    s_cbranch_scc1 L_spin_116
    s_endpgm
L_slow_117:
    s_mov_b32 s73, 0
L_spin_119:
    buffer_load_dword v29, v22, s[36:39], s82 offen offset:128 sc1
    s_waitcnt vmcnt(0)
    v_cmp_gt_u32 vcc, s72, v29
    s_cbranch_vccz L_back_118
    s_add_u32 s73, s73, 1
    s_cmp_lt_u32 s73, 262144
    s_cbranch_scc1 L_spin_119
    s_endpgm
L_slow_120:
    s_mov_b32 s73, 0
L_spin_122:
    buffer_load_dword v29, v22, s[36:39], s82 offen offset:256 sc1
    s_waitcnt vmcnt(0)
    v_cmp_gt_u32 vcc, s72, v29
    s_cbranch_vccz L_back_121
    s_add_u32 s73, s73, 1
    s_cmp_lt_u32 s73, 262144
    s_cbranch_scc1 L_spin_122
    s_endpgm
L_slow_123:
    s_mov_b32 s73, 0
L_spin_125:
    buffer_load_dword v29, v22, s[36:39], s82 offen offset:896 sc1
    s_waitcnt vmcnt(0)
    v_cmp_gt_u32 vcc, s72, v29
    s_cbranch_vccz L_back_124
    s_add_u32 s73, s73, 1
    s_cmp_lt_u32 s73, 262144
    s_cbranch_scc1 L_spin_125
    s_endpgm
    s_endpgm
.section .rodata,"a"
.p2align 6
.amdhsa_kernel interleave_layers__sliding_local_dilated__sliding_local_dilated__prompt_kernel
  .amdhsa_next_free_vgpr 512
  .amdhsa_next_free_sgpr 102
  .amdhsa_accum_offset 256
  .amdhsa_group_segment_fixed_size 0
  .amdhsa_kernarg_size 72
  .amdhsa_user_sgpr_count 2
  .amdhsa_user_sgpr_kernarg_segment_ptr 1
  .amdhsa_system_sgpr_workgroup_id_x 1
  .amdhsa_float_denorm_mode_32 3
.end_amdhsa_kernel
```
